```python
import torch

def _softmax(x, axis=-1):
    return torch.softmax(x, dim=axis)
def _gelu(x):
    return torch.nn.functional.gelu(x, approximate="tanh")
def _silu(x):
    return torch.nn.functional.silu(x)
def _sigmoid(x):
    return torch.sigmoid(x)
def _layernorm(x, axis=-1, eps=1e-5):
    m = x.mean(dim=axis, keepdim=True)
    v = x.var(dim=axis, keepdim=True, unbiased=False)
    return (x - m) / torch.sqrt(v + eps)
def _scatter_add(tgt, idx, src, axis=0):
    return tgt.clone().index_add_(axis, idx, src)
def _segment_sum(src, seg, n):
    out = torch.zeros((n,) + src.shape[1:], dtype=src.dtype)
    return out.index_add_(0, seg, src)
def _pad(x, pw):
    flat = tuple(v for pair in reversed(pw) for v in pair)
    return torch.nn.functional.pad(x, flat)

kernel_name = 'recurrent_scan__linear_kernel_hedgehog__glu_gated_reglu__prompt'

def setup_inputs():

    _w = (lambda a: (lambda t: t.to(torch.bfloat16) if t.is_floating_point() else t)(torch.as_tensor(a)))
    def _A_setup():
        B, S, D, H = 1, 2048, 512, 32
        Dh = D // H
        return {
            "x": _w((lambda *s: torch.randn(*s, dtype=torch.bfloat16) * 0.05)(B, S, D)),
            "wqkv": _w((lambda *s: torch.randn(*s, dtype=torch.bfloat16) * 0.8)(D, 3 * D)),
            "w_phi": _w((lambda *s: torch.randn(*s, dtype=torch.bfloat16) * 0.8)(H, Dh, Dh) * (Dh ** -0.5)),
            "wo": _w((lambda *s: torch.randn(*s, dtype=torch.bfloat16) * 0.8)(D, D)),
        }
    _A_in = _A_setup()

    def _B_setup():
        B, S, D, F = 1, 2048, 512, 1792
        return {
            "x": _w((lambda *s: torch.randn(*s, dtype=torch.bfloat16) * 0.05)(B, S, D)),
            "W_gate": _w((lambda *s: torch.randn(*s, dtype=torch.bfloat16) * 0.2)(D, F) * (2.0 / D) ** 0.5),
            "W_up": _w((lambda *s: torch.randn(*s, dtype=torch.bfloat16) * 0.2)(D, F) * (2.0 / D) ** 0.5),
            "W_down": _w((lambda *s: torch.randn(*s, dtype=torch.bfloat16) * 0.2)(F, D) * (1.0 / F) ** 0.5),
        }
    _B_in = _B_setup()

    return {
        "A_x": _A_in["x"],
        "A_wqkv": _A_in["wqkv"],
        "A_w_phi": _A_in["w_phi"],
        "A_wo": _A_in["wo"],
        "B_x": _B_in["x"],
        "B_W_gate": _B_in["W_gate"],
        "B_W_up": _B_in["W_up"],
        "B_W_down": _B_in["W_down"],
    }

def reference(A_x, A_wqkv, A_w_phi, A_wo, B_x, B_W_gate, B_W_up, B_W_down):
    def _A_ref(x, wqkv, w_phi, wo):
        B, S, D = x.shape
        H = 32; Dh = D // H
        qkv = (lambda x, *d: x.permute(*d))((x @ wqkv).reshape(B, S, 3, H, Dh), 2, 0, 3, 1, 4)
        q, k, v = qkv[0], qkv[1], qkv[2]
        pq = torch.einsum("bhsd,hdf->bhsf", q, w_phi)
        pk = torch.einsum("bhsd,hdf->bhsf", k, w_phi)
        phi_q = torch.concatenate([_softmax(pq, axis=-1), _softmax(-pq, axis=-1)], axis=-1)
        phi_k = torch.concatenate([_softmax(pk, axis=-1), _softmax(-pk, axis=-1)], axis=-1)
        kv = torch.einsum("bhsf,bhsd->bhfd", phi_k, v)
        z  = torch.einsum("bhsf->bhf", phi_k)
        num = torch.einsum("bhqf,bhfd->bhqd", phi_q, kv)
        den = torch.einsum("bhqf,bhf->bhq", phi_q, z)[..., None] + 1e-6
        o = num / den
        return (lambda x, *d: x.permute(*d))(o, 0, 2, 1, 3).reshape(B, S, D) @ wo

    def _B_ref(x, W_gate, W_up, W_down):
        gate = torch.einsum("bsd,df->bsf", x, W_gate)
        up = torch.einsum("bsd,df->bsf", x, W_up)
        gate = gate * (lambda x, dt: x.to(dt))(gate > 0, gate.dtype)
        h = gate * up
        return torch.einsum("bsf,fd->bsd", h, W_down)

    x = A_x
    xn = _layernorm(x, axis=-1)
    s = _A_ref(xn, A_wqkv, A_w_phi, A_wo)
    g = _silu(_B_ref(xn, B_W_gate, B_W_up, B_W_down))
    return x + s * g
```

```asm
; @launch grid=(256,1,1) block=(512,1,1) lds=163840
.amdgcn_target "amdgcn-amd-amdhsa--gfx950"
.text
.globl recurrent_scan__linear_kernel_hedgehog__glu_gated_reglu__prompt_kernel
.p2align 8
.type recurrent_scan__linear_kernel_hedgehog__glu_gated_reglu__prompt_kernel,@function
recurrent_scan__linear_kernel_hedgehog__glu_gated_reglu__prompt_kernel:
    s_cmp_ge_u32 s2, 256
    s_cbranch_scc1 L_end
    s_load_dwordx16 s[64:79], s[0:1], 0
    s_load_dwordx4 s[80:83], s[0:1], 64
    s_load_dwordx2 s[84:85], s[0:1], 80
    v_lshrrev_b32 v2, 6, v0
    v_and_b32 v1, 63, v0
    v_readfirstlane_b32 s48, v2
    s_and_b32 s3, s2, 7
    s_lshr_b32 s4, s2, 3
    s_cmp_lg_u32 s48, 7
    s_cbranch_scc1 L_nocode
    s_getpc_b64 s[6:7]
L_pc:
    s_and_b32 s5, s4, 7
    s_lshl_b32 s5, s5, 13
    v_lshl_add_u32 v3, v1, 7, s5
    v_min_u32 v3, L_end-L_pc, v3
    global_load_dword v9, v3, s[6:7]
L_nocode:
    s_and_b32 s5, s3, 1
    s_lshl_b32 s5, s5, 3
    s_and_b32 s6, s4, 7
    s_add_u32 s49, s5, s6
    s_and_b32 s6, s48, 3
    s_lshl_b32 s6, s6, 15
    s_lshl_b32 s5, s49, 17
    s_add_u32 s5, s5, s6
    v_lshrrev_b32 v3, 4, v1
    v_and_b32 v4, 15, v1
    v_xor_b32 v4, v3, v4
    v_lshlrev_b32 v4, 4, v4
    v_lshl_add_u32 v10, v3, 10, v4
    v_xor_b32 v11, 64, v10
    v_xor_b32 v12, 128, v10
    v_xor_b32 v13, 192, v10
    s_waitcnt lgkmcnt(0)
    s_mov_b32 s8, s64
    s_mov_b32 s9, s65
    s_mov_b32 s10, 2097152
    s_mov_b32 s11, 0x00020000
    s_lshr_b32 s6, s6, 1
    s_mov_b32 s96, s5
    s_mov_b32 s97, s6
    s_cmp_ge_u32 s48, 4
    s_cbranch_scc1 L_nox
    s_add_u32 m0, s97, 0
    s_add_u32 s7, s96, 0
    buffer_load_dwordx4 v10, s[8:11], s7 offen lds
    s_add_u32 m0, s97, 1024
    s_add_u32 s7, s96, 4096
    buffer_load_dwordx4 v11, s[8:11], s7 offen lds
    s_add_u32 m0, s97, 2048
    s_add_u32 s7, s96, 8192
    buffer_load_dwordx4 v12, s[8:11], s7 offen lds
    s_add_u32 m0, s97, 3072
    s_add_u32 s7, s96, 12288
    buffer_load_dwordx4 v13, s[8:11], s7 offen lds
    s_add_u32 m0, s97, 4096
    s_add_u32 s7, s96, 256
    buffer_load_dwordx4 v10, s[8:11], s7 offen lds
    s_add_u32 m0, s97, 5120
    s_add_u32 s7, s96, 4352
    buffer_load_dwordx4 v11, s[8:11], s7 offen lds
    s_add_u32 m0, s97, 6144
    s_add_u32 s7, s96, 8448
    buffer_load_dwordx4 v12, s[8:11], s7 offen lds
    s_add_u32 m0, s97, 7168
    s_add_u32 s7, s96, 12544
    buffer_load_dwordx4 v13, s[8:11], s7 offen lds
L_nox:
    s_mov_b32 s28, s66
    s_mov_b32 s29, s67
    s_mov_b32 s30, 1572864
    s_mov_b32 s31, 0x00020000
    s_mov_b32 s32, s74
    s_mov_b32 s33, s75
    s_mov_b32 s34, 1835008
    s_mov_b32 s35, 0x00020000
    s_mov_b32 s36, s76
    s_mov_b32 s37, s77
    s_mov_b32 s38, 1835008
    s_mov_b32 s39, 0x00020000
    s_lshr_b32 s5, s4, 3
    s_lshr_b32 s51, s5, 1
    s_and_b32 s5, s5, 1
    s_and_b32 s6, s3, 6
    s_add_u32 s50, s6, s5
    s_lshr_b32 s5, s3, 1
    s_lshl_b32 s5, s5, 3
    s_and_b32 s6, s4, 7
    s_add_u32 s52, s5, s6
    s_and_b32 s5, s3, 1
    s_lshl_b32 s5, s5, 2
    s_lshr_b32 s6, s4, 3
    s_add_u32 s53, s5, s6
    s_mov_b32 s44, s68
    s_mov_b32 s45, s69
    s_mov_b32 s46, 16384
    s_mov_b32 s47, 0x00020000
    s_mov_b32 s16, s70
    s_mov_b32 s17, s71
    s_mov_b32 s18, 524288
    s_mov_b32 s19, 0x00020000
    s_mov_b32 s12, s78
    s_mov_b32 s13, s79
    s_mov_b32 s14, 1835008
    s_mov_b32 s15, 0x00020000
    s_mov_b32 s24, s80
    s_mov_b32 s25, s81
    s_mov_b32 s26, 2097152
    s_mov_b32 s27, 0x00020000
    s_mov_b32 s40, s82
    s_mov_b32 s41, s83
    s_mov_b32 s42, 256
    s_mov_b32 s43, 0x00020000
    s_mov_b32 s20, s84
    s_mov_b32 s21, s85
    s_mov_b32 s22, 12582912
    s_mov_b32 s23, 0x00020000
    s_and_b32 s71, s48, 3
    s_mul_i32 s6, s50, 160
    s_add_u32 s6, s6, 512
    s_and_b32 s7, s50, 1
    s_lshl_b32 s3, s7, 5
    s_add_u32 s3, s3, s6
    s_xor_b32 s7, s7, 1
    s_lshl_b32 s4, s7, 7
    s_add_u32 s4, s4, s6
    s_add_u32 s5, s3, 64
    s_lshl_b32 s6, s50, 6
    s_cmp_eq_u32 s51, 0
    s_cselect_b32 s5, s6, s5
    s_mov_b32 s6, 32
    s_cmp_eq_u32 s48, 1
    s_cselect_b32 s6, 52, s6
    s_cmp_eq_u32 s48, 2
    s_cselect_b32 s6, 72, s6
    s_cmp_eq_u32 s48, 3
    s_cselect_b32 s6, 92, s6
    s_cmp_eq_u32 s48, 4
    s_cselect_b32 s6, 0, s6
    s_cmp_eq_u32 s48, 5
    s_cselect_b32 s6, 16, s6
    s_cmp_eq_u32 s48, 6
    s_cselect_b32 s6, 112, s6
    s_cmp_eq_u32 s48, 7
    s_cselect_b32 s6, 128, s6
    s_add_u32 s81, s48, 4
    s_sub_u32 s7, s48, 2
    s_cmp_ge_u32 s48, 4
    s_cselect_b32 s81, s7, s81
    s_add_u32 s7, s48, 2
    s_cmp_ge_u32 s48, 6
    s_cselect_b32 s81, s7, s81
    s_cselect_b32 s7, 112, 0
    s_lshl_b32 s81, s81, 14
    s_sub_u32 s7, s6, s7
    s_lshl_b32 s80, s7, 14
    s_lshl_b32 s7, s53, 7
    s_add_u32 s80, s80, s7
    s_mul_i32 s82, s52, 288
    s_add_u32 s82, s82, s6
    s_lshl_b32 s82, s82, 10
    s_add_u32 s83, s82, 147456
    s_lshl_b32 s6, s52, 3
    s_add_u32 s6, s6, s48
    s_lshl_b32 s6, s6, 13
    s_add_u32 s84, s6, s7
    s_cmp_ge_u32 s48, 4
    s_cbranch_scc1 L_helper
    s_cmp_eq_u32 s51, 0
    s_cbranch_scc0 L_compY
    s_branch L_compX
L_compX:
    s_setprio 1
    v_lshlrev_b32 v242, 4, v1
    v_lshrrev_b32 v2, 4, v1
    s_add_u32 m0, s97, 8192
    s_add_u32 s66, s96, 512
    buffer_load_dwordx4 v10, s[8:11], s66 offen lds
    v_and_b32 v3, 15, v1
    v_bfe_u32 v4, v1, 2, 2
    v_lshl_add_u32 v4, v2, 3, v4
    s_add_u32 m0, s97, 9216
    s_add_u32 s66, s96, 4608
    buffer_load_dwordx4 v11, s[8:11], s66 offen lds
    v_and_b32 v5, 3, v1
    v_lshlrev_b32 v5, 3, v5
    v_bfe_u32 v6, v1, 3, 1
    s_add_u32 m0, s97, 10240
    s_add_u32 s66, s96, 8704
    buffer_load_dwordx4 v12, s[8:11], s66 offen lds
    v_and_b32 v7, 1, v2
    v_lshl_add_u32 v6, v6, 1, v7
    v_lshl_add_u32 v5, v6, 5, v5
    s_add_u32 m0, s97, 11264
    s_add_u32 s66, s96, 12800
    buffer_load_dwordx4 v13, s[8:11], s66 offen lds
    v_lshl_add_u32 v216, v4, 7, v5
    v_add_u32 v220, 0x20000, v216
    v_xor_b32 v217, 32, v216
    s_add_u32 m0, s97, 12288
    s_add_u32 s66, s96, 768
    buffer_load_dwordx4 v10, s[8:11], s66 offen lds
    v_xor_b32 v221, 32, v220
    v_xor_b32 v218, 64, v216
    v_xor_b32 v222, 64, v220
    s_add_u32 m0, s97, 13312
    s_add_u32 s66, s96, 4864
    buffer_load_dwordx4 v11, s[8:11], s66 offen lds
    v_xor_b32 v219, 96, v216
    v_xor_b32 v223, 96, v220
    v_xor_b32 v4, v2, v3
    s_add_u32 m0, s97, 14336
    s_add_u32 s66, s96, 8960
    buffer_load_dwordx4 v12, s[8:11], s66 offen lds
    v_lshlrev_b32 v4, 4, v4
    v_and_b32 v5, 3, v1
    v_lshl_add_u32 v4, v5, 8, v4
    s_add_u32 m0, s97, 15360
    s_add_u32 s66, s96, 13056
    buffer_load_dwordx4 v13, s[8:11], s66 offen lds
    v_bfe_u32 v5, v1, 2, 2
    v_lshl_add_u32 v4, v5, 10, v4
    s_lshl_b32 s6, s48, 14
    v_add_u32 v246, s6, v4
    v_xor_b32 v247, 64, v246
    v_xor_b32 v248, 128, v246
    v_xor_b32 v249, 192, v246
    s_lshl_b32 s6, s48, 10
    s_add_u32 s6, s6, 65536
    v_lshlrev_b32 v4, 3, v1
    v_add_u32 v243, s6, v4
    v_and_b32 v4, 1, v2
    v_lshrrev_b32 v6, 1, v2
    v_lshl_add_u32 v4, v4, 1, v6
    v_xor_b32 v4, v4, v5
    v_lshlrev_b32 v4, 3, v4
    v_lshl_add_u32 v4, v3, 5, v4
    v_add_u32 v244, s6, v4
    s_lshl_b32 s6, s49, 3
    s_add_u32 s6, s6, s50
    s_lshl_b32 s6, s6, 4
    s_add_u32 s6, s6, s48
    s_lshl_b32 s6, s6, 10
    s_add_u32 s72, s6, 9699328
    v_and_b32 v4, 1, v1
    v_lshlrev_b32 v4, 4, v4
    v_mov_b32 v6, 0x3f80
    v_lshlrev_b32 v6, v4, v6
    v_cmp_eq_u32 vcc, v5, v2
    s_nop 1
    v_cndmask_b32 v6, 0, v6, vcc
    v_bfe_u32 v4, v1, 1, 1
    v_cmp_eq_u32 vcc, 0, v4
    s_nop 1
    v_cndmask_b32 v224, 0, v6, vcc
    v_cndmask_b32 v225, v6, 0, vcc
    v_mov_b32 v226, 0
    v_mov_b32 v227, 0
    v_mov_b32 v228, 0
    v_mov_b32 v229, 0
    v_mov_b32 v230, v224
    v_mov_b32 v231, v225
    s_lshl_b32 s6, s49, 2
    s_add_u32 s6, s6, s48
    s_mul_i32 s6, s6, 147456
    s_lshl_b32 s7, s3, 6
    s_add_u32 s68, s6, s7
    s_lshl_b32 s7, s4, 6
    s_add_u32 s69, s6, s7
    s_lshl_b32 s7, s5, 6
    s_add_u32 s70, s6, s7
    s_mov_b32 s74, 0x3f803f80
    s_waitcnt vmcnt(12)
    ds_read_b128 v[0:3], v246 offset:0
    ds_read_b128 v[8:11], v247 offset:0
    ds_read_b128 v[16:19], v248 offset:0
    ds_read_b128 v[24:27], v249 offset:0
    s_waitcnt lgkmcnt(3)
    v_dot2_f32_bf16 v128, v0, s74, 0
    v_dot2_f32_bf16 v130, v0, v0, 0
    v_dot2_f32_bf16 v132, v1, s74, 0
    v_dot2_f32_bf16 v134, v1, v1, 0
    v_dot2_f32_bf16 v128, v2, s74, v128
    v_dot2_f32_bf16 v130, v2, v2, v130
    v_dot2_f32_bf16 v132, v3, s74, v132
    v_dot2_f32_bf16 v134, v3, v3, v134
    s_waitcnt lgkmcnt(2)
    v_dot2_f32_bf16 v128, v8, s74, v128
    v_dot2_f32_bf16 v130, v8, v8, v130
    v_dot2_f32_bf16 v132, v9, s74, v132
    v_dot2_f32_bf16 v134, v9, v9, v134
    v_dot2_f32_bf16 v128, v10, s74, v128
    v_dot2_f32_bf16 v130, v10, v10, v130
    v_dot2_f32_bf16 v132, v11, s74, v132
    v_dot2_f32_bf16 v134, v11, v11, v134
    s_waitcnt lgkmcnt(1)
    v_dot2_f32_bf16 v128, v16, s74, v128
    v_dot2_f32_bf16 v130, v16, v16, v130
    v_dot2_f32_bf16 v132, v17, s74, v132
    v_dot2_f32_bf16 v134, v17, v17, v134
    v_dot2_f32_bf16 v128, v18, s74, v128
    v_dot2_f32_bf16 v130, v18, v18, v130
    v_dot2_f32_bf16 v132, v19, s74, v132
    v_dot2_f32_bf16 v134, v19, v19, v134
    s_waitcnt lgkmcnt(0)
    v_dot2_f32_bf16 v128, v24, s74, v128
    v_dot2_f32_bf16 v130, v24, v24, v130
    v_dot2_f32_bf16 v132, v25, s74, v132
    v_dot2_f32_bf16 v134, v25, v25, v134
    v_dot2_f32_bf16 v128, v26, s74, v128
    v_dot2_f32_bf16 v130, v26, v26, v130
    v_dot2_f32_bf16 v132, v27, s74, v132
    v_dot2_f32_bf16 v134, v27, v27, v134
    s_waitcnt vmcnt(8)
    ds_read_b128 v[32:35], v246 offset:4096
    ds_read_b128 v[40:43], v247 offset:4096
    ds_read_b128 v[48:51], v248 offset:4096
    ds_read_b128 v[56:59], v249 offset:4096
    s_waitcnt lgkmcnt(3)
    v_dot2_f32_bf16 v128, v32, s74, v128
    v_dot2_f32_bf16 v130, v32, v32, v130
    v_dot2_f32_bf16 v132, v33, s74, v132
    v_dot2_f32_bf16 v134, v33, v33, v134
    v_dot2_f32_bf16 v128, v34, s74, v128
    v_dot2_f32_bf16 v130, v34, v34, v130
    v_dot2_f32_bf16 v132, v35, s74, v132
    v_dot2_f32_bf16 v134, v35, v35, v134
    s_waitcnt lgkmcnt(2)
    v_dot2_f32_bf16 v128, v40, s74, v128
    v_dot2_f32_bf16 v130, v40, v40, v130
    v_dot2_f32_bf16 v132, v41, s74, v132
    v_dot2_f32_bf16 v134, v41, v41, v134
    v_dot2_f32_bf16 v128, v42, s74, v128
    v_dot2_f32_bf16 v130, v42, v42, v130
    v_dot2_f32_bf16 v132, v43, s74, v132
    v_dot2_f32_bf16 v134, v43, v43, v134
    s_waitcnt lgkmcnt(1)
    v_dot2_f32_bf16 v128, v48, s74, v128
    v_dot2_f32_bf16 v130, v48, v48, v130
    v_dot2_f32_bf16 v132, v49, s74, v132
    v_dot2_f32_bf16 v134, v49, v49, v134
    v_dot2_f32_bf16 v128, v50, s74, v128
    v_dot2_f32_bf16 v130, v50, v50, v130
    v_dot2_f32_bf16 v132, v51, s74, v132
    v_dot2_f32_bf16 v134, v51, v51, v134
    s_waitcnt lgkmcnt(0)
    v_dot2_f32_bf16 v128, v56, s74, v128
    v_dot2_f32_bf16 v130, v56, v56, v130
    v_dot2_f32_bf16 v132, v57, s74, v132
    v_dot2_f32_bf16 v134, v57, v57, v134
    v_dot2_f32_bf16 v128, v58, s74, v128
    v_dot2_f32_bf16 v130, v58, v58, v130
    v_dot2_f32_bf16 v132, v59, s74, v132
    v_dot2_f32_bf16 v134, v59, v59, v134
    s_waitcnt vmcnt(4)
    ds_read_b128 v[64:67], v246 offset:8192
    ds_read_b128 v[72:75], v247 offset:8192
    ds_read_b128 v[80:83], v248 offset:8192
    ds_read_b128 v[88:91], v249 offset:8192
    s_waitcnt lgkmcnt(3)
    v_dot2_f32_bf16 v128, v64, s74, v128
    v_dot2_f32_bf16 v130, v64, v64, v130
    v_dot2_f32_bf16 v132, v65, s74, v132
    v_dot2_f32_bf16 v134, v65, v65, v134
    v_dot2_f32_bf16 v128, v66, s74, v128
    v_dot2_f32_bf16 v130, v66, v66, v130
    v_dot2_f32_bf16 v132, v67, s74, v132
    v_dot2_f32_bf16 v134, v67, v67, v134
    s_waitcnt lgkmcnt(2)
    v_dot2_f32_bf16 v128, v72, s74, v128
    v_dot2_f32_bf16 v130, v72, v72, v130
    v_dot2_f32_bf16 v132, v73, s74, v132
    v_dot2_f32_bf16 v134, v73, v73, v134
    v_dot2_f32_bf16 v128, v74, s74, v128
    v_dot2_f32_bf16 v130, v74, v74, v130
    v_dot2_f32_bf16 v132, v75, s74, v132
    v_dot2_f32_bf16 v134, v75, v75, v134
    s_waitcnt lgkmcnt(1)
    v_dot2_f32_bf16 v128, v80, s74, v128
    v_dot2_f32_bf16 v130, v80, v80, v130
    v_dot2_f32_bf16 v132, v81, s74, v132
    v_dot2_f32_bf16 v134, v81, v81, v134
    v_dot2_f32_bf16 v128, v82, s74, v128
    v_dot2_f32_bf16 v130, v82, v82, v130
    v_dot2_f32_bf16 v132, v83, s74, v132
    v_dot2_f32_bf16 v134, v83, v83, v134
    s_waitcnt lgkmcnt(0)
    v_dot2_f32_bf16 v128, v88, s74, v128
    v_dot2_f32_bf16 v130, v88, v88, v130
    v_dot2_f32_bf16 v132, v89, s74, v132
    v_dot2_f32_bf16 v134, v89, v89, v134
    v_dot2_f32_bf16 v128, v90, s74, v128
    v_dot2_f32_bf16 v130, v90, v90, v130
    v_dot2_f32_bf16 v132, v91, s74, v132
    v_dot2_f32_bf16 v134, v91, v91, v134
    s_waitcnt vmcnt(0)
    ds_read_b128 v[96:99], v246 offset:12288
    ds_read_b128 v[104:107], v247 offset:12288
    ds_read_b128 v[112:115], v248 offset:12288
    ds_read_b128 v[120:123], v249 offset:12288
    v_add_u32 v246, 0x10000, v246
    v_add_u32 v247, 0x10000, v247
    v_add_u32 v248, 0x10000, v248
    v_add_u32 v249, 0x10000, v249
    s_waitcnt lgkmcnt(3)
    v_dot2_f32_bf16 v128, v96, s74, v128
    v_dot2_f32_bf16 v130, v96, v96, v130
    v_dot2_f32_bf16 v132, v97, s74, v132
    v_dot2_f32_bf16 v134, v97, v97, v134
    v_dot2_f32_bf16 v128, v98, s74, v128
    v_dot2_f32_bf16 v130, v98, v98, v130
    v_dot2_f32_bf16 v132, v99, s74, v132
    v_dot2_f32_bf16 v134, v99, v99, v134
    s_waitcnt lgkmcnt(2)
    v_dot2_f32_bf16 v128, v104, s74, v128
    v_dot2_f32_bf16 v130, v104, v104, v130
    v_dot2_f32_bf16 v132, v105, s74, v132
    v_dot2_f32_bf16 v134, v105, v105, v134
    v_dot2_f32_bf16 v128, v106, s74, v128
    v_dot2_f32_bf16 v130, v106, v106, v130
    v_dot2_f32_bf16 v132, v107, s74, v132
    v_dot2_f32_bf16 v134, v107, v107, v134
    s_waitcnt lgkmcnt(1)
    v_dot2_f32_bf16 v128, v112, s74, v128
    v_dot2_f32_bf16 v130, v112, v112, v130
    v_dot2_f32_bf16 v132, v113, s74, v132
    v_dot2_f32_bf16 v134, v113, v113, v134
    v_dot2_f32_bf16 v128, v114, s74, v128
    v_dot2_f32_bf16 v130, v114, v114, v130
    v_dot2_f32_bf16 v132, v115, s74, v132
    v_dot2_f32_bf16 v134, v115, v115, v134
    s_waitcnt lgkmcnt(0)
    v_dot2_f32_bf16 v128, v120, s74, v128
    v_dot2_f32_bf16 v130, v120, v120, v130
    v_dot2_f32_bf16 v132, v121, s74, v132
    v_dot2_f32_bf16 v134, v121, v121, v134
    v_dot2_f32_bf16 v128, v122, s74, v128
    v_dot2_f32_bf16 v130, v122, v122, v130
    v_dot2_f32_bf16 v132, v123, s74, v132
    v_dot2_f32_bf16 v134, v123, v123, v134
    s_nop 1
    v_add_f32 v128, v128, v132
    v_add_f32 v130, v130, v134
    s_nop 1
    v_permlane32_swap_b32 v128, v130
    v_add_f32 v128, v128, v130
    v_mov_b32 v130, v128
    s_nop 1
    v_permlane16_swap_b32 v128, v130
    v_add_f32 v128, v128, v130
    v_mul_f32 v128, 0x3b000000, v128
    v_mov_b32 v130, v128
    s_nop 1
    v_permlane32_swap_b32 v128, v130
    v_cvt_pk_bf16_f32 v136, -v128, -v128
    v_and_b32 v136, 0xffff0000, v136
    v_mov_b32 v137, v136
    v_mov_b32 v138, v136
    v_mov_b32 v139, v136
    s_nop 1
    v_mfma_f32_16x16x32_bf16 v[144:147], v[224:227], v[0:3], v[136:139]
    v_mov_b32 v251, 0
    v_mfma_f32_16x16x32_bf16 v[148:151], v[228:231], v[0:3], v[136:139]
    v_fma_f32 v130, -v128, v128, v130
    v_mfma_f32_16x16x32_bf16 v[152:155], v[224:227], v[8:11], v[136:139]
    v_max_f32 v130, 0, v130
    v_mfma_f32_16x16x32_bf16 v[156:159], v[228:231], v[8:11], v[136:139]
    v_cvt_pk_bf16_f32 v130, v130, v130
    v_mfma_f32_16x16x32_bf16 v[160:163], v[224:227], v[16:19], v[136:139]
    v_cvt_pk_bf16_f32 v0, v144, v145
    v_cvt_pk_bf16_f32 v1, v146, v147
    v_and_b32 v130, 0xffff0000, v130
    v_mfma_f32_16x16x32_bf16 v[164:167], v[228:231], v[16:19], v[136:139]
    v_cvt_pk_bf16_f32 v2, v148, v149
    v_cvt_pk_bf16_f32 v3, v150, v151
    v_add_f32 v130, 0x3727c5ac, v130
    v_mfma_f32_16x16x32_bf16 v[168:171], v[224:227], v[24:27], v[136:139]
    v_cvt_pk_bf16_f32 v8, v152, v153
    v_cvt_pk_bf16_f32 v9, v154, v155
    v_cvt_pk_bf16_f32 v130, v130, v130
    v_mfma_f32_16x16x32_bf16 v[172:175], v[228:231], v[24:27], v[136:139]
    v_cvt_pk_bf16_f32 v10, v156, v157
    v_cvt_pk_bf16_f32 v11, v158, v159
    v_and_b32 v130, 0xffff0000, v130
    v_mfma_f32_16x16x32_bf16 v[176:179], v[224:227], v[32:35], v[136:139]
    v_cvt_pk_bf16_f32 v16, v160, v161
    v_cvt_pk_bf16_f32 v17, v162, v163
    v_sqrt_f32 v130, v130
    v_mfma_f32_16x16x32_bf16 v[180:183], v[228:231], v[32:35], v[136:139]
    v_cvt_pk_bf16_f32 v18, v164, v165
    v_cvt_pk_bf16_f32 v19, v166, v167
    v_lshrrev_b32 v250, 2, v242
    v_mfma_f32_16x16x32_bf16 v[144:147], v[224:227], v[40:43], v[136:139]
    v_cvt_pk_bf16_f32 v24, v168, v169
    v_cvt_pk_bf16_f32 v25, v170, v171
    v_and_b32 v250, 0x3c, v250
    v_mfma_f32_16x16x32_bf16 v[148:151], v[228:231], v[40:43], v[136:139]
    v_cvt_pk_bf16_f32 v26, v172, v173
    v_cvt_pk_bf16_f32 v27, v174, v175
    s_lshl_b32 s6, s48, 7
    v_mfma_f32_16x16x32_bf16 v[152:155], v[224:227], v[48:51], v[136:139]
    v_cvt_pk_bf16_f32 v32, v176, v177
    v_cvt_pk_bf16_f32 v33, v178, v179
    v_add_u32 v250, s6, v250
    v_mfma_f32_16x16x32_bf16 v[156:159], v[228:231], v[48:51], v[136:139]
    v_cvt_pk_bf16_f32 v34, v180, v181
    v_cvt_pk_bf16_f32 v35, v182, v183
    v_add_u32 v252, 130048, v250
    v_mfma_f32_16x16x32_bf16 v[160:163], v[224:227], v[56:59], v[136:139]
    v_cvt_pk_bf16_f32 v40, v144, v145
    v_cvt_pk_bf16_f32 v41, v146, v147
    v_lshlrev_b32 v253, 1, v250
    v_mfma_f32_16x16x32_bf16 v[164:167], v[228:231], v[56:59], v[136:139]
    v_cvt_pk_bf16_f32 v42, v148, v149
    v_cvt_pk_bf16_f32 v43, v150, v151
    v_add_u32 v253, 129024, v253
    v_mfma_f32_16x16x32_bf16 v[168:171], v[224:227], v[64:67], v[136:139]
    v_cvt_pk_bf16_f32 v48, v152, v153
    v_cvt_pk_bf16_f32 v49, v154, v155
    v_cvt_pk_bf16_f32 v234, v130, v130
    v_mfma_f32_16x16x32_bf16 v[172:175], v[228:231], v[64:67], v[136:139]
    v_cvt_pk_bf16_f32 v50, v156, v157
    v_cvt_pk_bf16_f32 v51, v158, v159
    v_mov_b32 v235, v234
    v_mfma_f32_16x16x32_bf16 v[176:179], v[224:227], v[72:75], v[136:139]
    v_cvt_pk_bf16_f32 v56, v160, v161
    v_cvt_pk_bf16_f32 v57, v162, v163
    v_and_b32 v130, 0xffff0000, v234
    v_mfma_f32_16x16x32_bf16 v[180:183], v[228:231], v[72:75], v[136:139]
    v_cvt_pk_bf16_f32 v58, v164, v165
    v_cvt_pk_bf16_f32 v59, v166, v167
    v_rcp_f32 v130, v130
    v_mfma_f32_16x16x32_bf16 v[144:147], v[224:227], v[80:83], v[136:139]
    v_cvt_pk_bf16_f32 v64, v168, v169
    v_cvt_pk_bf16_f32 v65, v170, v171
    s_nop 0
    v_mfma_f32_16x16x32_bf16 v[148:151], v[228:231], v[80:83], v[136:139]
    v_cvt_pk_bf16_f32 v66, v172, v173
    v_cvt_pk_bf16_f32 v67, v174, v175
    v_mul_f32 v240, 0x3fb8aa3b, v130
    v_mfma_f32_16x16x32_bf16 v[152:155], v[224:227], v[88:91], v[136:139]
    v_cvt_pk_bf16_f32 v72, v176, v177
    v_cvt_pk_bf16_f32 v73, v178, v179
    v_mul_f32 v254, v130, v130
    v_mfma_f32_16x16x32_bf16 v[156:159], v[228:231], v[88:91], v[136:139]
    v_cvt_pk_bf16_f32 v74, v180, v181
    v_cvt_pk_bf16_f32 v75, v182, v183
    v_mfma_f32_16x16x32_bf16 v[160:163], v[224:227], v[96:99], v[136:139]
    v_cvt_pk_bf16_f32 v80, v144, v145
    v_cvt_pk_bf16_f32 v81, v146, v147
    v_mfma_f32_16x16x32_bf16 v[164:167], v[228:231], v[96:99], v[136:139]
    v_cvt_pk_bf16_f32 v82, v148, v149
    v_cvt_pk_bf16_f32 v83, v150, v151
    v_mfma_f32_16x16x32_bf16 v[168:171], v[224:227], v[104:107], v[136:139]
    v_cvt_pk_bf16_f32 v88, v152, v153
    v_cvt_pk_bf16_f32 v89, v154, v155
    v_mfma_f32_16x16x32_bf16 v[172:175], v[228:231], v[104:107], v[136:139]
    v_cvt_pk_bf16_f32 v90, v156, v157
    v_cvt_pk_bf16_f32 v91, v158, v159
    v_mfma_f32_16x16x32_bf16 v[176:179], v[224:227], v[112:115], v[136:139]
    v_cvt_pk_bf16_f32 v96, v160, v161
    v_cvt_pk_bf16_f32 v97, v162, v163
    v_mfma_f32_16x16x32_bf16 v[180:183], v[228:231], v[112:115], v[136:139]
    v_cvt_pk_bf16_f32 v98, v164, v165
    v_cvt_pk_bf16_f32 v99, v166, v167
    v_mfma_f32_16x16x32_bf16 v[144:147], v[224:227], v[120:123], v[136:139]
    v_cvt_pk_bf16_f32 v104, v168, v169
    v_cvt_pk_bf16_f32 v105, v170, v171
    v_mfma_f32_16x16x32_bf16 v[148:151], v[228:231], v[120:123], v[136:139]
    v_cvt_pk_bf16_f32 v106, v172, v173
    v_cvt_pk_bf16_f32 v107, v174, v175
    v_cvt_pk_bf16_f32 v112, v176, v177
    v_cvt_pk_bf16_f32 v113, v178, v179
    v_cvt_pk_bf16_f32 v114, v180, v181
    v_cvt_pk_bf16_f32 v115, v182, v183
    s_barrier
    ds_read_b128 v[4:7], v246 offset:0
    ds_read_b128 v[12:15], v247 offset:0
    ds_read_b128 v[20:23], v248 offset:0
    ds_read_b128 v[28:31], v249 offset:0
    ds_read_b128 v[36:39], v246 offset:4096
    ds_read_b128 v[44:47], v247 offset:4096
    ds_read_b128 v[52:55], v248 offset:4096
    ds_read_b128 v[60:63], v249 offset:4096
    ds_read_b128 v[68:71], v246 offset:8192
    ds_read_b128 v[76:79], v247 offset:8192
    ds_read_b128 v[84:87], v248 offset:8192
    ds_read_b128 v[92:95], v249 offset:8192
    v_cvt_pk_bf16_f32 v120, v144, v145
    v_cvt_pk_bf16_f32 v121, v146, v147
    v_cvt_pk_bf16_f32 v122, v148, v149
    v_cvt_pk_bf16_f32 v123, v150, v151
    s_waitcnt lgkmcnt(11)
    v_dot2_f32_bf16 v129, v4, s74, 0
    v_dot2_f32_bf16 v131, v4, v4, 0
    v_dot2_f32_bf16 v133, v5, s74, 0
    v_dot2_f32_bf16 v135, v5, v5, 0
    v_dot2_f32_bf16 v129, v6, s74, v129
    v_dot2_f32_bf16 v131, v6, v6, v131
    v_dot2_f32_bf16 v133, v7, s74, v133
    v_dot2_f32_bf16 v135, v7, v7, v135
    s_waitcnt lgkmcnt(10)
    v_dot2_f32_bf16 v129, v12, s74, v129
    v_dot2_f32_bf16 v131, v12, v12, v131
    v_dot2_f32_bf16 v133, v13, s74, v133
    v_dot2_f32_bf16 v135, v13, v13, v135
    v_dot2_f32_bf16 v129, v14, s74, v129
    v_dot2_f32_bf16 v131, v14, v14, v131
    v_dot2_f32_bf16 v133, v15, s74, v133
    v_dot2_f32_bf16 v135, v15, v15, v135
    s_waitcnt lgkmcnt(9)
    v_dot2_f32_bf16 v129, v20, s74, v129
    v_dot2_f32_bf16 v131, v20, v20, v131
    v_dot2_f32_bf16 v133, v21, s74, v133
    v_dot2_f32_bf16 v135, v21, v21, v135
    v_dot2_f32_bf16 v129, v22, s74, v129
    v_dot2_f32_bf16 v131, v22, v22, v131
    v_dot2_f32_bf16 v133, v23, s74, v133
    v_dot2_f32_bf16 v135, v23, v23, v135
    s_waitcnt lgkmcnt(8)
    v_dot2_f32_bf16 v129, v28, s74, v129
    v_dot2_f32_bf16 v131, v28, v28, v131
    v_dot2_f32_bf16 v133, v29, s74, v133
    v_dot2_f32_bf16 v135, v29, v29, v135
    v_dot2_f32_bf16 v129, v30, s74, v129
    v_dot2_f32_bf16 v131, v30, v30, v131
    v_dot2_f32_bf16 v133, v31, s74, v133
    v_dot2_f32_bf16 v135, v31, v31, v135
    ds_read_b128 v[100:103], v246 offset:12288
    ds_read_b128 v[108:111], v247 offset:12288
    ds_read_b128 v[116:119], v248 offset:12288
    ds_read_b128 v[124:127], v249 offset:12288
    s_waitcnt lgkmcnt(11)
    v_dot2_f32_bf16 v129, v36, s74, v129
    v_dot2_f32_bf16 v131, v36, v36, v131
    v_dot2_f32_bf16 v133, v37, s74, v133
    v_dot2_f32_bf16 v135, v37, v37, v135
    v_dot2_f32_bf16 v129, v38, s74, v129
    v_dot2_f32_bf16 v131, v38, v38, v131
    v_dot2_f32_bf16 v133, v39, s74, v133
    v_dot2_f32_bf16 v135, v39, v39, v135
    s_waitcnt lgkmcnt(10)
    v_dot2_f32_bf16 v129, v44, s74, v129
    v_dot2_f32_bf16 v131, v44, v44, v131
    v_dot2_f32_bf16 v133, v45, s74, v133
    v_dot2_f32_bf16 v135, v45, v45, v135
    v_dot2_f32_bf16 v129, v46, s74, v129
    v_dot2_f32_bf16 v131, v46, v46, v131
    v_dot2_f32_bf16 v133, v47, s74, v133
    v_dot2_f32_bf16 v135, v47, v47, v135
    s_waitcnt lgkmcnt(9)
    v_dot2_f32_bf16 v129, v52, s74, v129
    v_dot2_f32_bf16 v131, v52, v52, v131
    v_dot2_f32_bf16 v133, v53, s74, v133
    v_dot2_f32_bf16 v135, v53, v53, v135
    v_dot2_f32_bf16 v129, v54, s74, v129
    v_dot2_f32_bf16 v131, v54, v54, v131
    v_dot2_f32_bf16 v133, v55, s74, v133
    v_dot2_f32_bf16 v135, v55, v55, v135
    s_waitcnt lgkmcnt(8)
    v_dot2_f32_bf16 v129, v60, s74, v129
    v_dot2_f32_bf16 v131, v60, v60, v131
    v_dot2_f32_bf16 v133, v61, s74, v133
    v_dot2_f32_bf16 v135, v61, v61, v135
    v_dot2_f32_bf16 v129, v62, s74, v129
    v_dot2_f32_bf16 v131, v62, v62, v131
    v_dot2_f32_bf16 v133, v63, s74, v133
    v_dot2_f32_bf16 v135, v63, v63, v135
    s_waitcnt lgkmcnt(7)
    v_dot2_f32_bf16 v129, v68, s74, v129
    v_dot2_f32_bf16 v131, v68, v68, v131
    v_dot2_f32_bf16 v133, v69, s74, v133
    v_dot2_f32_bf16 v135, v69, v69, v135
    v_dot2_f32_bf16 v129, v70, s74, v129
    v_dot2_f32_bf16 v131, v70, v70, v131
    v_dot2_f32_bf16 v133, v71, s74, v133
    v_dot2_f32_bf16 v135, v71, v71, v135
    s_waitcnt lgkmcnt(6)
    v_dot2_f32_bf16 v129, v76, s74, v129
    v_dot2_f32_bf16 v131, v76, v76, v131
    v_dot2_f32_bf16 v133, v77, s74, v133
    v_dot2_f32_bf16 v135, v77, v77, v135
    v_dot2_f32_bf16 v129, v78, s74, v129
    v_dot2_f32_bf16 v131, v78, v78, v131
    v_dot2_f32_bf16 v133, v79, s74, v133
    v_dot2_f32_bf16 v135, v79, v79, v135
    s_waitcnt lgkmcnt(5)
    v_dot2_f32_bf16 v129, v84, s74, v129
    v_dot2_f32_bf16 v131, v84, v84, v131
    v_dot2_f32_bf16 v133, v85, s74, v133
    v_dot2_f32_bf16 v135, v85, v85, v135
    v_dot2_f32_bf16 v129, v86, s74, v129
    v_dot2_f32_bf16 v131, v86, v86, v131
    v_dot2_f32_bf16 v133, v87, s74, v133
    v_dot2_f32_bf16 v135, v87, v87, v135
    s_waitcnt lgkmcnt(4)
    v_dot2_f32_bf16 v129, v92, s74, v129
    v_dot2_f32_bf16 v131, v92, v92, v131
    v_dot2_f32_bf16 v133, v93, s74, v133
    v_dot2_f32_bf16 v135, v93, v93, v135
    v_dot2_f32_bf16 v129, v94, s74, v129
    v_dot2_f32_bf16 v131, v94, v94, v131
    v_dot2_f32_bf16 v133, v95, s74, v133
    v_dot2_f32_bf16 v135, v95, v95, v135
    s_waitcnt lgkmcnt(3)
    v_dot2_f32_bf16 v129, v100, s74, v129
    v_dot2_f32_bf16 v131, v100, v100, v131
    v_dot2_f32_bf16 v133, v101, s74, v133
    v_dot2_f32_bf16 v135, v101, v101, v135
    v_dot2_f32_bf16 v129, v102, s74, v129
    v_dot2_f32_bf16 v131, v102, v102, v131
    v_dot2_f32_bf16 v133, v103, s74, v133
    v_dot2_f32_bf16 v135, v103, v103, v135
    s_waitcnt lgkmcnt(2)
    v_dot2_f32_bf16 v129, v108, s74, v129
    v_dot2_f32_bf16 v131, v108, v108, v131
    v_dot2_f32_bf16 v133, v109, s74, v133
    v_dot2_f32_bf16 v135, v109, v109, v135
    v_dot2_f32_bf16 v129, v110, s74, v129
    v_dot2_f32_bf16 v131, v110, v110, v131
    v_dot2_f32_bf16 v133, v111, s74, v133
    v_dot2_f32_bf16 v135, v111, v111, v135
    s_waitcnt lgkmcnt(1)
    v_dot2_f32_bf16 v129, v116, s74, v129
    v_dot2_f32_bf16 v131, v116, v116, v131
    v_dot2_f32_bf16 v133, v117, s74, v133
    v_dot2_f32_bf16 v135, v117, v117, v135
    v_dot2_f32_bf16 v129, v118, s74, v129
    v_dot2_f32_bf16 v131, v118, v118, v131
    v_dot2_f32_bf16 v133, v119, s74, v133
    v_dot2_f32_bf16 v135, v119, v119, v135
    s_waitcnt lgkmcnt(0)
    v_dot2_f32_bf16 v129, v124, s74, v129
    v_dot2_f32_bf16 v131, v124, v124, v131
    v_dot2_f32_bf16 v133, v125, s74, v133
    v_dot2_f32_bf16 v135, v125, v125, v135
    v_dot2_f32_bf16 v129, v126, s74, v129
    v_dot2_f32_bf16 v131, v126, v126, v131
    v_dot2_f32_bf16 v133, v127, s74, v133
    v_dot2_f32_bf16 v135, v127, v127, v135
    s_barrier
    s_nop 0
    v_add_f32 v129, v129, v133
    v_add_f32 v131, v131, v135
    s_nop 1
    v_permlane32_swap_b32 v129, v131
    v_add_f32 v129, v129, v131
    v_mov_b32 v131, v129
    s_nop 1
    v_permlane16_swap_b32 v129, v131
    v_add_f32 v129, v129, v131
    v_mul_f32 v129, 0x3b000000, v129
    v_mov_b32 v131, v129
    s_nop 1
    v_permlane32_swap_b32 v129, v131
    v_cvt_pk_bf16_f32 v140, -v129, -v129
    v_and_b32 v140, 0xffff0000, v140
    v_mov_b32 v141, v140
    v_mov_b32 v142, v140
    v_mov_b32 v143, v140
    s_nop 1
    v_mfma_f32_16x16x32_bf16 v[144:147], v[224:227], v[4:7], v[140:143]
    v_fma_f32 v131, -v129, v129, v131
    v_mfma_f32_16x16x32_bf16 v[148:151], v[228:231], v[4:7], v[140:143]
    v_max_f32 v131, 0, v131
    v_mfma_f32_16x16x32_bf16 v[152:155], v[224:227], v[12:15], v[140:143]
    v_cvt_pk_bf16_f32 v131, v131, v131
    v_mfma_f32_16x16x32_bf16 v[156:159], v[228:231], v[12:15], v[140:143]
    v_and_b32 v131, 0xffff0000, v131
    v_mfma_f32_16x16x32_bf16 v[160:163], v[224:227], v[20:23], v[140:143]
    v_cvt_pk_bf16_f32 v4, v144, v145
    v_cvt_pk_bf16_f32 v5, v146, v147
    v_add_f32 v131, 0x3727c5ac, v131
    v_mfma_f32_16x16x32_bf16 v[164:167], v[228:231], v[20:23], v[140:143]
    v_cvt_pk_bf16_f32 v6, v148, v149
    v_cvt_pk_bf16_f32 v7, v150, v151
    v_cvt_pk_bf16_f32 v131, v131, v131
    v_mfma_f32_16x16x32_bf16 v[168:171], v[224:227], v[28:31], v[140:143]
    v_cvt_pk_bf16_f32 v12, v152, v153
    v_cvt_pk_bf16_f32 v13, v154, v155
    v_and_b32 v131, 0xffff0000, v131
    v_mfma_f32_16x16x32_bf16 v[172:175], v[228:231], v[28:31], v[140:143]
    v_cvt_pk_bf16_f32 v14, v156, v157
    v_cvt_pk_bf16_f32 v15, v158, v159
    v_sqrt_f32 v131, v131
    v_mfma_f32_16x16x32_bf16 v[176:179], v[224:227], v[36:39], v[140:143]
    v_cvt_pk_bf16_f32 v20, v160, v161
    v_cvt_pk_bf16_f32 v21, v162, v163
    s_nop 0
    v_mfma_f32_16x16x32_bf16 v[180:183], v[228:231], v[36:39], v[140:143]
    v_cvt_pk_bf16_f32 v22, v164, v165
    v_cvt_pk_bf16_f32 v23, v166, v167
    v_cvt_pk_bf16_f32 v236, v131, v131
    v_mfma_f32_16x16x32_bf16 v[144:147], v[224:227], v[44:47], v[140:143]
    v_cvt_pk_bf16_f32 v28, v168, v169
    v_cvt_pk_bf16_f32 v29, v170, v171
    v_mov_b32 v237, v236
    v_mfma_f32_16x16x32_bf16 v[148:151], v[228:231], v[44:47], v[140:143]
    v_cvt_pk_bf16_f32 v30, v172, v173
    v_cvt_pk_bf16_f32 v31, v174, v175
    v_and_b32 v131, 0xffff0000, v236
    v_mfma_f32_16x16x32_bf16 v[152:155], v[224:227], v[52:55], v[140:143]
    v_cvt_pk_bf16_f32 v36, v176, v177
    v_cvt_pk_bf16_f32 v37, v178, v179
    v_rcp_f32 v131, v131
    v_mfma_f32_16x16x32_bf16 v[156:159], v[228:231], v[52:55], v[140:143]
    v_cvt_pk_bf16_f32 v38, v180, v181
    v_cvt_pk_bf16_f32 v39, v182, v183
    ds_write_b64 v253, v[234:235] offset:0
    v_mfma_f32_16x16x32_bf16 v[160:163], v[224:227], v[60:63], v[140:143]
    v_cvt_pk_bf16_f32 v44, v144, v145
    v_cvt_pk_bf16_f32 v45, v146, v147
    ds_write_b64 v253, v[236:237] offset:128
    v_mfma_f32_16x16x32_bf16 v[164:167], v[228:231], v[60:63], v[140:143]
    v_cvt_pk_bf16_f32 v46, v148, v149
    v_cvt_pk_bf16_f32 v47, v150, v151
    v_mul_f32 v241, 0x3fb8aa3b, v131
    v_mfma_f32_16x16x32_bf16 v[168:171], v[224:227], v[68:71], v[140:143]
    v_cvt_pk_bf16_f32 v52, v152, v153
    v_cvt_pk_bf16_f32 v53, v154, v155
    v_mul_f32 v255, v131, v131
    v_mfma_f32_16x16x32_bf16 v[172:175], v[228:231], v[68:71], v[140:143]
    v_cvt_pk_bf16_f32 v54, v156, v157
    v_cvt_pk_bf16_f32 v55, v158, v159
    ds_write_b32 v252, v130 offset:0
    v_mfma_f32_16x16x32_bf16 v[176:179], v[224:227], v[76:79], v[140:143]
    v_cvt_pk_bf16_f32 v60, v160, v161
    v_cvt_pk_bf16_f32 v61, v162, v163
    ds_write_b32 v252, v131 offset:64
    v_mfma_f32_16x16x32_bf16 v[180:183], v[228:231], v[76:79], v[140:143]
    v_cvt_pk_bf16_f32 v62, v164, v165
    v_cvt_pk_bf16_f32 v63, v166, v167
    v_mfma_f32_16x16x32_bf16 v[144:147], v[224:227], v[84:87], v[140:143]
    v_cvt_pk_bf16_f32 v68, v168, v169
    v_cvt_pk_bf16_f32 v69, v170, v171
    v_mfma_f32_16x16x32_bf16 v[148:151], v[228:231], v[84:87], v[140:143]
    v_cvt_pk_bf16_f32 v70, v172, v173
    v_cvt_pk_bf16_f32 v71, v174, v175
    v_mfma_f32_16x16x32_bf16 v[152:155], v[224:227], v[92:95], v[140:143]
    v_cvt_pk_bf16_f32 v76, v176, v177
    v_cvt_pk_bf16_f32 v77, v178, v179
    v_mfma_f32_16x16x32_bf16 v[156:159], v[228:231], v[92:95], v[140:143]
    v_cvt_pk_bf16_f32 v78, v180, v181
    v_cvt_pk_bf16_f32 v79, v182, v183
    v_mfma_f32_16x16x32_bf16 v[160:163], v[224:227], v[100:103], v[140:143]
    v_cvt_pk_bf16_f32 v84, v144, v145
    v_cvt_pk_bf16_f32 v85, v146, v147
    v_mfma_f32_16x16x32_bf16 v[164:167], v[228:231], v[100:103], v[140:143]
    v_cvt_pk_bf16_f32 v86, v148, v149
    v_cvt_pk_bf16_f32 v87, v150, v151
    s_waitcnt lgkmcnt(0)
    s_barrier
    v_mfma_f32_16x16x32_bf16 v[168:171], v[224:227], v[108:111], v[140:143]
    v_cvt_pk_bf16_f32 v92, v152, v153
    v_cvt_pk_bf16_f32 v93, v154, v155
    v_mfma_f32_16x16x32_bf16 v[172:175], v[228:231], v[108:111], v[140:143]
    v_cvt_pk_bf16_f32 v94, v156, v157
    v_cvt_pk_bf16_f32 v95, v158, v159
    v_mfma_f32_16x16x32_bf16 v[176:179], v[224:227], v[116:119], v[140:143]
    v_cvt_pk_bf16_f32 v100, v160, v161
    v_cvt_pk_bf16_f32 v101, v162, v163
    v_mfma_f32_16x16x32_bf16 v[180:183], v[228:231], v[116:119], v[140:143]
    v_cvt_pk_bf16_f32 v102, v164, v165
    v_cvt_pk_bf16_f32 v103, v166, v167
    ds_read_b64_tr_b16 v[192:193], v220 offset:0
    ds_read_b64_tr_b16 v[194:195], v220 offset:512
    ds_read_b64_tr_b16 v[196:197], v221 offset:0
    ds_read_b64_tr_b16 v[198:199], v221 offset:512
    ds_read_b64_tr_b16 v[200:201], v222 offset:0
    ds_read_b64_tr_b16 v[202:203], v222 offset:512
    ds_read_b64_tr_b16 v[204:205], v223 offset:0
    ds_read_b64_tr_b16 v[206:207], v223 offset:512
    ds_read_b64_tr_b16 v[208:209], v220 offset:4096
    ds_read_b64_tr_b16 v[210:211], v220 offset:4608
    v_mfma_f32_16x16x32_bf16 v[144:147], v[224:227], v[124:127], v[140:143]
    v_cvt_pk_bf16_f32 v108, v168, v169
    v_cvt_pk_bf16_f32 v109, v170, v171
    v_mfma_f32_16x16x32_bf16 v[148:151], v[228:231], v[124:127], v[140:143]
    v_cvt_pk_bf16_f32 v110, v172, v173
    v_cvt_pk_bf16_f32 v111, v174, v175
    v_cvt_pk_bf16_f32 v116, v176, v177
    v_cvt_pk_bf16_f32 v117, v178, v179
    v_cvt_pk_bf16_f32 v118, v180, v181
    v_cvt_pk_bf16_f32 v119, v182, v183
    v_cvt_pk_bf16_f32 v124, v144, v145
    v_cvt_pk_bf16_f32 v125, v146, v147
    v_cvt_pk_bf16_f32 v126, v148, v149
    v_cvt_pk_bf16_f32 v127, v150, v151
    s_waitcnt lgkmcnt(6)
    v_mfma_f32_16x16x32_bf16 v[128:131], v[192:195], v[0:3], 0
    v_mfma_f32_16x16x32_bf16 v[132:135], v[192:195], v[4:7], 0
    ds_read_b64_tr_b16 v[212:213], v221 offset:4096
    v_mfma_f32_16x16x32_bf16 v[136:139], v[196:199], v[0:3], 0
    ds_read_b64_tr_b16 v[214:215], v221 offset:4608
    v_mfma_f32_16x16x32_bf16 v[140:143], v[196:199], v[4:7], 0
    ds_read_b64_tr_b16 v[192:193], v222 offset:4096
    s_waitcnt lgkmcnt(5)
    v_mfma_f32_16x16x32_bf16 v[144:147], v[200:203], v[0:3], 0
    ds_read_b64_tr_b16 v[194:195], v222 offset:4608
    v_mfma_f32_16x16x32_bf16 v[148:151], v[200:203], v[4:7], 0
    ds_read_b64_tr_b16 v[196:197], v223 offset:4096
    v_mfma_f32_16x16x32_bf16 v[152:155], v[204:207], v[0:3], 0
    ds_read_b64_tr_b16 v[198:199], v223 offset:4608
    v_mfma_f32_16x16x32_bf16 v[156:159], v[204:207], v[4:7], 0
    ds_read_b64_tr_b16 v[200:201], v220 offset:8192
    s_waitcnt lgkmcnt(5)
    v_mfma_f32_16x16x32_bf16 v[128:131], v[208:211], v[8:11], v[128:131]
    ds_read_b64_tr_b16 v[202:203], v220 offset:8704
    v_mfma_f32_16x16x32_bf16 v[132:135], v[208:211], v[12:15], v[132:135]
    ds_read_b64_tr_b16 v[204:205], v221 offset:8192
    v_mfma_f32_16x16x32_bf16 v[136:139], v[212:215], v[8:11], v[136:139]
    ds_read_b64_tr_b16 v[206:207], v221 offset:8704
    v_mfma_f32_16x16x32_bf16 v[140:143], v[212:215], v[12:15], v[140:143]
    ds_read_b64_tr_b16 v[208:209], v222 offset:8192
    s_waitcnt lgkmcnt(5)
    v_mfma_f32_16x16x32_bf16 v[144:147], v[192:195], v[8:11], v[144:147]
    ds_read_b64_tr_b16 v[210:211], v222 offset:8704
    v_mfma_f32_16x16x32_bf16 v[148:151], v[192:195], v[12:15], v[148:151]
    ds_read_b64_tr_b16 v[212:213], v223 offset:8192
    v_mfma_f32_16x16x32_bf16 v[152:155], v[196:199], v[8:11], v[152:155]
    ds_read_b64_tr_b16 v[214:215], v223 offset:8704
    v_mfma_f32_16x16x32_bf16 v[156:159], v[196:199], v[12:15], v[156:159]
    ds_read_b64_tr_b16 v[192:193], v220 offset:12288
    s_waitcnt lgkmcnt(5)
    v_mfma_f32_16x16x32_bf16 v[128:131], v[200:203], v[16:19], v[128:131]
    ds_read_b64_tr_b16 v[194:195], v220 offset:12800
    v_mfma_f32_16x16x32_bf16 v[132:135], v[200:203], v[20:23], v[132:135]
    ds_read_b64_tr_b16 v[196:197], v221 offset:12288
    v_mfma_f32_16x16x32_bf16 v[136:139], v[204:207], v[16:19], v[136:139]
    ds_read_b64_tr_b16 v[198:199], v221 offset:12800
    v_mfma_f32_16x16x32_bf16 v[140:143], v[204:207], v[20:23], v[140:143]
    ds_read_b64_tr_b16 v[200:201], v222 offset:12288
    s_waitcnt lgkmcnt(5)
    v_mfma_f32_16x16x32_bf16 v[144:147], v[208:211], v[16:19], v[144:147]
    ds_read_b64_tr_b16 v[202:203], v222 offset:12800
    v_mfma_f32_16x16x32_bf16 v[148:151], v[208:211], v[20:23], v[148:151]
    ds_read_b64_tr_b16 v[204:205], v223 offset:12288
    v_mfma_f32_16x16x32_bf16 v[152:155], v[212:215], v[16:19], v[152:155]
    ds_read_b64_tr_b16 v[206:207], v223 offset:12800
    v_mfma_f32_16x16x32_bf16 v[156:159], v[212:215], v[20:23], v[156:159]
    ds_read_b64_tr_b16 v[208:209], v220 offset:16384
    s_waitcnt lgkmcnt(5)
    v_mfma_f32_16x16x32_bf16 v[128:131], v[192:195], v[24:27], v[128:131]
    ds_read_b64_tr_b16 v[210:211], v220 offset:16896
    v_mfma_f32_16x16x32_bf16 v[132:135], v[192:195], v[28:31], v[132:135]
    ds_read_b64_tr_b16 v[212:213], v221 offset:16384
    v_mfma_f32_16x16x32_bf16 v[136:139], v[196:199], v[24:27], v[136:139]
    ds_read_b64_tr_b16 v[214:215], v221 offset:16896
    v_mfma_f32_16x16x32_bf16 v[140:143], v[196:199], v[28:31], v[140:143]
    ds_read_b64_tr_b16 v[192:193], v222 offset:16384
    s_waitcnt lgkmcnt(5)
    v_mfma_f32_16x16x32_bf16 v[144:147], v[200:203], v[24:27], v[144:147]
    ds_read_b64_tr_b16 v[194:195], v222 offset:16896
    v_mfma_f32_16x16x32_bf16 v[148:151], v[200:203], v[28:31], v[148:151]
    ds_read_b64_tr_b16 v[196:197], v223 offset:16384
    v_mfma_f32_16x16x32_bf16 v[152:155], v[204:207], v[24:27], v[152:155]
    ds_read_b64_tr_b16 v[198:199], v223 offset:16896
    v_mfma_f32_16x16x32_bf16 v[156:159], v[204:207], v[28:31], v[156:159]
    ds_read_b64_tr_b16 v[200:201], v220 offset:20480
    s_waitcnt lgkmcnt(5)
    v_mfma_f32_16x16x32_bf16 v[128:131], v[208:211], v[32:35], v[128:131]
    ds_read_b64_tr_b16 v[202:203], v220 offset:20992
    v_mfma_f32_16x16x32_bf16 v[132:135], v[208:211], v[36:39], v[132:135]
    ds_read_b64_tr_b16 v[204:205], v221 offset:20480
    v_mfma_f32_16x16x32_bf16 v[136:139], v[212:215], v[32:35], v[136:139]
    ds_read_b64_tr_b16 v[206:207], v221 offset:20992
    v_mfma_f32_16x16x32_bf16 v[140:143], v[212:215], v[36:39], v[140:143]
    ds_read_b64_tr_b16 v[208:209], v222 offset:20480
    s_waitcnt lgkmcnt(5)
    v_mfma_f32_16x16x32_bf16 v[144:147], v[192:195], v[32:35], v[144:147]
    ds_read_b64_tr_b16 v[210:211], v222 offset:20992
    v_mfma_f32_16x16x32_bf16 v[148:151], v[192:195], v[36:39], v[148:151]
    ds_read_b64_tr_b16 v[212:213], v223 offset:20480
    v_mfma_f32_16x16x32_bf16 v[152:155], v[196:199], v[32:35], v[152:155]
    ds_read_b64_tr_b16 v[214:215], v223 offset:20992
    v_mfma_f32_16x16x32_bf16 v[156:159], v[196:199], v[36:39], v[156:159]
    ds_read_b64_tr_b16 v[192:193], v220 offset:24576
    s_waitcnt lgkmcnt(5)
    v_mfma_f32_16x16x32_bf16 v[128:131], v[200:203], v[40:43], v[128:131]
    ds_read_b64_tr_b16 v[194:195], v220 offset:25088
    v_mfma_f32_16x16x32_bf16 v[132:135], v[200:203], v[44:47], v[132:135]
    ds_read_b64_tr_b16 v[196:197], v221 offset:24576
    v_mfma_f32_16x16x32_bf16 v[136:139], v[204:207], v[40:43], v[136:139]
    ds_read_b64_tr_b16 v[198:199], v221 offset:25088
    v_mfma_f32_16x16x32_bf16 v[140:143], v[204:207], v[44:47], v[140:143]
    ds_read_b64_tr_b16 v[200:201], v222 offset:24576
    s_waitcnt lgkmcnt(5)
    v_mfma_f32_16x16x32_bf16 v[144:147], v[208:211], v[40:43], v[144:147]
    ds_read_b64_tr_b16 v[202:203], v222 offset:25088
    v_mfma_f32_16x16x32_bf16 v[148:151], v[208:211], v[44:47], v[148:151]
    ds_read_b64_tr_b16 v[204:205], v223 offset:24576
    v_mfma_f32_16x16x32_bf16 v[152:155], v[212:215], v[40:43], v[152:155]
    ds_read_b64_tr_b16 v[206:207], v223 offset:25088
    v_mfma_f32_16x16x32_bf16 v[156:159], v[212:215], v[44:47], v[156:159]
    ds_read_b64_tr_b16 v[208:209], v220 offset:28672
    s_waitcnt lgkmcnt(5)
    v_mfma_f32_16x16x32_bf16 v[128:131], v[192:195], v[48:51], v[128:131]
    ds_read_b64_tr_b16 v[210:211], v220 offset:29184
    v_mfma_f32_16x16x32_bf16 v[132:135], v[192:195], v[52:55], v[132:135]
    ds_read_b64_tr_b16 v[212:213], v221 offset:28672
    v_mfma_f32_16x16x32_bf16 v[136:139], v[196:199], v[48:51], v[136:139]
    ds_read_b64_tr_b16 v[214:215], v221 offset:29184
    v_mfma_f32_16x16x32_bf16 v[140:143], v[196:199], v[52:55], v[140:143]
    ds_read_b64_tr_b16 v[192:193], v222 offset:28672
    s_waitcnt lgkmcnt(5)
    v_mfma_f32_16x16x32_bf16 v[144:147], v[200:203], v[48:51], v[144:147]
    ds_read_b64_tr_b16 v[194:195], v222 offset:29184
    v_mfma_f32_16x16x32_bf16 v[148:151], v[200:203], v[52:55], v[148:151]
    ds_read_b64_tr_b16 v[196:197], v223 offset:28672
    v_mfma_f32_16x16x32_bf16 v[152:155], v[204:207], v[48:51], v[152:155]
    ds_read_b64_tr_b16 v[198:199], v223 offset:29184
    v_mfma_f32_16x16x32_bf16 v[156:159], v[204:207], v[52:55], v[156:159]
    s_waitcnt lgkmcnt(4)
    v_mfma_f32_16x16x32_bf16 v[128:131], v[208:211], v[56:59], v[128:131]
    v_mfma_f32_16x16x32_bf16 v[132:135], v[208:211], v[60:63], v[132:135]
    s_waitcnt lgkmcnt(0)
    s_barrier
    ds_read_b64_tr_b16 v[200:201], v216 offset:0
    ds_read_b64_tr_b16 v[202:203], v216 offset:512
    ds_read_b64_tr_b16 v[204:205], v217 offset:0
    ds_read_b64_tr_b16 v[206:207], v217 offset:512
    v_mfma_f32_16x16x32_bf16 v[136:139], v[212:215], v[56:59], v[136:139]
    v_mfma_f32_16x16x32_bf16 v[140:143], v[212:215], v[60:63], v[140:143]
    ds_read_b64_tr_b16 v[208:209], v218 offset:0
    v_mfma_f32_16x16x32_bf16 v[144:147], v[192:195], v[56:59], v[144:147]
    ds_read_b64_tr_b16 v[210:211], v218 offset:512
    v_mfma_f32_16x16x32_bf16 v[148:151], v[192:195], v[60:63], v[148:151]
    ds_read_b64_tr_b16 v[212:213], v219 offset:0
    v_mfma_f32_16x16x32_bf16 v[152:155], v[196:199], v[56:59], v[152:155]
    ds_read_b64_tr_b16 v[214:215], v219 offset:512
    v_mfma_f32_16x16x32_bf16 v[156:159], v[196:199], v[60:63], v[156:159]
    ds_read_b64_tr_b16 v[192:193], v216 offset:4096
    s_waitcnt lgkmcnt(5)
    v_mfma_f32_16x16x32_bf16 v[128:131], v[200:203], v[64:67], v[128:131]
    ds_read_b64_tr_b16 v[194:195], v216 offset:4608
    v_mfma_f32_16x16x32_bf16 v[132:135], v[200:203], v[68:71], v[132:135]
    ds_read_b64_tr_b16 v[196:197], v217 offset:4096
    v_mfma_f32_16x16x32_bf16 v[136:139], v[204:207], v[64:67], v[136:139]
    ds_read_b64_tr_b16 v[198:199], v217 offset:4608
    v_mfma_f32_16x16x32_bf16 v[140:143], v[204:207], v[68:71], v[140:143]
    ds_read_b64_tr_b16 v[200:201], v218 offset:4096
    s_waitcnt lgkmcnt(5)
    v_mfma_f32_16x16x32_bf16 v[144:147], v[208:211], v[64:67], v[144:147]
    ds_read_b64_tr_b16 v[202:203], v218 offset:4608
    v_mfma_f32_16x16x32_bf16 v[148:151], v[208:211], v[68:71], v[148:151]
    ds_read_b64_tr_b16 v[204:205], v219 offset:4096
    v_mfma_f32_16x16x32_bf16 v[152:155], v[212:215], v[64:67], v[152:155]
    ds_read_b64_tr_b16 v[206:207], v219 offset:4608
    v_mfma_f32_16x16x32_bf16 v[156:159], v[212:215], v[68:71], v[156:159]
    ds_read_b64_tr_b16 v[208:209], v216 offset:8192
    buffer_load_dword v248, v251, s[40:43], 0 offen sc1
    s_waitcnt lgkmcnt(5)
    v_mfma_f32_16x16x32_bf16 v[128:131], v[192:195], v[72:75], v[128:131]
    ds_read_b64_tr_b16 v[210:211], v216 offset:8704
    v_mfma_f32_16x16x32_bf16 v[132:135], v[192:195], v[76:79], v[132:135]
    ds_read_b64_tr_b16 v[212:213], v217 offset:8192
    s_lshl_b32 s6, s49, 2
    v_mfma_f32_16x16x32_bf16 v[136:139], v[196:199], v[72:75], v[136:139]
    ds_read_b64_tr_b16 v[214:215], v217 offset:8704
    v_mfma_f32_16x16x32_bf16 v[140:143], v[196:199], v[76:79], v[140:143]
    ds_read_b64_tr_b16 v[192:193], v218 offset:8192
    s_add_u32 s6, s6, s48
    s_waitcnt lgkmcnt(5)
    v_mfma_f32_16x16x32_bf16 v[144:147], v[200:203], v[72:75], v[144:147]
    ds_read_b64_tr_b16 v[194:195], v218 offset:8704
    v_mfma_f32_16x16x32_bf16 v[148:151], v[200:203], v[76:79], v[148:151]
    ds_read_b64_tr_b16 v[196:197], v219 offset:8192
    s_lshl_b32 s6, s6, 5
    v_mfma_f32_16x16x32_bf16 v[152:155], v[204:207], v[72:75], v[152:155]
    ds_read_b64_tr_b16 v[198:199], v219 offset:8704
    v_mfma_f32_16x16x32_bf16 v[156:159], v[204:207], v[76:79], v[156:159]
    ds_read_b64_tr_b16 v[200:201], v216 offset:12288
    s_add_u32 s6, s6, s50
    s_waitcnt lgkmcnt(5)
    v_mfma_f32_16x16x32_bf16 v[128:131], v[208:211], v[80:83], v[128:131]
    ds_read_b64_tr_b16 v[202:203], v216 offset:12800
    v_mfma_f32_16x16x32_bf16 v[132:135], v[208:211], v[84:87], v[132:135]
    ds_read_b64_tr_b16 v[204:205], v217 offset:12288
    s_lshl_b32 s6, s6, 2
    v_mfma_f32_16x16x32_bf16 v[136:139], v[212:215], v[80:83], v[136:139]
    ds_read_b64_tr_b16 v[206:207], v217 offset:12800
    v_mfma_f32_16x16x32_bf16 v[140:143], v[212:215], v[84:87], v[140:143]
    ds_read_b64_tr_b16 v[208:209], v218 offset:12288
    s_add_u32 s6, s6, 11800576
    s_waitcnt lgkmcnt(5)
    v_mfma_f32_16x16x32_bf16 v[144:147], v[192:195], v[80:83], v[144:147]
    ds_read_b64_tr_b16 v[210:211], v218 offset:12800
    v_mfma_f32_16x16x32_bf16 v[148:151], v[192:195], v[84:87], v[148:151]
    ds_read_b64_tr_b16 v[212:213], v219 offset:12288
    v_mov_b32 v252, s6
    v_mfma_f32_16x16x32_bf16 v[152:155], v[196:199], v[80:83], v[152:155]
    ds_read_b64_tr_b16 v[214:215], v219 offset:12800
    v_mfma_f32_16x16x32_bf16 v[156:159], v[196:199], v[84:87], v[156:159]
    ds_read_b64_tr_b16 v[192:193], v216 offset:16384
    s_lshl_b32 s6, s49, 3
    s_waitcnt lgkmcnt(5)
    v_mfma_f32_16x16x32_bf16 v[128:131], v[200:203], v[88:91], v[128:131]
    ds_read_b64_tr_b16 v[194:195], v216 offset:16896
    v_mfma_f32_16x16x32_bf16 v[132:135], v[200:203], v[92:95], v[132:135]
    ds_read_b64_tr_b16 v[196:197], v217 offset:16384
    s_add_u32 s6, s6, s50
    v_mfma_f32_16x16x32_bf16 v[136:139], v[204:207], v[88:91], v[136:139]
    ds_read_b64_tr_b16 v[198:199], v217 offset:16896
    v_mfma_f32_16x16x32_bf16 v[140:143], v[204:207], v[92:95], v[140:143]
    ds_read_b64_tr_b16 v[200:201], v218 offset:16384
    s_lshl_b32 s6, s6, 5
    s_waitcnt lgkmcnt(5)
    v_mfma_f32_16x16x32_bf16 v[144:147], v[208:211], v[88:91], v[144:147]
    ds_read_b64_tr_b16 v[202:203], v218 offset:16896
    v_mfma_f32_16x16x32_bf16 v[148:151], v[208:211], v[92:95], v[148:151]
    ds_read_b64_tr_b16 v[204:205], v219 offset:16384
    s_add_u32 s6, s6, s48
    v_mfma_f32_16x16x32_bf16 v[152:155], v[212:215], v[88:91], v[152:155]
    ds_read_b64_tr_b16 v[206:207], v219 offset:16896
    v_mfma_f32_16x16x32_bf16 v[156:159], v[212:215], v[92:95], v[156:159]
    ds_read_b64_tr_b16 v[208:209], v216 offset:20480
    s_lshl_b32 s6, s6, 2
    s_waitcnt lgkmcnt(5)
    v_mfma_f32_16x16x32_bf16 v[128:131], v[192:195], v[96:99], v[128:131]
    ds_read_b64_tr_b16 v[210:211], v216 offset:20992
    v_mfma_f32_16x16x32_bf16 v[132:135], v[192:195], v[100:103], v[132:135]
    ds_read_b64_tr_b16 v[212:213], v217 offset:20480
    s_add_u32 s6, s6, 11821056
    v_mfma_f32_16x16x32_bf16 v[136:139], v[196:199], v[96:99], v[136:139]
    ds_read_b64_tr_b16 v[214:215], v217 offset:20992
    v_mfma_f32_16x16x32_bf16 v[140:143], v[196:199], v[100:103], v[140:143]
    ds_read_b64_tr_b16 v[192:193], v218 offset:20480
    v_mov_b32 v253, s6
    s_waitcnt lgkmcnt(5)
    v_mfma_f32_16x16x32_bf16 v[144:147], v[200:203], v[96:99], v[144:147]
    ds_read_b64_tr_b16 v[194:195], v218 offset:20992
    v_mfma_f32_16x16x32_bf16 v[148:151], v[200:203], v[100:103], v[148:151]
    ds_read_b64_tr_b16 v[196:197], v219 offset:20480
    v_mfma_f32_16x16x32_bf16 v[152:155], v[204:207], v[96:99], v[152:155]
    ds_read_b64_tr_b16 v[198:199], v219 offset:20992
    v_mfma_f32_16x16x32_bf16 v[156:159], v[204:207], v[100:103], v[156:159]
    ds_read_b64_tr_b16 v[200:201], v216 offset:24576
    s_waitcnt lgkmcnt(5)
    v_mfma_f32_16x16x32_bf16 v[128:131], v[208:211], v[104:107], v[128:131]
    ds_read_b64_tr_b16 v[202:203], v216 offset:25088
    v_mfma_f32_16x16x32_bf16 v[132:135], v[208:211], v[108:111], v[132:135]
    ds_read_b64_tr_b16 v[204:205], v217 offset:24576
    v_mfma_f32_16x16x32_bf16 v[136:139], v[212:215], v[104:107], v[136:139]
    ds_read_b64_tr_b16 v[206:207], v217 offset:25088
    v_mfma_f32_16x16x32_bf16 v[140:143], v[212:215], v[108:111], v[140:143]
    ds_read_b64_tr_b16 v[208:209], v218 offset:24576
    s_waitcnt lgkmcnt(5)
    v_mfma_f32_16x16x32_bf16 v[144:147], v[192:195], v[104:107], v[144:147]
    ds_read_b64_tr_b16 v[210:211], v218 offset:25088
    v_mfma_f32_16x16x32_bf16 v[148:151], v[192:195], v[108:111], v[148:151]
    ds_read_b64_tr_b16 v[212:213], v219 offset:24576
    v_mfma_f32_16x16x32_bf16 v[152:155], v[196:199], v[104:107], v[152:155]
    ds_read_b64_tr_b16 v[214:215], v219 offset:25088
    v_mfma_f32_16x16x32_bf16 v[156:159], v[196:199], v[108:111], v[156:159]
    ds_read_b64_tr_b16 v[192:193], v216 offset:28672
    s_waitcnt lgkmcnt(5)
    v_mfma_f32_16x16x32_bf16 v[128:131], v[200:203], v[112:115], v[128:131]
    ds_read_b64_tr_b16 v[194:195], v216 offset:29184
    v_mfma_f32_16x16x32_bf16 v[132:135], v[200:203], v[116:119], v[132:135]
    ds_read_b64_tr_b16 v[196:197], v217 offset:28672
    v_mfma_f32_16x16x32_bf16 v[136:139], v[204:207], v[112:115], v[136:139]
    ds_read_b64_tr_b16 v[198:199], v217 offset:29184
    v_mfma_f32_16x16x32_bf16 v[140:143], v[204:207], v[116:119], v[140:143]
    ds_read_b64_tr_b16 v[200:201], v218 offset:28672
    s_waitcnt lgkmcnt(5)
    v_mfma_f32_16x16x32_bf16 v[144:147], v[208:211], v[112:115], v[144:147]
    ds_read_b64_tr_b16 v[202:203], v218 offset:29184
    v_mfma_f32_16x16x32_bf16 v[148:151], v[208:211], v[116:119], v[148:151]
    ds_read_b64_tr_b16 v[204:205], v219 offset:28672
    v_mfma_f32_16x16x32_bf16 v[152:155], v[212:215], v[112:115], v[152:155]
    ds_read_b64_tr_b16 v[206:207], v219 offset:29184
    v_mfma_f32_16x16x32_bf16 v[156:159], v[212:215], v[116:119], v[156:159]
    s_waitcnt lgkmcnt(4)
    v_mfma_f32_16x16x32_bf16 v[128:131], v[192:195], v[120:123], v[128:131]
    v_mfma_f32_16x16x32_bf16 v[132:135], v[192:195], v[124:127], v[132:135]
    s_waitcnt lgkmcnt(0)
    s_barrier
    ds_read_b64_tr_b16 v[208:209], v216 offset:32768
    ds_read_b64_tr_b16 v[210:211], v216 offset:33280
    ds_read_b64_tr_b16 v[212:213], v217 offset:32768
    ds_read_b64_tr_b16 v[214:215], v217 offset:33280
    v_mfma_f32_16x16x32_bf16 v[136:139], v[196:199], v[120:123], v[136:139]
    v_mfma_f32_16x16x32_bf16 v[140:143], v[196:199], v[124:127], v[140:143]
    ds_read_b64_tr_b16 v[192:193], v218 offset:32768
    v_mfma_f32_16x16x32_bf16 v[144:147], v[200:203], v[120:123], v[144:147]
    ds_read_b64_tr_b16 v[194:195], v218 offset:33280
    v_mfma_f32_16x16x32_bf16 v[148:151], v[200:203], v[124:127], v[148:151]
    ds_read_b64_tr_b16 v[196:197], v219 offset:32768
    v_mfma_f32_16x16x32_bf16 v[152:155], v[204:207], v[120:123], v[152:155]
    ds_read_b64_tr_b16 v[198:199], v219 offset:33280
    v_mfma_f32_16x16x32_bf16 v[156:159], v[204:207], v[124:127], v[156:159]
    ds_read_b64_tr_b16 v[200:201], v216 offset:36864
    s_waitcnt lgkmcnt(5)
    v_mfma_f32_16x16x32_bf16 v[160:163], v[208:211], v[0:3], 0
    ds_read_b64_tr_b16 v[202:203], v216 offset:37376
    v_mfma_f32_16x16x32_bf16 v[164:167], v[208:211], v[4:7], 0
    ds_read_b64_tr_b16 v[204:205], v217 offset:36864
    v_mfma_f32_16x16x32_bf16 v[168:171], v[212:215], v[0:3], 0
    ds_read_b64_tr_b16 v[206:207], v217 offset:37376
    v_mul_f32 v128, v128, v240
    v_mul_f32 v129, v129, v240
    v_mfma_f32_16x16x32_bf16 v[172:175], v[212:215], v[4:7], 0
    ds_read_b64_tr_b16 v[208:209], v218 offset:36864
    v_mul_f32 v130, v130, v240
    v_mul_f32 v131, v131, v240
    s_waitcnt lgkmcnt(5)
    v_mfma_f32_16x16x32_bf16 v[176:179], v[192:195], v[0:3], 0
    ds_read_b64_tr_b16 v[210:211], v218 offset:37376
    v_cvt_pk_bf16_f32 v224, v128, v129
    v_cvt_pk_bf16_f32 v225, v130, v131
    v_mfma_f32_16x16x32_bf16 v[180:183], v[192:195], v[4:7], 0
    ds_read_b64_tr_b16 v[212:213], v219 offset:36864
    v_mul_f32 v132, v132, v241
    v_mul_f32 v133, v133, v241
    v_mfma_f32_16x16x32_bf16 v[184:187], v[196:199], v[0:3], 0
    ds_read_b64_tr_b16 v[214:215], v219 offset:37376
    v_mul_f32 v134, v134, v241
    v_mul_f32 v135, v135, v241
    v_mfma_f32_16x16x32_bf16 v[188:191], v[196:199], v[4:7], 0
    ds_read_b64_tr_b16 v[192:193], v216 offset:40960
    v_cvt_pk_bf16_f32 v226, v132, v133
    v_cvt_pk_bf16_f32 v227, v134, v135
    s_waitcnt lgkmcnt(5)
    v_mfma_f32_16x16x32_bf16 v[160:163], v[200:203], v[8:11], v[160:163]
    ds_read_b64_tr_b16 v[194:195], v216 offset:41472
    v_mul_f32 v136, v136, v240
    v_mul_f32 v137, v137, v240
    v_mfma_f32_16x16x32_bf16 v[164:167], v[200:203], v[12:15], v[164:167]
    ds_read_b64_tr_b16 v[196:197], v217 offset:40960
    v_mul_f32 v138, v138, v240
    v_mul_f32 v139, v139, v240
    v_mfma_f32_16x16x32_bf16 v[168:171], v[204:207], v[8:11], v[168:171]
    ds_read_b64_tr_b16 v[198:199], v217 offset:41472
    v_cvt_pk_bf16_f32 v228, v136, v137
    v_cvt_pk_bf16_f32 v229, v138, v139
    v_mfma_f32_16x16x32_bf16 v[172:175], v[204:207], v[12:15], v[172:175]
    ds_read_b64_tr_b16 v[200:201], v218 offset:40960
    v_permlane16_swap_b32 v224, v226
    v_permlane16_swap_b32 v225, v227
    s_waitcnt lgkmcnt(5)
    v_mfma_f32_16x16x32_bf16 v[176:179], v[208:211], v[8:11], v[176:179]
    ds_read_b64_tr_b16 v[202:203], v218 offset:41472
    ds_write_b64 v243, v[224:225] offset:0
    v_mfma_f32_16x16x32_bf16 v[180:183], v[208:211], v[12:15], v[180:183]
    ds_read_b64_tr_b16 v[204:205], v219 offset:40960
    ds_write_b64 v243, v[226:227] offset:512
    v_mul_f32 v140, v140, v241
    v_mfma_f32_16x16x32_bf16 v[184:187], v[212:215], v[8:11], v[184:187]
    ds_read_b64_tr_b16 v[206:207], v219 offset:41472
    v_mul_f32 v141, v141, v241
    v_mul_f32 v142, v142, v241
    v_mfma_f32_16x16x32_bf16 v[188:191], v[212:215], v[12:15], v[188:191]
    ds_read_b64_tr_b16 v[208:209], v216 offset:45056
    v_mul_f32 v143, v143, v241
    v_cvt_pk_bf16_f32 v230, v140, v141
    s_waitcnt lgkmcnt(7)
    v_mfma_f32_16x16x32_bf16 v[160:163], v[192:195], v[16:19], v[160:163]
    ds_read_b64_tr_b16 v[210:211], v216 offset:45568
    v_cvt_pk_bf16_f32 v231, v142, v143
    v_mul_f32 v144, v144, v240
    v_mfma_f32_16x16x32_bf16 v[164:167], v[192:195], v[20:23], v[164:167]
    ds_read_b64_tr_b16 v[212:213], v217 offset:45056
    v_mul_f32 v145, v145, v240
    v_mul_f32 v146, v146, v240
    v_mfma_f32_16x16x32_bf16 v[168:171], v[196:199], v[16:19], v[168:171]
    ds_read_b64_tr_b16 v[214:215], v217 offset:45568
    v_mul_f32 v147, v147, v240
    v_cvt_pk_bf16_f32 v232, v144, v145
    v_mfma_f32_16x16x32_bf16 v[172:175], v[196:199], v[20:23], v[172:175]
    ds_read_b64_tr_b16 v[192:193], v218 offset:45056
    v_cvt_pk_bf16_f32 v233, v146, v147
    v_permlane16_swap_b32 v228, v230
    s_waitcnt lgkmcnt(5)
    v_mfma_f32_16x16x32_bf16 v[176:179], v[200:203], v[16:19], v[176:179]
    ds_read_b64_tr_b16 v[194:195], v218 offset:45568
    v_permlane16_swap_b32 v229, v231
    ds_write_b64 v243, v[228:229] offset:4096
    v_mfma_f32_16x16x32_bf16 v[180:183], v[200:203], v[20:23], v[180:183]
    ds_read_b64_tr_b16 v[196:197], v219 offset:45056
    ds_write_b64 v243, v[230:231] offset:4608
    v_mul_f32 v148, v148, v241
    v_mfma_f32_16x16x32_bf16 v[184:187], v[204:207], v[16:19], v[184:187]
    ds_read_b64_tr_b16 v[198:199], v219 offset:45568
    v_mul_f32 v149, v149, v241
    v_mul_f32 v150, v150, v241
    v_mfma_f32_16x16x32_bf16 v[188:191], v[204:207], v[20:23], v[188:191]
    ds_read_b64_tr_b16 v[200:201], v216 offset:49152
    v_mul_f32 v151, v151, v241
    v_cvt_pk_bf16_f32 v234, v148, v149
    s_waitcnt lgkmcnt(7)
    v_mfma_f32_16x16x32_bf16 v[160:163], v[208:211], v[24:27], v[160:163]
    ds_read_b64_tr_b16 v[202:203], v216 offset:49664
    v_cvt_pk_bf16_f32 v235, v150, v151
    v_mul_f32 v152, v152, v240
    v_mfma_f32_16x16x32_bf16 v[164:167], v[208:211], v[28:31], v[164:167]
    ds_read_b64_tr_b16 v[204:205], v217 offset:49152
    v_mul_f32 v153, v153, v240
    v_mul_f32 v154, v154, v240
    v_mfma_f32_16x16x32_bf16 v[168:171], v[212:215], v[24:27], v[168:171]
    ds_read_b64_tr_b16 v[206:207], v217 offset:49664
    v_mul_f32 v155, v155, v240
    v_cvt_pk_bf16_f32 v236, v152, v153
    v_mfma_f32_16x16x32_bf16 v[172:175], v[212:215], v[28:31], v[172:175]
    ds_read_b64_tr_b16 v[208:209], v218 offset:49152
    v_cvt_pk_bf16_f32 v237, v154, v155
    v_permlane16_swap_b32 v232, v234
    s_waitcnt lgkmcnt(5)
    v_mfma_f32_16x16x32_bf16 v[176:179], v[192:195], v[24:27], v[176:179]
    ds_read_b64_tr_b16 v[210:211], v218 offset:49664
    v_permlane16_swap_b32 v233, v235
    ds_write_b64 v243, v[232:233] offset:8192
    v_mfma_f32_16x16x32_bf16 v[180:183], v[192:195], v[28:31], v[180:183]
    ds_read_b64_tr_b16 v[212:213], v219 offset:49152
    ds_write_b64 v243, v[234:235] offset:8704
    v_mul_f32 v156, v156, v241
    v_mfma_f32_16x16x32_bf16 v[184:187], v[196:199], v[24:27], v[184:187]
    ds_read_b64_tr_b16 v[214:215], v219 offset:49664
    v_mul_f32 v157, v157, v241
    v_mfma_f32_16x16x32_bf16 v[188:191], v[196:199], v[28:31], v[188:191]
    ds_read_b64_tr_b16 v[192:193], v216 offset:53248
    v_mul_f32 v158, v158, v241
    v_mul_f32 v159, v159, v241
    s_waitcnt lgkmcnt(7)
    v_mfma_f32_16x16x32_bf16 v[160:163], v[200:203], v[32:35], v[160:163]
    ds_read_b64_tr_b16 v[194:195], v216 offset:53760
    v_cvt_pk_bf16_f32 v238, v156, v157
    v_mfma_f32_16x16x32_bf16 v[164:167], v[200:203], v[36:39], v[164:167]
    ds_read_b64_tr_b16 v[196:197], v217 offset:53248
    v_cvt_pk_bf16_f32 v239, v158, v159
    v_permlane16_swap_b32 v236, v238
    v_mfma_f32_16x16x32_bf16 v[168:171], v[204:207], v[32:35], v[168:171]
    ds_read_b64_tr_b16 v[198:199], v217 offset:53760
    v_permlane16_swap_b32 v237, v239
    v_mfma_f32_16x16x32_bf16 v[172:175], v[204:207], v[36:39], v[172:175]
    ds_read_b64_tr_b16 v[200:201], v218 offset:53248
    ds_write_b64 v243, v[236:237] offset:12288
    ds_write_b64 v243, v[238:239] offset:12800
    s_waitcnt lgkmcnt(7)
    v_mfma_f32_16x16x32_bf16 v[176:179], v[208:211], v[32:35], v[176:179]
    ds_read_b64_tr_b16 v[202:203], v218 offset:53760
    v_mfma_f32_16x16x32_bf16 v[180:183], v[208:211], v[36:39], v[180:183]
    ds_read_b64_tr_b16 v[204:205], v219 offset:53248
    v_mfma_f32_16x16x32_bf16 v[184:187], v[212:215], v[32:35], v[184:187]
    ds_read_b64_tr_b16 v[206:207], v219 offset:53760
    v_mfma_f32_16x16x32_bf16 v[188:191], v[212:215], v[36:39], v[188:191]
    s_waitcnt lgkmcnt(3)
    s_barrier
    ds_read_b64_tr_b16 v[208:209], v216 offset:57344
    v_mfma_f32_16x16x32_bf16 v[160:163], v[192:195], v[40:43], v[160:163]
    ds_read_b64_tr_b16 v[210:211], v216 offset:57856
    v_mfma_f32_16x16x32_bf16 v[164:167], v[192:195], v[44:47], v[164:167]
    ds_read_b64_tr_b16 v[212:213], v217 offset:57344
    v_mfma_f32_16x16x32_bf16 v[168:171], v[196:199], v[40:43], v[168:171]
    ds_read_b64_tr_b16 v[214:215], v217 offset:57856
    v_mfma_f32_16x16x32_bf16 v[172:175], v[196:199], v[44:47], v[172:175]
    ds_read_b64_tr_b16 v[192:193], v218 offset:57344
    s_waitcnt lgkmcnt(5)
    v_mfma_f32_16x16x32_bf16 v[176:179], v[200:203], v[40:43], v[176:179]
    ds_read_b64_tr_b16 v[194:195], v218 offset:57856
    v_mfma_f32_16x16x32_bf16 v[180:183], v[200:203], v[44:47], v[180:183]
    ds_read_b64_tr_b16 v[196:197], v219 offset:57344
    v_mfma_f32_16x16x32_bf16 v[184:187], v[204:207], v[40:43], v[184:187]
    ds_read_b64_tr_b16 v[198:199], v219 offset:57856
    v_mfma_f32_16x16x32_bf16 v[188:191], v[204:207], v[44:47], v[188:191]
    ds_read_b64_tr_b16 v[200:201], v216 offset:61440
    s_waitcnt lgkmcnt(5)
    v_mfma_f32_16x16x32_bf16 v[160:163], v[208:211], v[48:51], v[160:163]
    ds_read_b64_tr_b16 v[202:203], v216 offset:61952
    v_mfma_f32_16x16x32_bf16 v[164:167], v[208:211], v[52:55], v[164:167]
    ds_read_b64_tr_b16 v[204:205], v217 offset:61440
    v_mfma_f32_16x16x32_bf16 v[168:171], v[212:215], v[48:51], v[168:171]
    ds_read_b64_tr_b16 v[206:207], v217 offset:61952
    v_mfma_f32_16x16x32_bf16 v[172:175], v[212:215], v[52:55], v[172:175]
    ds_read_b64_tr_b16 v[208:209], v218 offset:61440
    s_waitcnt lgkmcnt(5)
    v_mfma_f32_16x16x32_bf16 v[176:179], v[192:195], v[48:51], v[176:179]
    ds_read_b64_tr_b16 v[210:211], v218 offset:61952
    v_mfma_f32_16x16x32_bf16 v[180:183], v[192:195], v[52:55], v[180:183]
    ds_read_b64_tr_b16 v[212:213], v219 offset:61440
    v_mfma_f32_16x16x32_bf16 v[184:187], v[196:199], v[48:51], v[184:187]
    ds_read_b64_tr_b16 v[214:215], v219 offset:61952
    v_mfma_f32_16x16x32_bf16 v[188:191], v[196:199], v[52:55], v[188:191]
    s_waitcnt lgkmcnt(4)
    v_mfma_f32_16x16x32_bf16 v[160:163], v[200:203], v[56:59], v[160:163]
    v_mfma_f32_16x16x32_bf16 v[164:167], v[200:203], v[60:63], v[164:167]
    s_waitcnt lgkmcnt(0)
    s_barrier
    ds_read_b64_tr_b16 v[192:193], v220 offset:0
    ds_read_b64_tr_b16 v[194:195], v220 offset:512
    ds_read_b64_tr_b16 v[196:197], v221 offset:0
    ds_read_b64_tr_b16 v[198:199], v221 offset:512
    v_mfma_f32_16x16x32_bf16 v[168:171], v[204:207], v[56:59], v[168:171]
    v_mfma_f32_16x16x32_bf16 v[172:175], v[204:207], v[60:63], v[172:175]
    ds_read_b64_tr_b16 v[200:201], v222 offset:0
    v_mfma_f32_16x16x32_bf16 v[176:179], v[208:211], v[56:59], v[176:179]
    ds_read_b64_tr_b16 v[202:203], v222 offset:512
    v_mfma_f32_16x16x32_bf16 v[180:183], v[208:211], v[60:63], v[180:183]
    ds_read_b64_tr_b16 v[204:205], v223 offset:0
    v_mfma_f32_16x16x32_bf16 v[184:187], v[212:215], v[56:59], v[184:187]
    ds_read_b64_tr_b16 v[206:207], v223 offset:512
    v_mfma_f32_16x16x32_bf16 v[188:191], v[212:215], v[60:63], v[188:191]
    ds_read_b64_tr_b16 v[208:209], v220 offset:4096
    s_waitcnt lgkmcnt(5)
    v_mfma_f32_16x16x32_bf16 v[160:163], v[192:195], v[64:67], v[160:163]
    ds_read_b64_tr_b16 v[210:211], v220 offset:4608
    v_mfma_f32_16x16x32_bf16 v[164:167], v[192:195], v[68:71], v[164:167]
    ds_read_b64_tr_b16 v[212:213], v221 offset:4096
    v_mfma_f32_16x16x32_bf16 v[168:171], v[196:199], v[64:67], v[168:171]
    ds_read_b64_tr_b16 v[214:215], v221 offset:4608
    v_mfma_f32_16x16x32_bf16 v[172:175], v[196:199], v[68:71], v[172:175]
    ds_read_b64_tr_b16 v[192:193], v222 offset:4096
    s_waitcnt lgkmcnt(5)
    v_mfma_f32_16x16x32_bf16 v[176:179], v[200:203], v[64:67], v[176:179]
    ds_read_b64_tr_b16 v[194:195], v222 offset:4608
    v_mfma_f32_16x16x32_bf16 v[180:183], v[200:203], v[68:71], v[180:183]
    ds_read_b64_tr_b16 v[196:197], v223 offset:4096
    v_mfma_f32_16x16x32_bf16 v[184:187], v[204:207], v[64:67], v[184:187]
    ds_read_b64_tr_b16 v[198:199], v223 offset:4608
    v_mfma_f32_16x16x32_bf16 v[188:191], v[204:207], v[68:71], v[188:191]
    ds_read_b64_tr_b16 v[200:201], v220 offset:8192
    s_waitcnt lgkmcnt(5)
    v_mfma_f32_16x16x32_bf16 v[160:163], v[208:211], v[72:75], v[160:163]
    ds_read_b64_tr_b16 v[202:203], v220 offset:8704
    v_mfma_f32_16x16x32_bf16 v[164:167], v[208:211], v[76:79], v[164:167]
    ds_read_b64_tr_b16 v[204:205], v221 offset:8192
    s_waitcnt vmcnt(0)
    v_cmp_eq_u32 vcc, 0, v248
    s_nop 0
    s_cbranch_vccz L_nonXc_x
    s_mov_b32 s75, 0
L_nonXc:
    buffer_load_dword v248, v251, s[40:43], 0 offen sc1
    s_waitcnt vmcnt(0)
    s_add_u32 s75, s75, 1
    s_cmp_gt_u32 s75, 1048576
    s_cbranch_scc1 L_nonXc_x
    v_cmp_eq_u32 vcc, 0, v248
    s_nop 0
    s_cbranch_vccnz L_nonXc
L_nonXc_x:
    v_mfma_f32_16x16x32_bf16 v[168:171], v[212:215], v[72:75], v[168:171]
    ds_read_b64_tr_b16 v[206:207], v221 offset:8704
    v_mfma_f32_16x16x32_bf16 v[172:175], v[212:215], v[76:79], v[172:175]
    ds_read_b64_tr_b16 v[208:209], v222 offset:8192
    s_waitcnt lgkmcnt(5)
    v_mfma_f32_16x16x32_bf16 v[176:179], v[192:195], v[72:75], v[176:179]
    ds_read_b64_tr_b16 v[210:211], v222 offset:8704
    v_mfma_f32_16x16x32_bf16 v[180:183], v[192:195], v[76:79], v[180:183]
    ds_read_b64_tr_b16 v[212:213], v223 offset:8192
    v_mfma_f32_16x16x32_bf16 v[184:187], v[196:199], v[72:75], v[184:187]
    ds_read_b64_tr_b16 v[214:215], v223 offset:8704
    v_mfma_f32_16x16x32_bf16 v[188:191], v[196:199], v[76:79], v[188:191]
    ds_read_b64_tr_b16 v[192:193], v220 offset:12288
    s_waitcnt lgkmcnt(5)
    v_mfma_f32_16x16x32_bf16 v[160:163], v[200:203], v[80:83], v[160:163]
    ds_read_b64_tr_b16 v[194:195], v220 offset:12800
    v_mfma_f32_16x16x32_bf16 v[164:167], v[200:203], v[84:87], v[164:167]
    ds_read_b64_tr_b16 v[196:197], v221 offset:12288
    v_mfma_f32_16x16x32_bf16 v[168:171], v[204:207], v[80:83], v[168:171]
    ds_read_b64_tr_b16 v[198:199], v221 offset:12800
    v_mfma_f32_16x16x32_bf16 v[172:175], v[204:207], v[84:87], v[172:175]
    ds_read_b64_tr_b16 v[200:201], v222 offset:12288
    s_waitcnt lgkmcnt(5)
    v_mfma_f32_16x16x32_bf16 v[176:179], v[208:211], v[80:83], v[176:179]
    ds_read_b64_tr_b16 v[202:203], v222 offset:12800
    v_mfma_f32_16x16x32_bf16 v[180:183], v[208:211], v[84:87], v[180:183]
    ds_read_b64_tr_b16 v[204:205], v223 offset:12288
    v_mfma_f32_16x16x32_bf16 v[184:187], v[212:215], v[80:83], v[184:187]
    ds_read_b64_tr_b16 v[206:207], v223 offset:12800
    v_mfma_f32_16x16x32_bf16 v[188:191], v[212:215], v[84:87], v[188:191]
    ds_read_b64_tr_b16 v[208:209], v220 offset:16384
    s_waitcnt lgkmcnt(5)
    v_mfma_f32_16x16x32_bf16 v[160:163], v[192:195], v[88:91], v[160:163]
    ds_read_b64_tr_b16 v[210:211], v220 offset:16896
    v_mfma_f32_16x16x32_bf16 v[164:167], v[192:195], v[92:95], v[164:167]
    ds_read_b64_tr_b16 v[212:213], v221 offset:16384
    v_mfma_f32_16x16x32_bf16 v[168:171], v[196:199], v[88:91], v[168:171]
    ds_read_b64_tr_b16 v[214:215], v221 offset:16896
    v_mfma_f32_16x16x32_bf16 v[172:175], v[196:199], v[92:95], v[172:175]
    ds_read_b64_tr_b16 v[192:193], v222 offset:16384
    s_waitcnt lgkmcnt(5)
    v_mfma_f32_16x16x32_bf16 v[176:179], v[200:203], v[88:91], v[176:179]
    ds_read_b64_tr_b16 v[194:195], v222 offset:16896
    v_mfma_f32_16x16x32_bf16 v[180:183], v[200:203], v[92:95], v[180:183]
    ds_read_b64_tr_b16 v[196:197], v223 offset:16384
    v_mfma_f32_16x16x32_bf16 v[184:187], v[204:207], v[88:91], v[184:187]
    ds_read_b64_tr_b16 v[198:199], v223 offset:16896
    v_mfma_f32_16x16x32_bf16 v[188:191], v[204:207], v[92:95], v[188:191]
    ds_read_b64_tr_b16 v[200:201], v220 offset:20480
    s_waitcnt lgkmcnt(5)
    v_mfma_f32_16x16x32_bf16 v[160:163], v[208:211], v[96:99], v[160:163]
    ds_read_b64_tr_b16 v[202:203], v220 offset:20992
    v_mfma_f32_16x16x32_bf16 v[164:167], v[208:211], v[100:103], v[164:167]
    ds_read_b64_tr_b16 v[204:205], v221 offset:20480
    v_mfma_f32_16x16x32_bf16 v[168:171], v[212:215], v[96:99], v[168:171]
    ds_read_b64_tr_b16 v[206:207], v221 offset:20992
    v_mfma_f32_16x16x32_bf16 v[172:175], v[212:215], v[100:103], v[172:175]
    ds_read_b64_tr_b16 v[208:209], v222 offset:20480
    s_waitcnt lgkmcnt(5)
    v_mfma_f32_16x16x32_bf16 v[176:179], v[192:195], v[96:99], v[176:179]
    ds_read_b64_tr_b16 v[210:211], v222 offset:20992
    v_mfma_f32_16x16x32_bf16 v[180:183], v[192:195], v[100:103], v[180:183]
    ds_read_b64_tr_b16 v[212:213], v223 offset:20480
    v_mfma_f32_16x16x32_bf16 v[184:187], v[196:199], v[96:99], v[184:187]
    ds_read_b64_tr_b16 v[214:215], v223 offset:20992
    v_mfma_f32_16x16x32_bf16 v[188:191], v[196:199], v[100:103], v[188:191]
    ds_read_b64_tr_b16 v[192:193], v220 offset:24576
    s_waitcnt lgkmcnt(5)
    v_mfma_f32_16x16x32_bf16 v[160:163], v[200:203], v[104:107], v[160:163]
    ds_read_b64_tr_b16 v[194:195], v220 offset:25088
    v_mfma_f32_16x16x32_bf16 v[164:167], v[200:203], v[108:111], v[164:167]
    ds_read_b64_tr_b16 v[196:197], v221 offset:24576
    v_mfma_f32_16x16x32_bf16 v[168:171], v[204:207], v[104:107], v[168:171]
    ds_read_b64_tr_b16 v[198:199], v221 offset:25088
    v_mfma_f32_16x16x32_bf16 v[172:175], v[204:207], v[108:111], v[172:175]
    ds_read_b64_tr_b16 v[200:201], v222 offset:24576
    s_waitcnt lgkmcnt(5)
    v_mfma_f32_16x16x32_bf16 v[176:179], v[208:211], v[104:107], v[176:179]
    ds_read_b64_tr_b16 v[202:203], v222 offset:25088
    v_mfma_f32_16x16x32_bf16 v[180:183], v[208:211], v[108:111], v[180:183]
    ds_read_b64_tr_b16 v[204:205], v223 offset:24576
    v_mfma_f32_16x16x32_bf16 v[184:187], v[212:215], v[104:107], v[184:187]
    ds_read_b64_tr_b16 v[206:207], v223 offset:25088
    v_mfma_f32_16x16x32_bf16 v[188:191], v[212:215], v[108:111], v[188:191]
    ds_read_b64_tr_b16 v[208:209], v220 offset:28672
    s_waitcnt lgkmcnt(5)
    v_mfma_f32_16x16x32_bf16 v[160:163], v[192:195], v[112:115], v[160:163]
    ds_read_b64_tr_b16 v[210:211], v220 offset:29184
    v_mfma_f32_16x16x32_bf16 v[164:167], v[192:195], v[116:119], v[164:167]
    ds_read_b64_tr_b16 v[212:213], v221 offset:28672
    v_mfma_f32_16x16x32_bf16 v[168:171], v[196:199], v[112:115], v[168:171]
    ds_read_b64_tr_b16 v[214:215], v221 offset:29184
    v_mfma_f32_16x16x32_bf16 v[172:175], v[196:199], v[116:119], v[172:175]
    ds_read_b64_tr_b16 v[192:193], v222 offset:28672
    s_waitcnt lgkmcnt(5)
    v_mfma_f32_16x16x32_bf16 v[176:179], v[200:203], v[112:115], v[176:179]
    ds_read_b64_tr_b16 v[194:195], v222 offset:29184
    v_mfma_f32_16x16x32_bf16 v[180:183], v[200:203], v[116:119], v[180:183]
    ds_read_b64_tr_b16 v[196:197], v223 offset:28672
    v_mfma_f32_16x16x32_bf16 v[184:187], v[204:207], v[112:115], v[184:187]
    ds_read_b64_tr_b16 v[198:199], v223 offset:29184
    v_mfma_f32_16x16x32_bf16 v[188:191], v[204:207], v[116:119], v[188:191]
    s_waitcnt lgkmcnt(4)
    v_mfma_f32_16x16x32_bf16 v[160:163], v[208:211], v[120:123], v[160:163]
    v_mfma_f32_16x16x32_bf16 v[164:167], v[208:211], v[124:127], v[164:167]
    s_waitcnt lgkmcnt(0)
    s_barrier
    ds_read_b64_tr_b16 v[200:201], v216 offset:0
    ds_read_b64_tr_b16 v[202:203], v216 offset:512
    ds_read_b64_tr_b16 v[204:205], v217 offset:0
    ds_read_b64_tr_b16 v[206:207], v217 offset:512
    v_mfma_f32_16x16x32_bf16 v[168:171], v[212:215], v[120:123], v[168:171]
    v_mfma_f32_16x16x32_bf16 v[172:175], v[212:215], v[124:127], v[172:175]
    ds_read_b64_tr_b16 v[208:209], v218 offset:0
    v_mfma_f32_16x16x32_bf16 v[176:179], v[192:195], v[120:123], v[176:179]
    ds_read_b64_tr_b16 v[210:211], v218 offset:512
    v_mfma_f32_16x16x32_bf16 v[180:183], v[192:195], v[124:127], v[180:183]
    ds_read_b64_tr_b16 v[212:213], v219 offset:0
    v_mfma_f32_16x16x32_bf16 v[184:187], v[196:199], v[120:123], v[184:187]
    ds_read_b64_tr_b16 v[214:215], v219 offset:512
    v_mfma_f32_16x16x32_bf16 v[188:191], v[196:199], v[124:127], v[188:191]
    ds_read_b64_tr_b16 v[192:193], v216 offset:4096
    s_waitcnt lgkmcnt(5)
    v_mfma_f32_16x16x32_bf16 v[128:131], v[200:203], v[0:3], 0
    ds_read_b64_tr_b16 v[194:195], v216 offset:4608
    v_mfma_f32_16x16x32_bf16 v[132:135], v[200:203], v[4:7], 0
    ds_read_b64_tr_b16 v[196:197], v217 offset:4096
    v_mfma_f32_16x16x32_bf16 v[136:139], v[204:207], v[0:3], 0
    ds_read_b64_tr_b16 v[198:199], v217 offset:4608
    v_cvt_pk_bf16_f32 v224, v160, v161
    v_mfma_f32_16x16x32_bf16 v[140:143], v[204:207], v[4:7], 0
    ds_read_b64_tr_b16 v[200:201], v218 offset:4096
    v_cvt_pk_bf16_f32 v225, v162, v163
    s_waitcnt lgkmcnt(5)
    v_mfma_f32_16x16x32_bf16 v[144:147], v[208:211], v[0:3], 0
    ds_read_b64_tr_b16 v[202:203], v218 offset:4608
    ds_write_b64 v244, v[224:225] offset:0
    v_mfma_f32_16x16x32_bf16 v[148:151], v[208:211], v[4:7], 0
    ds_read_b64_tr_b16 v[204:205], v219 offset:4096
    v_cvt_pk_bf16_f32 v226, v164, v165
    v_mfma_f32_16x16x32_bf16 v[152:155], v[212:215], v[0:3], 0
    ds_read_b64_tr_b16 v[206:207], v219 offset:4608
    v_cvt_pk_bf16_f32 v227, v166, v167
    v_mfma_f32_16x16x32_bf16 v[156:159], v[212:215], v[4:7], 0
    ds_read_b64_tr_b16 v[208:209], v216 offset:8192
    ds_write_b64 v244, v[226:227] offset:512
    s_waitcnt lgkmcnt(7)
    v_mfma_f32_16x16x32_bf16 v[128:131], v[192:195], v[8:11], v[128:131]
    ds_read_b64_tr_b16 v[210:211], v216 offset:8704
    v_cvt_pk_bf16_f32 v228, v168, v169
    v_mfma_f32_16x16x32_bf16 v[132:135], v[192:195], v[12:15], v[132:135]
    ds_read_b64_tr_b16 v[212:213], v217 offset:8192
    v_cvt_pk_bf16_f32 v229, v170, v171
    v_mfma_f32_16x16x32_bf16 v[136:139], v[196:199], v[8:11], v[136:139]
    ds_read_b64_tr_b16 v[214:215], v217 offset:8704
    ds_write_b64 v244, v[228:229] offset:4096
    v_mfma_f32_16x16x32_bf16 v[140:143], v[196:199], v[12:15], v[140:143]
    ds_read_b64_tr_b16 v[192:193], v218 offset:8192
    v_cvt_pk_bf16_f32 v230, v172, v173
    s_waitcnt lgkmcnt(7)
    v_mfma_f32_16x16x32_bf16 v[144:147], v[200:203], v[8:11], v[144:147]
    ds_read_b64_tr_b16 v[194:195], v218 offset:8704
    v_cvt_pk_bf16_f32 v231, v174, v175
    v_mfma_f32_16x16x32_bf16 v[148:151], v[200:203], v[12:15], v[148:151]
    ds_read_b64_tr_b16 v[196:197], v219 offset:8192
    ds_write_b64 v244, v[230:231] offset:4608
    v_mfma_f32_16x16x32_bf16 v[152:155], v[204:207], v[8:11], v[152:155]
    ds_read_b64_tr_b16 v[198:199], v219 offset:8704
    v_cvt_pk_bf16_f32 v232, v176, v177
    v_mfma_f32_16x16x32_bf16 v[156:159], v[204:207], v[12:15], v[156:159]
    ds_read_b64_tr_b16 v[200:201], v216 offset:12288
    v_cvt_pk_bf16_f32 v233, v178, v179
    s_waitcnt lgkmcnt(7)
    v_mfma_f32_16x16x32_bf16 v[128:131], v[208:211], v[16:19], v[128:131]
    ds_read_b64_tr_b16 v[202:203], v216 offset:12800
    ds_write_b64 v244, v[232:233] offset:8192
    v_mfma_f32_16x16x32_bf16 v[132:135], v[208:211], v[20:23], v[132:135]
    ds_read_b64_tr_b16 v[204:205], v217 offset:12288
    v_cvt_pk_bf16_f32 v234, v180, v181
    v_mfma_f32_16x16x32_bf16 v[136:139], v[212:215], v[16:19], v[136:139]
    ds_read_b64_tr_b16 v[206:207], v217 offset:12800
    v_cvt_pk_bf16_f32 v235, v182, v183
    v_mfma_f32_16x16x32_bf16 v[140:143], v[212:215], v[20:23], v[140:143]
    ds_read_b64_tr_b16 v[208:209], v218 offset:12288
    ds_write_b64 v244, v[234:235] offset:8704
    s_waitcnt lgkmcnt(7)
    v_mfma_f32_16x16x32_bf16 v[144:147], v[192:195], v[16:19], v[144:147]
    ds_read_b64_tr_b16 v[210:211], v218 offset:12800
    v_cvt_pk_bf16_f32 v236, v184, v185
    v_mfma_f32_16x16x32_bf16 v[148:151], v[192:195], v[20:23], v[148:151]
    ds_read_b64_tr_b16 v[212:213], v219 offset:12288
    v_cvt_pk_bf16_f32 v237, v186, v187
    v_mfma_f32_16x16x32_bf16 v[152:155], v[196:199], v[16:19], v[152:155]
    ds_read_b64_tr_b16 v[214:215], v219 offset:12800
    ds_write_b64 v244, v[236:237] offset:12288
    v_mfma_f32_16x16x32_bf16 v[156:159], v[196:199], v[20:23], v[156:159]
    ds_read_b64_tr_b16 v[192:193], v216 offset:16384
    v_cvt_pk_bf16_f32 v238, v188, v189
    s_waitcnt lgkmcnt(7)
    v_mfma_f32_16x16x32_bf16 v[128:131], v[200:203], v[24:27], v[128:131]
    ds_read_b64_tr_b16 v[194:195], v216 offset:16896
    v_cvt_pk_bf16_f32 v239, v190, v191
    v_mfma_f32_16x16x32_bf16 v[132:135], v[200:203], v[28:31], v[132:135]
    ds_read_b64_tr_b16 v[196:197], v217 offset:16384
    ds_write_b64 v244, v[238:239] offset:12800
    v_mfma_f32_16x16x32_bf16 v[136:139], v[204:207], v[24:27], v[136:139]
    ds_read_b64_tr_b16 v[198:199], v217 offset:16896
    v_mfma_f32_16x16x32_bf16 v[140:143], v[204:207], v[28:31], v[140:143]
    ds_read_b64_tr_b16 v[200:201], v218 offset:16384
    s_waitcnt lgkmcnt(7)
    v_mfma_f32_16x16x32_bf16 v[144:147], v[208:211], v[24:27], v[144:147]
    ds_read_b64_tr_b16 v[202:203], v218 offset:16896
    v_mfma_f32_16x16x32_bf16 v[148:151], v[208:211], v[28:31], v[148:151]
    s_waitcnt lgkmcnt(3)
    s_barrier
    ds_read_b64_tr_b16 v[204:205], v219 offset:16384
    v_mfma_f32_16x16x32_bf16 v[152:155], v[212:215], v[24:27], v[152:155]
    ds_read_b64_tr_b16 v[206:207], v219 offset:16896
    v_mfma_f32_16x16x32_bf16 v[156:159], v[212:215], v[28:31], v[156:159]
    ds_read_b64_tr_b16 v[208:209], v216 offset:20480
    s_waitcnt lgkmcnt(5)
    v_mfma_f32_16x16x32_bf16 v[128:131], v[192:195], v[32:35], v[128:131]
    ds_read_b64_tr_b16 v[210:211], v216 offset:20992
    v_mfma_f32_16x16x32_bf16 v[132:135], v[192:195], v[36:39], v[132:135]
    ds_read_b64_tr_b16 v[212:213], v217 offset:20480
    v_mfma_f32_16x16x32_bf16 v[136:139], v[196:199], v[32:35], v[136:139]
    ds_read_b64_tr_b16 v[214:215], v217 offset:20992
    v_mfma_f32_16x16x32_bf16 v[140:143], v[196:199], v[36:39], v[140:143]
    ds_read_b64_tr_b16 v[192:193], v218 offset:20480
    s_waitcnt lgkmcnt(5)
    v_mfma_f32_16x16x32_bf16 v[144:147], v[200:203], v[32:35], v[144:147]
    ds_read_b64_tr_b16 v[194:195], v218 offset:20992
    v_mfma_f32_16x16x32_bf16 v[148:151], v[200:203], v[36:39], v[148:151]
    ds_read_b64_tr_b16 v[196:197], v219 offset:20480
    v_mfma_f32_16x16x32_bf16 v[152:155], v[204:207], v[32:35], v[152:155]
    ds_read_b64_tr_b16 v[198:199], v219 offset:20992
    v_mfma_f32_16x16x32_bf16 v[156:159], v[204:207], v[36:39], v[156:159]
    ds_read_b64_tr_b16 v[200:201], v216 offset:24576
    s_waitcnt lgkmcnt(5)
    v_mfma_f32_16x16x32_bf16 v[128:131], v[208:211], v[40:43], v[128:131]
    ds_read_b64_tr_b16 v[202:203], v216 offset:25088
    v_mfma_f32_16x16x32_bf16 v[132:135], v[208:211], v[44:47], v[132:135]
    ds_read_b64_tr_b16 v[204:205], v217 offset:24576
    v_mfma_f32_16x16x32_bf16 v[136:139], v[212:215], v[40:43], v[136:139]
    ds_read_b64_tr_b16 v[206:207], v217 offset:25088
    v_mfma_f32_16x16x32_bf16 v[140:143], v[212:215], v[44:47], v[140:143]
    ds_read_b64_tr_b16 v[208:209], v218 offset:24576
    s_waitcnt lgkmcnt(5)
    v_mfma_f32_16x16x32_bf16 v[144:147], v[192:195], v[40:43], v[144:147]
    ds_read_b64_tr_b16 v[210:211], v218 offset:25088
    v_mfma_f32_16x16x32_bf16 v[148:151], v[192:195], v[44:47], v[148:151]
    ds_read_b64_tr_b16 v[212:213], v219 offset:24576
    v_mfma_f32_16x16x32_bf16 v[152:155], v[196:199], v[40:43], v[152:155]
    ds_read_b64_tr_b16 v[214:215], v219 offset:25088
    v_mfma_f32_16x16x32_bf16 v[156:159], v[196:199], v[44:47], v[156:159]
    ds_read_b64_tr_b16 v[192:193], v216 offset:28672
    s_waitcnt lgkmcnt(5)
    v_mfma_f32_16x16x32_bf16 v[128:131], v[200:203], v[48:51], v[128:131]
    ds_read_b64_tr_b16 v[194:195], v216 offset:29184
    v_mfma_f32_16x16x32_bf16 v[132:135], v[200:203], v[52:55], v[132:135]
    ds_read_b64_tr_b16 v[196:197], v217 offset:28672
    v_mfma_f32_16x16x32_bf16 v[136:139], v[204:207], v[48:51], v[136:139]
    ds_read_b64_tr_b16 v[198:199], v217 offset:29184
    v_mfma_f32_16x16x32_bf16 v[140:143], v[204:207], v[52:55], v[140:143]
    ds_read_b64_tr_b16 v[200:201], v218 offset:28672
    s_waitcnt lgkmcnt(5)
    v_mfma_f32_16x16x32_bf16 v[144:147], v[208:211], v[48:51], v[144:147]
    ds_read_b64_tr_b16 v[202:203], v218 offset:29184
    v_mfma_f32_16x16x32_bf16 v[148:151], v[208:211], v[52:55], v[148:151]
    ds_read_b64_tr_b16 v[204:205], v219 offset:28672
    v_mfma_f32_16x16x32_bf16 v[152:155], v[212:215], v[48:51], v[152:155]
    ds_read_b64_tr_b16 v[206:207], v219 offset:29184
    v_mfma_f32_16x16x32_bf16 v[156:159], v[212:215], v[52:55], v[156:159]
    s_waitcnt lgkmcnt(4)
    v_mfma_f32_16x16x32_bf16 v[128:131], v[192:195], v[56:59], v[128:131]
    v_mfma_f32_16x16x32_bf16 v[132:135], v[192:195], v[60:63], v[132:135]
    s_waitcnt lgkmcnt(0)
    s_barrier
    ds_read_b64_tr_b16 v[208:209], v216 offset:32768
    ds_read_b64_tr_b16 v[210:211], v216 offset:33280
    ds_read_b64_tr_b16 v[212:213], v217 offset:32768
    ds_read_b64_tr_b16 v[214:215], v217 offset:33280
    v_mfma_f32_16x16x32_bf16 v[136:139], v[196:199], v[56:59], v[136:139]
    v_mfma_f32_16x16x32_bf16 v[140:143], v[196:199], v[60:63], v[140:143]
    ds_read_b64_tr_b16 v[192:193], v218 offset:32768
    v_mfma_f32_16x16x32_bf16 v[144:147], v[200:203], v[56:59], v[144:147]
    ds_read_b64_tr_b16 v[194:195], v218 offset:33280
    v_mfma_f32_16x16x32_bf16 v[148:151], v[200:203], v[60:63], v[148:151]
    ds_read_b64_tr_b16 v[196:197], v219 offset:32768
    v_mfma_f32_16x16x32_bf16 v[152:155], v[204:207], v[56:59], v[152:155]
    ds_read_b64_tr_b16 v[198:199], v219 offset:33280
    v_mfma_f32_16x16x32_bf16 v[156:159], v[204:207], v[60:63], v[156:159]
    ds_read_b64_tr_b16 v[200:201], v216 offset:36864
    s_waitcnt lgkmcnt(5)
    v_mfma_f32_16x16x32_bf16 v[128:131], v[208:211], v[64:67], v[128:131]
    ds_read_b64_tr_b16 v[202:203], v216 offset:37376
    v_mfma_f32_16x16x32_bf16 v[132:135], v[208:211], v[68:71], v[132:135]
    ds_read_b64_tr_b16 v[204:205], v217 offset:36864
    v_mfma_f32_16x16x32_bf16 v[136:139], v[212:215], v[64:67], v[136:139]
    ds_read_b64_tr_b16 v[206:207], v217 offset:37376
    v_mfma_f32_16x16x32_bf16 v[140:143], v[212:215], v[68:71], v[140:143]
    ds_read_b64_tr_b16 v[208:209], v218 offset:36864
    s_waitcnt lgkmcnt(5)
    v_mfma_f32_16x16x32_bf16 v[144:147], v[192:195], v[64:67], v[144:147]
    ds_read_b64_tr_b16 v[210:211], v218 offset:37376
    v_mfma_f32_16x16x32_bf16 v[148:151], v[192:195], v[68:71], v[148:151]
    ds_read_b64_tr_b16 v[212:213], v219 offset:36864
    v_mfma_f32_16x16x32_bf16 v[152:155], v[196:199], v[64:67], v[152:155]
    ds_read_b64_tr_b16 v[214:215], v219 offset:37376
    v_mfma_f32_16x16x32_bf16 v[156:159], v[196:199], v[68:71], v[156:159]
    ds_read_b64_tr_b16 v[192:193], v216 offset:40960
    s_waitcnt lgkmcnt(5)
    v_mfma_f32_16x16x32_bf16 v[128:131], v[200:203], v[72:75], v[128:131]
    ds_read_b64_tr_b16 v[194:195], v216 offset:41472
    v_mfma_f32_16x16x32_bf16 v[132:135], v[200:203], v[76:79], v[132:135]
    ds_read_b64_tr_b16 v[196:197], v217 offset:40960
    v_mfma_f32_16x16x32_bf16 v[136:139], v[204:207], v[72:75], v[136:139]
    ds_read_b64_tr_b16 v[198:199], v217 offset:41472
    v_mfma_f32_16x16x32_bf16 v[140:143], v[204:207], v[76:79], v[140:143]
    ds_read_b64_tr_b16 v[200:201], v218 offset:40960
    s_waitcnt lgkmcnt(5)
    v_mfma_f32_16x16x32_bf16 v[144:147], v[208:211], v[72:75], v[144:147]
    ds_read_b64_tr_b16 v[202:203], v218 offset:41472
    v_mfma_f32_16x16x32_bf16 v[148:151], v[208:211], v[76:79], v[148:151]
    ds_read_b64_tr_b16 v[204:205], v219 offset:40960
    v_mfma_f32_16x16x32_bf16 v[152:155], v[212:215], v[72:75], v[152:155]
    ds_read_b64_tr_b16 v[206:207], v219 offset:41472
    v_mfma_f32_16x16x32_bf16 v[156:159], v[212:215], v[76:79], v[156:159]
    ds_read_b64_tr_b16 v[208:209], v216 offset:45056
    s_waitcnt lgkmcnt(5)
    v_mfma_f32_16x16x32_bf16 v[128:131], v[192:195], v[80:83], v[128:131]
    ds_read_b64_tr_b16 v[210:211], v216 offset:45568
    v_mfma_f32_16x16x32_bf16 v[132:135], v[192:195], v[84:87], v[132:135]
    ds_read_b64_tr_b16 v[212:213], v217 offset:45056
    v_mfma_f32_16x16x32_bf16 v[136:139], v[196:199], v[80:83], v[136:139]
    ds_read_b64_tr_b16 v[214:215], v217 offset:45568
    v_mfma_f32_16x16x32_bf16 v[140:143], v[196:199], v[84:87], v[140:143]
    ds_read_b64_tr_b16 v[192:193], v218 offset:45056
    s_waitcnt lgkmcnt(5)
    v_mfma_f32_16x16x32_bf16 v[144:147], v[200:203], v[80:83], v[144:147]
    ds_read_b64_tr_b16 v[194:195], v218 offset:45568
    v_mfma_f32_16x16x32_bf16 v[148:151], v[200:203], v[84:87], v[148:151]
    ds_read_b64_tr_b16 v[196:197], v219 offset:45056
    v_mfma_f32_16x16x32_bf16 v[152:155], v[204:207], v[80:83], v[152:155]
    ds_read_b64_tr_b16 v[198:199], v219 offset:45568
    v_mfma_f32_16x16x32_bf16 v[156:159], v[204:207], v[84:87], v[156:159]
    ds_read_b64_tr_b16 v[200:201], v216 offset:49152
    s_waitcnt lgkmcnt(5)
    v_mfma_f32_16x16x32_bf16 v[128:131], v[208:211], v[88:91], v[128:131]
    ds_read_b64_tr_b16 v[202:203], v216 offset:49664
    v_mfma_f32_16x16x32_bf16 v[132:135], v[208:211], v[92:95], v[132:135]
    ds_read_b64_tr_b16 v[204:205], v217 offset:49152
    v_mfma_f32_16x16x32_bf16 v[136:139], v[212:215], v[88:91], v[136:139]
    ds_read_b64_tr_b16 v[206:207], v217 offset:49664
    v_mfma_f32_16x16x32_bf16 v[140:143], v[212:215], v[92:95], v[140:143]
    ds_read_b64_tr_b16 v[208:209], v218 offset:49152
    s_waitcnt lgkmcnt(5)
    v_mfma_f32_16x16x32_bf16 v[144:147], v[192:195], v[88:91], v[144:147]
    ds_read_b64_tr_b16 v[210:211], v218 offset:49664
    v_mfma_f32_16x16x32_bf16 v[148:151], v[192:195], v[92:95], v[148:151]
    ds_read_b64_tr_b16 v[212:213], v219 offset:49152
    v_mfma_f32_16x16x32_bf16 v[152:155], v[196:199], v[88:91], v[152:155]
    ds_read_b64_tr_b16 v[214:215], v219 offset:49664
    v_mfma_f32_16x16x32_bf16 v[156:159], v[196:199], v[92:95], v[156:159]
    ds_read_b64_tr_b16 v[192:193], v216 offset:53248
    s_waitcnt lgkmcnt(5)
    v_mfma_f32_16x16x32_bf16 v[128:131], v[200:203], v[96:99], v[128:131]
    ds_read_b64_tr_b16 v[194:195], v216 offset:53760
    v_mfma_f32_16x16x32_bf16 v[132:135], v[200:203], v[100:103], v[132:135]
    ds_read_b64_tr_b16 v[196:197], v217 offset:53248
    v_mfma_f32_16x16x32_bf16 v[136:139], v[204:207], v[96:99], v[136:139]
    ds_read_b64_tr_b16 v[198:199], v217 offset:53760
    v_mfma_f32_16x16x32_bf16 v[140:143], v[204:207], v[100:103], v[140:143]
    ds_read_b64_tr_b16 v[200:201], v218 offset:53248
    s_waitcnt lgkmcnt(5)
    v_mfma_f32_16x16x32_bf16 v[144:147], v[208:211], v[96:99], v[144:147]
    ds_read_b64_tr_b16 v[202:203], v218 offset:53760
    v_mfma_f32_16x16x32_bf16 v[148:151], v[208:211], v[100:103], v[148:151]
    ds_read_b64_tr_b16 v[204:205], v219 offset:53248
    v_mfma_f32_16x16x32_bf16 v[152:155], v[212:215], v[96:99], v[152:155]
    ds_read_b64_tr_b16 v[206:207], v219 offset:53760
    v_mfma_f32_16x16x32_bf16 v[156:159], v[212:215], v[100:103], v[156:159]
    ds_read_b64_tr_b16 v[208:209], v216 offset:57344
    s_waitcnt lgkmcnt(5)
    v_mfma_f32_16x16x32_bf16 v[128:131], v[192:195], v[104:107], v[128:131]
    ds_read_b64_tr_b16 v[210:211], v216 offset:57856
    v_mfma_f32_16x16x32_bf16 v[132:135], v[192:195], v[108:111], v[132:135]
    ds_read_b64_tr_b16 v[212:213], v217 offset:57344
    v_mfma_f32_16x16x32_bf16 v[136:139], v[196:199], v[104:107], v[136:139]
    ds_read_b64_tr_b16 v[214:215], v217 offset:57856
    v_mfma_f32_16x16x32_bf16 v[140:143], v[196:199], v[108:111], v[140:143]
    ds_read_b64_tr_b16 v[192:193], v218 offset:57344
    s_waitcnt lgkmcnt(5)
    v_mfma_f32_16x16x32_bf16 v[144:147], v[200:203], v[104:107], v[144:147]
    ds_read_b64_tr_b16 v[194:195], v218 offset:57856
    v_mfma_f32_16x16x32_bf16 v[148:151], v[200:203], v[108:111], v[148:151]
    ds_read_b64_tr_b16 v[196:197], v219 offset:57344
    v_mfma_f32_16x16x32_bf16 v[152:155], v[204:207], v[104:107], v[152:155]
    ds_read_b64_tr_b16 v[198:199], v219 offset:57856
    v_mfma_f32_16x16x32_bf16 v[156:159], v[204:207], v[108:111], v[156:159]
    ds_read_b64_tr_b16 v[200:201], v216 offset:61440
    s_waitcnt lgkmcnt(5)
    v_mfma_f32_16x16x32_bf16 v[128:131], v[208:211], v[112:115], v[128:131]
    ds_read_b64_tr_b16 v[202:203], v216 offset:61952
    v_mfma_f32_16x16x32_bf16 v[132:135], v[208:211], v[116:119], v[132:135]
    ds_read_b64_tr_b16 v[204:205], v217 offset:61440
    v_mfma_f32_16x16x32_bf16 v[136:139], v[212:215], v[112:115], v[136:139]
    ds_read_b64_tr_b16 v[206:207], v217 offset:61952
    v_mfma_f32_16x16x32_bf16 v[140:143], v[212:215], v[116:119], v[140:143]
    ds_read_b64_tr_b16 v[208:209], v218 offset:61440
    s_waitcnt lgkmcnt(5)
    v_mfma_f32_16x16x32_bf16 v[144:147], v[192:195], v[112:115], v[144:147]
    ds_read_b64_tr_b16 v[210:211], v218 offset:61952
    v_mfma_f32_16x16x32_bf16 v[148:151], v[192:195], v[116:119], v[148:151]
    ds_read_b64_tr_b16 v[212:213], v219 offset:61440
    v_mfma_f32_16x16x32_bf16 v[152:155], v[196:199], v[112:115], v[152:155]
    ds_read_b64_tr_b16 v[214:215], v219 offset:61952
    v_mfma_f32_16x16x32_bf16 v[156:159], v[196:199], v[116:119], v[156:159]
    s_waitcnt lgkmcnt(4)
    v_mfma_f32_16x16x32_bf16 v[128:131], v[200:203], v[120:123], v[128:131]
    v_mfma_f32_16x16x32_bf16 v[132:135], v[200:203], v[124:127], v[132:135]
    s_waitcnt lgkmcnt(0)
    s_barrier
    ds_read_b64_tr_b16 v[192:193], v220 offset:0
    ds_read_b64_tr_b16 v[194:195], v220 offset:512
    ds_read_b64_tr_b16 v[196:197], v221 offset:0
    ds_read_b64_tr_b16 v[198:199], v221 offset:512
    v_mfma_f32_16x16x32_bf16 v[136:139], v[204:207], v[120:123], v[136:139]
    v_mfma_f32_16x16x32_bf16 v[140:143], v[204:207], v[124:127], v[140:143]
    ds_read_b64_tr_b16 v[200:201], v220 offset:16384
    v_mfma_f32_16x16x32_bf16 v[144:147], v[208:211], v[120:123], v[144:147]
    ds_read_b64_tr_b16 v[202:203], v220 offset:16896
    v_mfma_f32_16x16x32_bf16 v[148:151], v[208:211], v[124:127], v[148:151]
    ds_read_b64_tr_b16 v[204:205], v221 offset:16384
    v_mfma_f32_16x16x32_bf16 v[152:155], v[212:215], v[120:123], v[152:155]
    ds_read_b64_tr_b16 v[206:207], v221 offset:16896
    v_mfma_f32_16x16x32_bf16 v[156:159], v[212:215], v[124:127], v[156:159]
    ds_read_b64_tr_b16 v[208:209], v220 offset:4096
    s_waitcnt lgkmcnt(5)
    v_mfma_f32_16x16x32_bf16 v[160:163], v[192:195], v[0:3], 0
    ds_read_b64_tr_b16 v[210:211], v220 offset:4608
    v_mfma_f32_16x16x32_bf16 v[164:167], v[192:195], v[4:7], 0
    ds_read_b64_tr_b16 v[212:213], v221 offset:4096
    v_mfma_f32_16x16x32_bf16 v[168:171], v[196:199], v[0:3], 0
    ds_read_b64_tr_b16 v[214:215], v221 offset:4608
    v_mul_f32 v128, v128, v240
    v_mul_f32 v129, v129, v240
    v_mfma_f32_16x16x32_bf16 v[172:175], v[196:199], v[4:7], 0
    ds_read_b64_tr_b16 v[192:193], v220 offset:20480
    v_mul_f32 v130, v130, v240
    v_mul_f32 v131, v131, v240
    v_cvt_pk_bf16_f32 v224, v128, v129
    s_waitcnt lgkmcnt(5)
    v_mfma_f32_16x16x32_bf16 v[176:179], v[200:203], v[0:3], 0
    ds_read_b64_tr_b16 v[194:195], v220 offset:20992
    v_cvt_pk_bf16_f32 v225, v130, v131
    v_mul_f32 v132, v132, v241
    v_mfma_f32_16x16x32_bf16 v[180:183], v[200:203], v[4:7], 0
    ds_read_b64_tr_b16 v[196:197], v221 offset:20480
    v_mul_f32 v133, v133, v241
    v_mul_f32 v134, v134, v241
    v_mul_f32 v135, v135, v241
    v_mfma_f32_16x16x32_bf16 v[184:187], v[204:207], v[0:3], 0
    ds_read_b64_tr_b16 v[198:199], v221 offset:20992
    v_cvt_pk_bf16_f32 v226, v132, v133
    v_cvt_pk_bf16_f32 v227, v134, v135
    v_mfma_f32_16x16x32_bf16 v[188:191], v[204:207], v[4:7], 0
    ds_read_b64_tr_b16 v[200:201], v220 offset:8192
    v_mul_f32 v136, v136, v240
    v_mul_f32 v137, v137, v240
    v_mul_f32 v138, v138, v240
    s_waitcnt lgkmcnt(5)
    v_mfma_f32_16x16x32_bf16 v[160:163], v[208:211], v[8:11], v[160:163]
    ds_read_b64_tr_b16 v[202:203], v220 offset:8704
    v_mul_f32 v139, v139, v240
    v_cvt_pk_bf16_f32 v228, v136, v137
    v_mfma_f32_16x16x32_bf16 v[164:167], v[208:211], v[12:15], v[164:167]
    ds_read_b64_tr_b16 v[204:205], v221 offset:8192
    v_cvt_pk_bf16_f32 v229, v138, v139
    v_permlane16_swap_b32 v224, v226
    v_mfma_f32_16x16x32_bf16 v[168:171], v[212:215], v[8:11], v[168:171]
    ds_read_b64_tr_b16 v[206:207], v221 offset:8704
    v_permlane16_swap_b32 v225, v227
    buffer_store_dwordx4 v[224:227], v242, s[20:23], s72 offen sc1
    v_mfma_f32_16x16x32_bf16 v[172:175], v[212:215], v[12:15], v[172:175]
    ds_read_b64_tr_b16 v[208:209], v220 offset:24576
    s_add_u32 s72, s72, 4096
    v_mul_f32 v140, v140, v241
    s_waitcnt lgkmcnt(5)
    v_mfma_f32_16x16x32_bf16 v[176:179], v[192:195], v[8:11], v[176:179]
    ds_read_b64_tr_b16 v[210:211], v220 offset:25088
    v_mul_f32 v141, v141, v241
    v_mul_f32 v142, v142, v241
    v_mfma_f32_16x16x32_bf16 v[180:183], v[192:195], v[12:15], v[180:183]
    ds_read_b64_tr_b16 v[212:213], v221 offset:24576
    v_mul_f32 v143, v143, v241
    v_cvt_pk_bf16_f32 v230, v140, v141
    v_mfma_f32_16x16x32_bf16 v[184:187], v[196:199], v[8:11], v[184:187]
    ds_read_b64_tr_b16 v[214:215], v221 offset:25088
    v_cvt_pk_bf16_f32 v231, v142, v143
    v_mul_f32 v144, v144, v240
    v_mfma_f32_16x16x32_bf16 v[188:191], v[196:199], v[12:15], v[188:191]
    ds_read_b64_tr_b16 v[192:193], v220 offset:12288
    v_mul_f32 v145, v145, v240
    v_mul_f32 v146, v146, v240
    s_waitcnt lgkmcnt(5)
    v_mfma_f32_16x16x32_bf16 v[160:163], v[200:203], v[16:19], v[160:163]
    ds_read_b64_tr_b16 v[194:195], v220 offset:12800
    v_mul_f32 v147, v147, v240
    v_cvt_pk_bf16_f32 v232, v144, v145
    v_mfma_f32_16x16x32_bf16 v[164:167], v[200:203], v[20:23], v[164:167]
    ds_read_b64_tr_b16 v[196:197], v221 offset:12288
    v_cvt_pk_bf16_f32 v233, v146, v147
    v_permlane16_swap_b32 v228, v230
    v_mfma_f32_16x16x32_bf16 v[168:171], v[204:207], v[16:19], v[168:171]
    ds_read_b64_tr_b16 v[198:199], v221 offset:12800
    v_permlane16_swap_b32 v229, v231
    buffer_store_dwordx4 v[228:231], v242, s[20:23], s72 offen sc1
    v_mfma_f32_16x16x32_bf16 v[172:175], v[204:207], v[20:23], v[172:175]
    ds_read_b64_tr_b16 v[200:201], v220 offset:28672
    s_add_u32 s72, s72, 4096
    v_mul_f32 v148, v148, v241
    s_waitcnt lgkmcnt(5)
    v_mfma_f32_16x16x32_bf16 v[176:179], v[208:211], v[16:19], v[176:179]
    ds_read_b64_tr_b16 v[202:203], v220 offset:29184
    v_mul_f32 v149, v149, v241
    v_mul_f32 v150, v150, v241
    v_mfma_f32_16x16x32_bf16 v[180:183], v[208:211], v[20:23], v[180:183]
    ds_read_b64_tr_b16 v[204:205], v221 offset:28672
    v_mul_f32 v151, v151, v241
    v_cvt_pk_bf16_f32 v234, v148, v149
    v_mfma_f32_16x16x32_bf16 v[184:187], v[212:215], v[16:19], v[184:187]
    ds_read_b64_tr_b16 v[206:207], v221 offset:29184
    v_cvt_pk_bf16_f32 v235, v150, v151
    v_mul_f32 v152, v152, v240
    v_mfma_f32_16x16x32_bf16 v[188:191], v[212:215], v[20:23], v[188:191]
    ds_read_b64_tr_b16 v[208:209], v222 offset:0
    v_mul_f32 v153, v153, v240
    v_mul_f32 v154, v154, v240
    s_waitcnt lgkmcnt(5)
    v_mfma_f32_16x16x32_bf16 v[160:163], v[192:195], v[24:27], v[160:163]
    ds_read_b64_tr_b16 v[210:211], v222 offset:512
    v_mul_f32 v155, v155, v240
    v_cvt_pk_bf16_f32 v236, v152, v153
    v_mfma_f32_16x16x32_bf16 v[164:167], v[192:195], v[28:31], v[164:167]
    ds_read_b64_tr_b16 v[212:213], v223 offset:0
    v_cvt_pk_bf16_f32 v237, v154, v155
    v_permlane16_swap_b32 v232, v234
    v_mfma_f32_16x16x32_bf16 v[168:171], v[196:199], v[24:27], v[168:171]
    ds_read_b64_tr_b16 v[214:215], v223 offset:512
    v_permlane16_swap_b32 v233, v235
    buffer_store_dwordx4 v[232:235], v242, s[20:23], s72 offen sc1
    v_mfma_f32_16x16x32_bf16 v[172:175], v[196:199], v[28:31], v[172:175]
    ds_read_b64_tr_b16 v[192:193], v222 offset:16384
    s_add_u32 s72, s72, 4096
    v_mul_f32 v156, v156, v241
    s_waitcnt lgkmcnt(5)
    v_mfma_f32_16x16x32_bf16 v[176:179], v[200:203], v[24:27], v[176:179]
    ds_read_b64_tr_b16 v[194:195], v222 offset:16896
    v_mul_f32 v157, v157, v241
    v_mul_f32 v158, v158, v241
    v_mfma_f32_16x16x32_bf16 v[180:183], v[200:203], v[28:31], v[180:183]
    ds_read_b64_tr_b16 v[196:197], v223 offset:16384
    v_mul_f32 v159, v159, v241
    v_cvt_pk_bf16_f32 v238, v156, v157
    v_mfma_f32_16x16x32_bf16 v[184:187], v[204:207], v[24:27], v[184:187]
    ds_read_b64_tr_b16 v[198:199], v223 offset:16896
    v_cvt_pk_bf16_f32 v239, v158, v159
    v_permlane16_swap_b32 v236, v238
    v_mfma_f32_16x16x32_bf16 v[188:191], v[204:207], v[28:31], v[188:191]
    ds_read_b64_tr_b16 v[200:201], v222 offset:4096
    v_permlane16_swap_b32 v237, v239
    buffer_store_dwordx4 v[236:239], v242, s[20:23], s72 offen sc1
    s_waitcnt lgkmcnt(5)
    v_mfma_f32_16x16x32_bf16 v[128:131], v[208:211], v[0:3], 0
    ds_read_b64_tr_b16 v[202:203], v222 offset:4608
    v_mfma_f32_16x16x32_bf16 v[132:135], v[208:211], v[4:7], 0
    ds_read_b64_tr_b16 v[204:205], v223 offset:4096
    v_mfma_f32_16x16x32_bf16 v[136:139], v[212:215], v[0:3], 0
    ds_read_b64_tr_b16 v[206:207], v223 offset:4608
    v_mfma_f32_16x16x32_bf16 v[140:143], v[212:215], v[4:7], 0
    ds_read_b64_tr_b16 v[208:209], v222 offset:20480
    s_waitcnt lgkmcnt(5)
    v_mfma_f32_16x16x32_bf16 v[144:147], v[192:195], v[0:3], 0
    ds_read_b64_tr_b16 v[210:211], v222 offset:20992
    v_mfma_f32_16x16x32_bf16 v[148:151], v[192:195], v[4:7], 0
    ds_read_b64_tr_b16 v[212:213], v223 offset:20480
    v_mfma_f32_16x16x32_bf16 v[152:155], v[196:199], v[0:3], 0
    ds_read_b64_tr_b16 v[214:215], v223 offset:20992
    v_mfma_f32_16x16x32_bf16 v[156:159], v[196:199], v[4:7], 0
    ds_read_b64_tr_b16 v[192:193], v222 offset:8192
    s_waitcnt lgkmcnt(5)
    v_mfma_f32_16x16x32_bf16 v[128:131], v[200:203], v[8:11], v[128:131]
    ds_read_b64_tr_b16 v[194:195], v222 offset:8704
    v_mfma_f32_16x16x32_bf16 v[132:135], v[200:203], v[12:15], v[132:135]
    ds_read_b64_tr_b16 v[196:197], v223 offset:8192
    v_mfma_f32_16x16x32_bf16 v[136:139], v[204:207], v[8:11], v[136:139]
    ds_read_b64_tr_b16 v[198:199], v223 offset:8704
    v_mfma_f32_16x16x32_bf16 v[140:143], v[204:207], v[12:15], v[140:143]
    ds_read_b64_tr_b16 v[200:201], v222 offset:24576
    s_waitcnt lgkmcnt(5)
    v_mfma_f32_16x16x32_bf16 v[144:147], v[208:211], v[8:11], v[144:147]
    ds_read_b64_tr_b16 v[202:203], v222 offset:25088
    v_mfma_f32_16x16x32_bf16 v[148:151], v[208:211], v[12:15], v[148:151]
    ds_read_b64_tr_b16 v[204:205], v223 offset:24576
    v_mfma_f32_16x16x32_bf16 v[152:155], v[212:215], v[8:11], v[152:155]
    ds_read_b64_tr_b16 v[206:207], v223 offset:25088
    v_mfma_f32_16x16x32_bf16 v[156:159], v[212:215], v[12:15], v[156:159]
    ds_read_b64_tr_b16 v[208:209], v222 offset:12288
    s_waitcnt lgkmcnt(5)
    v_mfma_f32_16x16x32_bf16 v[128:131], v[192:195], v[16:19], v[128:131]
    ds_read_b64_tr_b16 v[210:211], v222 offset:12800
    v_mfma_f32_16x16x32_bf16 v[132:135], v[192:195], v[20:23], v[132:135]
    ds_read_b64_tr_b16 v[212:213], v223 offset:12288
    v_mfma_f32_16x16x32_bf16 v[136:139], v[196:199], v[16:19], v[136:139]
    ds_read_b64_tr_b16 v[214:215], v223 offset:12800
    v_mfma_f32_16x16x32_bf16 v[140:143], v[196:199], v[20:23], v[140:143]
    ds_read_b64_tr_b16 v[192:193], v222 offset:28672
    s_waitcnt lgkmcnt(5)
    v_mfma_f32_16x16x32_bf16 v[144:147], v[200:203], v[16:19], v[144:147]
    ds_read_b64_tr_b16 v[194:195], v222 offset:29184
    v_mfma_f32_16x16x32_bf16 v[148:151], v[200:203], v[20:23], v[148:151]
    ds_read_b64_tr_b16 v[196:197], v223 offset:28672
    v_mfma_f32_16x16x32_bf16 v[152:155], v[204:207], v[16:19], v[152:155]
    ds_read_b64_tr_b16 v[198:199], v223 offset:29184
    v_mfma_f32_16x16x32_bf16 v[156:159], v[204:207], v[20:23], v[156:159]
    s_waitcnt lgkmcnt(4)
    v_mfma_f32_16x16x32_bf16 v[128:131], v[208:211], v[24:27], v[128:131]
    v_mfma_f32_16x16x32_bf16 v[132:135], v[208:211], v[28:31], v[132:135]
    s_waitcnt lgkmcnt(0)
    s_barrier
    ds_read_b64_tr_b16 v[200:201], v216 offset:0
    ds_read_b64_tr_b16 v[202:203], v216 offset:512
    ds_read_b64_tr_b16 v[204:205], v217 offset:0
    ds_read_b64_tr_b16 v[206:207], v217 offset:512
    v_mfma_f32_16x16x32_bf16 v[136:139], v[212:215], v[24:27], v[136:139]
    v_mfma_f32_16x16x32_bf16 v[140:143], v[212:215], v[28:31], v[140:143]
    ds_read_b64_tr_b16 v[208:209], v216 offset:16384
    v_mfma_f32_16x16x32_bf16 v[144:147], v[192:195], v[24:27], v[144:147]
    ds_read_b64_tr_b16 v[210:211], v216 offset:16896
    v_mfma_f32_16x16x32_bf16 v[148:151], v[192:195], v[28:31], v[148:151]
    ds_read_b64_tr_b16 v[212:213], v217 offset:16384
    v_mfma_f32_16x16x32_bf16 v[152:155], v[196:199], v[24:27], v[152:155]
    ds_read_b64_tr_b16 v[214:215], v217 offset:16896
    v_mfma_f32_16x16x32_bf16 v[156:159], v[196:199], v[28:31], v[156:159]
    ds_read_b64_tr_b16 v[192:193], v216 offset:4096
    s_waitcnt lgkmcnt(5)
    v_mfma_f32_16x16x32_bf16 v[160:163], v[200:203], v[32:35], v[160:163]
    ds_read_b64_tr_b16 v[194:195], v216 offset:4608
    v_mfma_f32_16x16x32_bf16 v[164:167], v[200:203], v[36:39], v[164:167]
    ds_read_b64_tr_b16 v[196:197], v217 offset:4096
    v_mfma_f32_16x16x32_bf16 v[168:171], v[204:207], v[32:35], v[168:171]
    ds_read_b64_tr_b16 v[198:199], v217 offset:4608
    v_mfma_f32_16x16x32_bf16 v[172:175], v[204:207], v[36:39], v[172:175]
    ds_read_b64_tr_b16 v[200:201], v216 offset:20480
    s_waitcnt lgkmcnt(5)
    v_mfma_f32_16x16x32_bf16 v[176:179], v[208:211], v[32:35], v[176:179]
    ds_read_b64_tr_b16 v[202:203], v216 offset:20992
    v_mfma_f32_16x16x32_bf16 v[180:183], v[208:211], v[36:39], v[180:183]
    ds_read_b64_tr_b16 v[204:205], v217 offset:20480
    v_mfma_f32_16x16x32_bf16 v[184:187], v[212:215], v[32:35], v[184:187]
    ds_read_b64_tr_b16 v[206:207], v217 offset:20992
    v_mfma_f32_16x16x32_bf16 v[188:191], v[212:215], v[36:39], v[188:191]
    ds_read_b64_tr_b16 v[208:209], v216 offset:8192
    s_waitcnt lgkmcnt(5)
    v_mfma_f32_16x16x32_bf16 v[160:163], v[192:195], v[40:43], v[160:163]
    ds_read_b64_tr_b16 v[210:211], v216 offset:8704
    v_mfma_f32_16x16x32_bf16 v[164:167], v[192:195], v[44:47], v[164:167]
    ds_read_b64_tr_b16 v[212:213], v217 offset:8192
    v_mfma_f32_16x16x32_bf16 v[168:171], v[196:199], v[40:43], v[168:171]
    ds_read_b64_tr_b16 v[214:215], v217 offset:8704
    v_mfma_f32_16x16x32_bf16 v[172:175], v[196:199], v[44:47], v[172:175]
    ds_read_b64_tr_b16 v[192:193], v216 offset:24576
    s_waitcnt lgkmcnt(5)
    v_mfma_f32_16x16x32_bf16 v[176:179], v[200:203], v[40:43], v[176:179]
    ds_read_b64_tr_b16 v[194:195], v216 offset:25088
    v_mfma_f32_16x16x32_bf16 v[180:183], v[200:203], v[44:47], v[180:183]
    ds_read_b64_tr_b16 v[196:197], v217 offset:24576
    v_mfma_f32_16x16x32_bf16 v[184:187], v[204:207], v[40:43], v[184:187]
    ds_read_b64_tr_b16 v[198:199], v217 offset:25088
    v_mfma_f32_16x16x32_bf16 v[188:191], v[204:207], v[44:47], v[188:191]
    ds_read_b64_tr_b16 v[200:201], v216 offset:12288
    s_waitcnt vmcnt(0)
    s_mov_b64 exec, 1
    buffer_store_dword v248, v253, s[20:23], 0 offen sc1
    s_mov_b64 exec, -1
    s_waitcnt lgkmcnt(5)
    v_mfma_f32_16x16x32_bf16 v[160:163], v[208:211], v[48:51], v[160:163]
    ds_read_b64_tr_b16 v[202:203], v216 offset:12800
    v_mfma_f32_16x16x32_bf16 v[164:167], v[208:211], v[52:55], v[164:167]
    s_barrier
    ds_read_b64_tr_b16 v[204:205], v217 offset:12288
    v_mfma_f32_16x16x32_bf16 v[168:171], v[212:215], v[48:51], v[168:171]
    ds_read_b64_tr_b16 v[206:207], v217 offset:12800
    v_mfma_f32_16x16x32_bf16 v[172:175], v[212:215], v[52:55], v[172:175]
    ds_read_b64_tr_b16 v[208:209], v216 offset:28672
    s_waitcnt lgkmcnt(5)
    v_mfma_f32_16x16x32_bf16 v[176:179], v[192:195], v[48:51], v[176:179]
    ds_read_b64_tr_b16 v[210:211], v216 offset:29184
    v_mfma_f32_16x16x32_bf16 v[180:183], v[192:195], v[52:55], v[180:183]
    ds_read_b64_tr_b16 v[212:213], v217 offset:28672
    v_mfma_f32_16x16x32_bf16 v[184:187], v[196:199], v[48:51], v[184:187]
    ds_read_b64_tr_b16 v[214:215], v217 offset:29184
    v_mfma_f32_16x16x32_bf16 v[188:191], v[196:199], v[52:55], v[188:191]
    ds_read_b64_tr_b16 v[192:193], v218 offset:0
    s_waitcnt lgkmcnt(5)
    v_mfma_f32_16x16x32_bf16 v[160:163], v[200:203], v[56:59], v[160:163]
    ds_read_b64_tr_b16 v[194:195], v218 offset:512
    v_mfma_f32_16x16x32_bf16 v[164:167], v[200:203], v[60:63], v[164:167]
    ds_read_b64_tr_b16 v[196:197], v219 offset:0
    v_mfma_f32_16x16x32_bf16 v[168:171], v[204:207], v[56:59], v[168:171]
    ds_read_b64_tr_b16 v[198:199], v219 offset:512
    v_mfma_f32_16x16x32_bf16 v[172:175], v[204:207], v[60:63], v[172:175]
    ds_read_b64_tr_b16 v[200:201], v218 offset:16384
    s_waitcnt lgkmcnt(5)
    v_mfma_f32_16x16x32_bf16 v[176:179], v[208:211], v[56:59], v[176:179]
    ds_read_b64_tr_b16 v[202:203], v218 offset:16896
    v_mfma_f32_16x16x32_bf16 v[180:183], v[208:211], v[60:63], v[180:183]
    ds_read_b64_tr_b16 v[204:205], v219 offset:16384
    v_mfma_f32_16x16x32_bf16 v[184:187], v[212:215], v[56:59], v[184:187]
    ds_read_b64_tr_b16 v[206:207], v219 offset:16896
    v_mfma_f32_16x16x32_bf16 v[188:191], v[212:215], v[60:63], v[188:191]
    ds_read_b64_tr_b16 v[208:209], v218 offset:4096
    s_waitcnt lgkmcnt(5)
    v_mfma_f32_16x16x32_bf16 v[128:131], v[192:195], v[32:35], v[128:131]
    ds_read_b64_tr_b16 v[210:211], v218 offset:4608
    v_mfma_f32_16x16x32_bf16 v[132:135], v[192:195], v[36:39], v[132:135]
    ds_read_b64_tr_b16 v[212:213], v219 offset:4096
    v_mfma_f32_16x16x32_bf16 v[136:139], v[196:199], v[32:35], v[136:139]
    ds_read_b64_tr_b16 v[214:215], v219 offset:4608
    v_mfma_f32_16x16x32_bf16 v[140:143], v[196:199], v[36:39], v[140:143]
    ds_read_b64_tr_b16 v[192:193], v218 offset:20480
    s_waitcnt lgkmcnt(5)
    v_mfma_f32_16x16x32_bf16 v[144:147], v[200:203], v[32:35], v[144:147]
    ds_read_b64_tr_b16 v[194:195], v218 offset:20992
    v_mfma_f32_16x16x32_bf16 v[148:151], v[200:203], v[36:39], v[148:151]
    ds_read_b64_tr_b16 v[196:197], v219 offset:20480
    v_mfma_f32_16x16x32_bf16 v[152:155], v[204:207], v[32:35], v[152:155]
    ds_read_b64_tr_b16 v[198:199], v219 offset:20992
    v_mfma_f32_16x16x32_bf16 v[156:159], v[204:207], v[36:39], v[156:159]
    ds_read_b64_tr_b16 v[200:201], v218 offset:8192
    s_waitcnt lgkmcnt(5)
    v_mfma_f32_16x16x32_bf16 v[128:131], v[208:211], v[40:43], v[128:131]
    ds_read_b64_tr_b16 v[202:203], v218 offset:8704
    v_mfma_f32_16x16x32_bf16 v[132:135], v[208:211], v[44:47], v[132:135]
    ds_read_b64_tr_b16 v[204:205], v219 offset:8192
    v_mfma_f32_16x16x32_bf16 v[136:139], v[212:215], v[40:43], v[136:139]
    ds_read_b64_tr_b16 v[206:207], v219 offset:8704
    v_mfma_f32_16x16x32_bf16 v[140:143], v[212:215], v[44:47], v[140:143]
    ds_read_b64_tr_b16 v[208:209], v218 offset:24576
    s_waitcnt lgkmcnt(5)
    v_mfma_f32_16x16x32_bf16 v[144:147], v[192:195], v[40:43], v[144:147]
    ds_read_b64_tr_b16 v[210:211], v218 offset:25088
    v_mfma_f32_16x16x32_bf16 v[148:151], v[192:195], v[44:47], v[148:151]
    ds_read_b64_tr_b16 v[212:213], v219 offset:24576
    v_mfma_f32_16x16x32_bf16 v[152:155], v[196:199], v[40:43], v[152:155]
    ds_read_b64_tr_b16 v[214:215], v219 offset:25088
    v_mfma_f32_16x16x32_bf16 v[156:159], v[196:199], v[44:47], v[156:159]
    ds_read_b64_tr_b16 v[192:193], v218 offset:12288
    s_waitcnt lgkmcnt(5)
    v_mfma_f32_16x16x32_bf16 v[128:131], v[200:203], v[48:51], v[128:131]
    ds_read_b64_tr_b16 v[194:195], v218 offset:12800
    v_mfma_f32_16x16x32_bf16 v[132:135], v[200:203], v[52:55], v[132:135]
    ds_read_b64_tr_b16 v[196:197], v219 offset:12288
    v_mfma_f32_16x16x32_bf16 v[136:139], v[204:207], v[48:51], v[136:139]
    ds_read_b64_tr_b16 v[198:199], v219 offset:12800
    v_mfma_f32_16x16x32_bf16 v[140:143], v[204:207], v[52:55], v[140:143]
    ds_read_b64_tr_b16 v[200:201], v218 offset:28672
    s_waitcnt lgkmcnt(5)
    v_mfma_f32_16x16x32_bf16 v[144:147], v[208:211], v[48:51], v[144:147]
    ds_read_b64_tr_b16 v[202:203], v218 offset:29184
    v_mfma_f32_16x16x32_bf16 v[148:151], v[208:211], v[52:55], v[148:151]
    ds_read_b64_tr_b16 v[204:205], v219 offset:28672
    v_mfma_f32_16x16x32_bf16 v[152:155], v[212:215], v[48:51], v[152:155]
    ds_read_b64_tr_b16 v[206:207], v219 offset:29184
    v_mfma_f32_16x16x32_bf16 v[156:159], v[212:215], v[52:55], v[156:159]
    ds_read_b64_tr_b16 v[208:209], v216 offset:32768
    s_waitcnt lgkmcnt(5)
    v_mfma_f32_16x16x32_bf16 v[128:131], v[192:195], v[56:59], v[128:131]
    ds_read_b64_tr_b16 v[210:211], v216 offset:33280
    v_mfma_f32_16x16x32_bf16 v[132:135], v[192:195], v[60:63], v[132:135]
    ds_read_b64_tr_b16 v[212:213], v217 offset:32768
    v_mfma_f32_16x16x32_bf16 v[136:139], v[196:199], v[56:59], v[136:139]
    ds_read_b64_tr_b16 v[214:215], v217 offset:33280
    v_mfma_f32_16x16x32_bf16 v[140:143], v[196:199], v[60:63], v[140:143]
    ds_read_b64_tr_b16 v[192:193], v216 offset:49152
    s_waitcnt lgkmcnt(5)
    v_mfma_f32_16x16x32_bf16 v[144:147], v[200:203], v[56:59], v[144:147]
    ds_read_b64_tr_b16 v[194:195], v216 offset:49664
    v_mfma_f32_16x16x32_bf16 v[148:151], v[200:203], v[60:63], v[148:151]
    ds_read_b64_tr_b16 v[196:197], v217 offset:49152
    v_mfma_f32_16x16x32_bf16 v[152:155], v[204:207], v[56:59], v[152:155]
    ds_read_b64_tr_b16 v[198:199], v217 offset:49664
    v_mfma_f32_16x16x32_bf16 v[156:159], v[204:207], v[60:63], v[156:159]
    ds_read_b64_tr_b16 v[200:201], v216 offset:36864
    s_waitcnt lgkmcnt(5)
    v_mfma_f32_16x16x32_bf16 v[160:163], v[208:211], v[64:67], v[160:163]
    ds_read_b64_tr_b16 v[202:203], v216 offset:37376
    v_mfma_f32_16x16x32_bf16 v[164:167], v[208:211], v[68:71], v[164:167]
    ds_read_b64_tr_b16 v[204:205], v217 offset:36864
    v_mfma_f32_16x16x32_bf16 v[168:171], v[212:215], v[64:67], v[168:171]
    ds_read_b64_tr_b16 v[206:207], v217 offset:37376
    v_mfma_f32_16x16x32_bf16 v[172:175], v[212:215], v[68:71], v[172:175]
    ds_read_b64_tr_b16 v[208:209], v216 offset:53248
    s_waitcnt lgkmcnt(5)
    v_mfma_f32_16x16x32_bf16 v[176:179], v[192:195], v[64:67], v[176:179]
    ds_read_b64_tr_b16 v[210:211], v216 offset:53760
    v_mfma_f32_16x16x32_bf16 v[180:183], v[192:195], v[68:71], v[180:183]
    ds_read_b64_tr_b16 v[212:213], v217 offset:53248
    v_mfma_f32_16x16x32_bf16 v[184:187], v[196:199], v[64:67], v[184:187]
    ds_read_b64_tr_b16 v[214:215], v217 offset:53760
    v_lshrrev_b32 v249, 4, v242
    v_mfma_f32_16x16x32_bf16 v[188:191], v[196:199], v[68:71], v[188:191]
    ds_read_b64_tr_b16 v[192:193], v216 offset:40960
    v_lshrrev_b32 v250, 5, v249
    s_waitcnt lgkmcnt(5)
    v_mfma_f32_16x16x32_bf16 v[160:163], v[200:203], v[72:75], v[160:163]
    ds_read_b64_tr_b16 v[194:195], v216 offset:41472
    v_bfe_u32 v244, v249, 2, 2
    v_mfma_f32_16x16x32_bf16 v[164:167], v[200:203], v[76:79], v[164:167]
    ds_read_b64_tr_b16 v[196:197], v217 offset:40960
    v_lshl_add_u32 v244, v250, 3, v244
    v_mfma_f32_16x16x32_bf16 v[168:171], v[204:207], v[72:75], v[168:171]
    ds_read_b64_tr_b16 v[198:199], v217 offset:41472
    v_lshlrev_b32 v244, 7, v244
    v_mfma_f32_16x16x32_bf16 v[172:175], v[204:207], v[76:79], v[172:175]
    ds_read_b64_tr_b16 v[200:201], v216 offset:57344
    v_bfe_u32 v250, v249, 3, 1
    s_waitcnt lgkmcnt(5)
    v_mfma_f32_16x16x32_bf16 v[176:179], v[208:211], v[72:75], v[176:179]
    ds_read_b64_tr_b16 v[202:203], v216 offset:57856
    v_lshl_add_u32 v244, v250, 6, v244
    v_mfma_f32_16x16x32_bf16 v[180:183], v[208:211], v[76:79], v[180:183]
    ds_read_b64_tr_b16 v[204:205], v217 offset:57344
    v_bfe_u32 v250, v249, 4, 1
    v_mfma_f32_16x16x32_bf16 v[184:187], v[212:215], v[72:75], v[184:187]
    ds_read_b64_tr_b16 v[206:207], v217 offset:57856
    v_lshl_add_u32 v244, v250, 5, v244
    v_mfma_f32_16x16x32_bf16 v[188:191], v[212:215], v[76:79], v[188:191]
    ds_read_b64_tr_b16 v[208:209], v216 offset:45056
    v_and_b32 v250, 3, v249
    s_waitcnt lgkmcnt(5)
    v_mfma_f32_16x16x32_bf16 v[160:163], v[192:195], v[80:83], v[160:163]
    ds_read_b64_tr_b16 v[210:211], v216 offset:45568
    v_lshl_add_u32 v244, v250, 3, v244
    v_mfma_f32_16x16x32_bf16 v[164:167], v[192:195], v[84:87], v[164:167]
    ds_read_b64_tr_b16 v[212:213], v217 offset:45056
    v_add_u32 v244, s81, v244
    v_mfma_f32_16x16x32_bf16 v[168:171], v[196:199], v[80:83], v[168:171]
    ds_read_b64_tr_b16 v[214:215], v217 offset:45568
    v_xor_b32 v246, 64, v244
    v_mfma_f32_16x16x32_bf16 v[172:175], v[196:199], v[84:87], v[172:175]
    ds_read_b64_tr_b16 v[192:193], v216 offset:61440
    v_lshrrev_b32 v250, 3, v249
    s_waitcnt lgkmcnt(5)
    v_mfma_f32_16x16x32_bf16 v[176:179], v[200:203], v[80:83], v[176:179]
    ds_read_b64_tr_b16 v[194:195], v216 offset:61952
    v_mfma_f32_16x16x32_bf16 v[180:183], v[200:203], v[84:87], v[180:183]
    ds_read_b64_tr_b16 v[196:197], v217 offset:61440
    v_bfe_u32 v243, v249, 4, 1
    v_mfma_f32_16x16x32_bf16 v[184:187], v[204:207], v[80:83], v[184:187]
    ds_read_b64_tr_b16 v[198:199], v217 offset:61952
    v_mfma_f32_16x16x32_bf16 v[188:191], v[204:207], v[84:87], v[188:191]
    ds_read_b64_tr_b16 v[200:201], v218 offset:32768
    v_lshlrev_b32 v243, 2, v243
    s_waitcnt lgkmcnt(5)
    v_mfma_f32_16x16x32_bf16 v[160:163], v[208:211], v[88:91], v[160:163]
    ds_read_b64_tr_b16 v[202:203], v218 offset:33280
    v_mfma_f32_16x16x32_bf16 v[164:167], v[208:211], v[92:95], v[164:167]
    ds_read_b64_tr_b16 v[204:205], v219 offset:32768
    v_xor_b32 v243, v249, v243
    v_mfma_f32_16x16x32_bf16 v[168:171], v[212:215], v[88:91], v[168:171]
    ds_read_b64_tr_b16 v[206:207], v219 offset:33280
    v_mfma_f32_16x16x32_bf16 v[172:175], v[212:215], v[92:95], v[172:175]
    ds_read_b64_tr_b16 v[208:209], v218 offset:49152
    v_and_b32 v243, 7, v243
    s_waitcnt lgkmcnt(5)
    v_mfma_f32_16x16x32_bf16 v[176:179], v[192:195], v[88:91], v[176:179]
    ds_read_b64_tr_b16 v[210:211], v218 offset:49664
    v_mfma_f32_16x16x32_bf16 v[180:183], v[192:195], v[92:95], v[180:183]
    ds_read_b64_tr_b16 v[212:213], v219 offset:49152
    v_lshlrev_b32 v243, 4, v243
    v_mfma_f32_16x16x32_bf16 v[184:187], v[196:199], v[88:91], v[184:187]
    ds_read_b64_tr_b16 v[214:215], v219 offset:49664
    v_mfma_f32_16x16x32_bf16 v[188:191], v[196:199], v[92:95], v[188:191]
    ds_read_b64_tr_b16 v[192:193], v218 offset:36864
    v_lshl_add_u32 v243, v250, 10, v243
    s_waitcnt lgkmcnt(5)
    v_mfma_f32_16x16x32_bf16 v[128:131], v[200:203], v[64:67], v[128:131]
    ds_read_b64_tr_b16 v[194:195], v218 offset:37376
    v_mfma_f32_16x16x32_bf16 v[132:135], v[200:203], v[68:71], v[132:135]
    ds_read_b64_tr_b16 v[196:197], v219 offset:36864
    v_and_b32 v250, 1, v249
    v_mfma_f32_16x16x32_bf16 v[136:139], v[204:207], v[64:67], v[136:139]
    ds_read_b64_tr_b16 v[198:199], v219 offset:37376
    v_mfma_f32_16x16x32_bf16 v[140:143], v[204:207], v[68:71], v[140:143]
    ds_read_b64_tr_b16 v[200:201], v218 offset:53248
    v_lshlrev_b32 v250, 2, v250
    s_waitcnt lgkmcnt(5)
    v_mfma_f32_16x16x32_bf16 v[144:147], v[208:211], v[64:67], v[144:147]
    ds_read_b64_tr_b16 v[202:203], v218 offset:53760
    v_mfma_f32_16x16x32_bf16 v[148:151], v[208:211], v[68:71], v[148:151]
    ds_read_b64_tr_b16 v[204:205], v219 offset:53248
    v_bfe_u32 v253, v249, 1, 1
    v_mfma_f32_16x16x32_bf16 v[152:155], v[212:215], v[64:67], v[152:155]
    ds_read_b64_tr_b16 v[206:207], v219 offset:53760
    v_mfma_f32_16x16x32_bf16 v[156:159], v[212:215], v[68:71], v[156:159]
    ds_read_b64_tr_b16 v[208:209], v218 offset:40960
    v_lshl_add_u32 v253, v253, 7, v250
    s_waitcnt lgkmcnt(5)
    v_mfma_f32_16x16x32_bf16 v[128:131], v[192:195], v[72:75], v[128:131]
    ds_read_b64_tr_b16 v[210:211], v218 offset:41472
    v_mfma_f32_16x16x32_bf16 v[132:135], v[192:195], v[76:79], v[132:135]
    ds_read_b64_tr_b16 v[212:213], v219 offset:40960
    s_lshl_b32 s6, s52, 8
    v_mfma_f32_16x16x32_bf16 v[136:139], v[196:199], v[72:75], v[136:139]
    ds_read_b64_tr_b16 v[214:215], v219 offset:41472
    v_mfma_f32_16x16x32_bf16 v[140:143], v[196:199], v[76:79], v[140:143]
    ds_read_b64_tr_b16 v[192:193], v218 offset:57344
    s_lshl_b32 s7, s48, 3
    s_waitcnt lgkmcnt(5)
    v_mfma_f32_16x16x32_bf16 v[144:147], v[200:203], v[72:75], v[144:147]
    ds_read_b64_tr_b16 v[194:195], v218 offset:57856
    v_mfma_f32_16x16x32_bf16 v[148:151], v[200:203], v[76:79], v[148:151]
    ds_read_b64_tr_b16 v[196:197], v219 offset:57344
    s_add_u32 s6, s6, s7
    v_mfma_f32_16x16x32_bf16 v[152:155], v[204:207], v[72:75], v[152:155]
    ds_read_b64_tr_b16 v[198:199], v219 offset:57856
    v_mfma_f32_16x16x32_bf16 v[156:159], v[204:207], v[76:79], v[156:159]
    ds_read_b64_tr_b16 v[200:201], v218 offset:45056
    s_add_u32 s6, s6, 11808800
    s_waitcnt lgkmcnt(5)
    v_mfma_f32_16x16x32_bf16 v[128:131], v[208:211], v[80:83], v[128:131]
    ds_read_b64_tr_b16 v[202:203], v218 offset:45568
    v_mfma_f32_16x16x32_bf16 v[132:135], v[208:211], v[84:87], v[132:135]
    ds_read_b64_tr_b16 v[204:205], v219 offset:45056
    v_add_u32 v253, s6, v253
    v_mfma_f32_16x16x32_bf16 v[136:139], v[212:215], v[80:83], v[136:139]
    ds_read_b64_tr_b16 v[206:207], v219 offset:45568
    v_mfma_f32_16x16x32_bf16 v[140:143], v[212:215], v[84:87], v[140:143]
    ds_read_b64_tr_b16 v[208:209], v218 offset:61440
    s_waitcnt lgkmcnt(5)
    v_mfma_f32_16x16x32_bf16 v[144:147], v[192:195], v[80:83], v[144:147]
    ds_read_b64_tr_b16 v[210:211], v218 offset:61952
    v_mfma_f32_16x16x32_bf16 v[148:151], v[192:195], v[84:87], v[148:151]
    ds_read_b64_tr_b16 v[212:213], v219 offset:61440
    v_mfma_f32_16x16x32_bf16 v[152:155], v[196:199], v[80:83], v[152:155]
    ds_read_b64_tr_b16 v[214:215], v219 offset:61952
    v_mfma_f32_16x16x32_bf16 v[156:159], v[196:199], v[84:87], v[156:159]
    s_waitcnt lgkmcnt(4)
    v_mfma_f32_16x16x32_bf16 v[128:131], v[200:203], v[88:91], v[128:131]
    v_mfma_f32_16x16x32_bf16 v[132:135], v[200:203], v[92:95], v[132:135]
    s_waitcnt lgkmcnt(0)
    s_barrier
    ds_read_b64_tr_b16 v[192:193], v220 offset:0
    ds_read_b64_tr_b16 v[194:195], v220 offset:512
    ds_read_b64_tr_b16 v[196:197], v221 offset:0
    ds_read_b64_tr_b16 v[198:199], v221 offset:512
    v_mfma_f32_16x16x32_bf16 v[136:139], v[204:207], v[88:91], v[136:139]
    v_mfma_f32_16x16x32_bf16 v[140:143], v[204:207], v[92:95], v[140:143]
    ds_read_b64_tr_b16 v[200:201], v220 offset:16384
    v_mfma_f32_16x16x32_bf16 v[144:147], v[208:211], v[88:91], v[144:147]
    ds_read_b64_tr_b16 v[202:203], v220 offset:16896
    v_mfma_f32_16x16x32_bf16 v[148:151], v[208:211], v[92:95], v[148:151]
    ds_read_b64_tr_b16 v[204:205], v221 offset:16384
    ds_read_b64_tr_b16 v[0:1], v244 offset:0
    ds_read_b64_tr_b16 v[2:3], v244 offset:512
    v_mfma_f32_16x16x32_bf16 v[152:155], v[212:215], v[88:91], v[152:155]
    ds_read_b64_tr_b16 v[206:207], v221 offset:16896
    v_mfma_f32_16x16x32_bf16 v[156:159], v[212:215], v[92:95], v[156:159]
    ds_read_b64_tr_b16 v[208:209], v220 offset:4096
    ds_read_b64_tr_b16 v[4:5], v246 offset:0
    ds_read_b64_tr_b16 v[6:7], v246 offset:512
    s_waitcnt lgkmcnt(9)
    v_mfma_f32_16x16x32_bf16 v[160:163], v[192:195], v[96:99], v[160:163]
    ds_read_b64_tr_b16 v[210:211], v220 offset:4608
    v_mfma_f32_16x16x32_bf16 v[164:167], v[192:195], v[100:103], v[164:167]
    ds_read_b64_tr_b16 v[212:213], v221 offset:4096
    ds_read_b64_tr_b16 v[8:9], v244 offset:2048
    ds_read_b64_tr_b16 v[10:11], v244 offset:2560
    v_mfma_f32_16x16x32_bf16 v[168:171], v[196:199], v[96:99], v[168:171]
    ds_read_b64_tr_b16 v[214:215], v221 offset:4608
    v_mfma_f32_16x16x32_bf16 v[172:175], v[196:199], v[100:103], v[172:175]
    ds_read_b64_tr_b16 v[192:193], v220 offset:20480
    ds_read_b64_tr_b16 v[12:13], v246 offset:2048
    ds_read_b64_tr_b16 v[14:15], v246 offset:2560
    s_waitcnt lgkmcnt(11)
    v_mfma_f32_16x16x32_bf16 v[176:179], v[200:203], v[96:99], v[176:179]
    ds_read_b64_tr_b16 v[194:195], v220 offset:20992
    v_mfma_f32_16x16x32_bf16 v[180:183], v[200:203], v[100:103], v[180:183]
    ds_read_b64_tr_b16 v[196:197], v221 offset:20480
    ds_read_b64_tr_b16 v[16:17], v244 offset:4096
    ds_read_b64_tr_b16 v[18:19], v244 offset:4608
    s_add_u32 m0, s81, 0
    s_add_u32 s64, s80, 131072
    s_waitcnt lgkmcnt(12)
    buffer_load_dwordx4 v243, s[12:15], s64 offen lds
    v_mfma_f32_16x16x32_bf16 v[184:187], v[204:207], v[96:99], v[184:187]
    ds_read_b64_tr_b16 v[198:199], v221 offset:20992
    v_mfma_f32_16x16x32_bf16 v[188:191], v[204:207], v[100:103], v[188:191]
    ds_read_b64_tr_b16 v[200:201], v220 offset:8192
    ds_read_b64_tr_b16 v[20:21], v246 offset:4096
    ds_read_b64_tr_b16 v[22:23], v246 offset:4608
    s_add_u32 m0, s81, 1024
    s_add_u32 s64, s80, 139264
    buffer_load_dwordx4 v243, s[12:15], s64 offen lds
    s_waitcnt lgkmcnt(11)
    v_mfma_f32_16x16x32_bf16 v[160:163], v[208:211], v[104:107], v[160:163]
    ds_read_b64_tr_b16 v[202:203], v220 offset:8704
    v_mfma_f32_16x16x32_bf16 v[164:167], v[208:211], v[108:111], v[164:167]
    ds_read_b64_tr_b16 v[204:205], v221 offset:8192
    buffer_load_dword v250, v253, s[20:23], 0 offen sc1
    ds_read_b64_tr_b16 v[24:25], v244 offset:6144
    ds_read_b64_tr_b16 v[26:27], v244 offset:6656
    s_add_u32 m0, s81, 2048
    s_add_u32 s64, s80, 147456
    s_waitcnt lgkmcnt(12)
    buffer_load_dwordx4 v243, s[12:15], s64 offen lds
    v_mfma_f32_16x16x32_bf16 v[168:171], v[212:215], v[104:107], v[168:171]
    ds_read_b64_tr_b16 v[206:207], v221 offset:8704
    v_mfma_f32_16x16x32_bf16 v[172:175], v[212:215], v[108:111], v[172:175]
    ds_read_b64_tr_b16 v[208:209], v220 offset:24576
    ds_read_b64_tr_b16 v[28:29], v246 offset:6144
    ds_read_b64_tr_b16 v[30:31], v246 offset:6656
    s_add_u32 m0, s81, 3072
    s_add_u32 s64, s80, 155648
    buffer_load_dwordx4 v243, s[12:15], s64 offen lds
    s_waitcnt lgkmcnt(11)
    v_mfma_f32_16x16x32_bf16 v[176:179], v[192:195], v[104:107], v[176:179]
    ds_read_b64_tr_b16 v[210:211], v220 offset:25088
    v_mfma_f32_16x16x32_bf16 v[180:183], v[192:195], v[108:111], v[180:183]
    ds_read_b64_tr_b16 v[212:213], v221 offset:24576
    ds_read_b64_tr_b16 v[32:33], v244 offset:8192
    ds_read_b64_tr_b16 v[34:35], v244 offset:8704
    s_add_u32 m0, s81, 4096
    s_add_u32 s64, s80, 163840
    s_waitcnt lgkmcnt(12)
    buffer_load_dwordx4 v243, s[12:15], s64 offen lds
    v_mfma_f32_16x16x32_bf16 v[184:187], v[196:199], v[104:107], v[184:187]
    ds_read_b64_tr_b16 v[214:215], v221 offset:25088
    v_mfma_f32_16x16x32_bf16 v[188:191], v[196:199], v[108:111], v[188:191]
    ds_read_b64_tr_b16 v[192:193], v220 offset:12288
    ds_read_b64_tr_b16 v[36:37], v246 offset:8192
    ds_read_b64_tr_b16 v[38:39], v246 offset:8704
    s_add_u32 m0, s81, 5120
    s_add_u32 s64, s80, 172032
    buffer_load_dwordx4 v243, s[12:15], s64 offen lds
    s_waitcnt lgkmcnt(11)
    v_mfma_f32_16x16x32_bf16 v[160:163], v[200:203], v[112:115], v[160:163]
    ds_read_b64_tr_b16 v[194:195], v220 offset:12800
    v_mfma_f32_16x16x32_bf16 v[164:167], v[200:203], v[116:119], v[164:167]
    ds_read_b64_tr_b16 v[196:197], v221 offset:12288
    ds_read_b64_tr_b16 v[40:41], v244 offset:10240
    ds_read_b64_tr_b16 v[42:43], v244 offset:10752
    s_add_u32 m0, s81, 6144
    s_add_u32 s64, s80, 180224
    s_waitcnt lgkmcnt(12)
    buffer_load_dwordx4 v243, s[12:15], s64 offen lds
    v_mfma_f32_16x16x32_bf16 v[168:171], v[204:207], v[112:115], v[168:171]
    ds_read_b64_tr_b16 v[198:199], v221 offset:12800
    v_mfma_f32_16x16x32_bf16 v[172:175], v[204:207], v[116:119], v[172:175]
    ds_read_b64_tr_b16 v[200:201], v220 offset:28672
    ds_read_b64_tr_b16 v[44:45], v246 offset:10240
    ds_read_b64_tr_b16 v[46:47], v246 offset:10752
    s_add_u32 m0, s81, 7168
    s_add_u32 s64, s80, 188416
    buffer_load_dwordx4 v243, s[12:15], s64 offen lds
    s_waitcnt lgkmcnt(11)
    v_mfma_f32_16x16x32_bf16 v[176:179], v[208:211], v[112:115], v[176:179]
    ds_read_b64_tr_b16 v[202:203], v220 offset:29184
    v_mfma_f32_16x16x32_bf16 v[180:183], v[208:211], v[116:119], v[180:183]
    ds_read_b64_tr_b16 v[204:205], v221 offset:28672
    ds_read_b64_tr_b16 v[48:49], v244 offset:12288
    ds_read_b64_tr_b16 v[50:51], v244 offset:12800
    s_add_u32 m0, s81, 8192
    s_add_u32 s64, s80, 65536
    s_waitcnt lgkmcnt(12)
    buffer_load_dwordx4 v243, s[12:15], s64 offen lds
    v_mfma_f32_16x16x32_bf16 v[184:187], v[212:215], v[112:115], v[184:187]
    ds_read_b64_tr_b16 v[206:207], v221 offset:29184
    v_mfma_f32_16x16x32_bf16 v[188:191], v[212:215], v[116:119], v[188:191]
    ds_read_b64_tr_b16 v[208:209], v222 offset:0
    ds_read_b64_tr_b16 v[52:53], v246 offset:12288
    ds_read_b64_tr_b16 v[54:55], v246 offset:12800
    s_add_u32 m0, s81, 9216
    s_add_u32 s64, s80, 73728
    buffer_load_dwordx4 v243, s[12:15], s64 offen lds
    s_waitcnt lgkmcnt(11)
    v_mfma_f32_16x16x32_bf16 v[160:163], v[192:195], v[120:123], v[160:163]
    ds_read_b64_tr_b16 v[210:211], v222 offset:512
    v_mfma_f32_16x16x32_bf16 v[164:167], v[192:195], v[124:127], v[164:167]
    ds_read_b64_tr_b16 v[212:213], v223 offset:0
    ds_read_b64_tr_b16 v[56:57], v244 offset:14336
    ds_read_b64_tr_b16 v[58:59], v244 offset:14848
    s_add_u32 m0, s81, 10240
    s_add_u32 s64, s80, 81920
    s_waitcnt lgkmcnt(12)
    buffer_load_dwordx4 v243, s[12:15], s64 offen lds
    v_mfma_f32_16x16x32_bf16 v[168:171], v[196:199], v[120:123], v[168:171]
    ds_read_b64_tr_b16 v[214:215], v223 offset:512
    v_mfma_f32_16x16x32_bf16 v[172:175], v[196:199], v[124:127], v[172:175]
    ds_read_b64_tr_b16 v[192:193], v222 offset:16384
    ds_read_b64_tr_b16 v[60:61], v246 offset:14336
    ds_read_b64_tr_b16 v[62:63], v246 offset:14848
    s_add_u32 m0, s81, 11264
    s_add_u32 s64, s80, 90112
    buffer_load_dwordx4 v243, s[12:15], s64 offen lds
    s_waitcnt lgkmcnt(11)
    v_mfma_f32_16x16x32_bf16 v[176:179], v[200:203], v[120:123], v[176:179]
    ds_read_b64_tr_b16 v[194:195], v222 offset:16896
    v_mfma_f32_16x16x32_bf16 v[180:183], v[200:203], v[124:127], v[180:183]
    ds_read_b64_tr_b16 v[196:197], v223 offset:16384
    s_add_u32 m0, s81, 12288
    s_add_u32 s64, s80, 98304
    s_waitcnt lgkmcnt(10)
    buffer_load_dwordx4 v243, s[12:15], s64 offen lds
    s_waitcnt vmcnt(11)
    v_cmp_ne_u32 vcc, v250, v248
    s_mov_b32 s73, 0
    s_cbranch_vccnz L_eX_x
    buffer_load_dwordx4 v[64:67], v242, s[20:23], s82 offen offset:0 sc1
    buffer_load_dwordx4 v[68:71], v242, s[20:23], s83 offen offset:0 sc1
    buffer_load_dwordx4 v[72:75], v242, s[20:23], s82 offen offset:1024 sc1
    buffer_load_dwordx4 v[76:79], v242, s[20:23], s83 offen offset:1024 sc1
    buffer_load_dwordx4 v[80:83], v242, s[20:23], s82 offen offset:2048 sc1
    buffer_load_dwordx4 v[84:87], v242, s[20:23], s83 offen offset:2048 sc1
    buffer_load_dwordx4 v[88:91], v242, s[20:23], s82 offen offset:3072 sc1
    buffer_load_dwordx4 v[92:95], v242, s[20:23], s83 offen offset:3072 sc1
    s_mov_b32 s73, 1
L_eX_x:
    v_mfma_f32_16x16x32_bf16 v[184:187], v[204:207], v[120:123], v[184:187]
    ds_read_b64_tr_b16 v[198:199], v223 offset:16896
    v_mfma_f32_16x16x32_bf16 v[188:191], v[204:207], v[124:127], v[188:191]
    ds_read_b64_tr_b16 v[200:201], v222 offset:4096
    s_add_u32 m0, s81, 13312
    s_add_u32 s64, s80, 106496
    buffer_load_dwordx4 v243, s[12:15], s64 offen lds
    s_waitcnt lgkmcnt(7)
    v_mfma_f32_16x16x32_bf16 v[128:131], v[208:211], v[96:99], v[128:131]
    ds_read_b64_tr_b16 v[202:203], v222 offset:4608
    v_mfma_f32_16x16x32_bf16 v[132:135], v[208:211], v[100:103], v[132:135]
    ds_read_b64_tr_b16 v[204:205], v223 offset:4096
    s_add_u32 m0, s81, 14336
    s_add_u32 s64, s80, 114688
    s_waitcnt lgkmcnt(6)
    buffer_load_dwordx4 v243, s[12:15], s64 offen lds
    v_mfma_f32_16x16x32_bf16 v[136:139], v[212:215], v[96:99], v[136:139]
    ds_read_b64_tr_b16 v[206:207], v223 offset:4608
    v_max_f32 v160, 0, v160
    v_max_f32 v161, 0, v161
    v_mfma_f32_16x16x32_bf16 v[140:143], v[212:215], v[100:103], v[140:143]
    ds_read_b64_tr_b16 v[208:209], v222 offset:20480
    s_add_u32 m0, s81, 15360
    s_add_u32 s64, s80, 122880
    buffer_load_dwordx4 v243, s[12:15], s64 offen lds
    v_max_f32 v162, 0, v162
    v_max_f32 v163, 0, v163
    v_max_f32 v164, 0, v164
    s_waitcnt lgkmcnt(5)
    v_mfma_f32_16x16x32_bf16 v[144:147], v[192:195], v[96:99], v[144:147]
    ds_read_b64_tr_b16 v[210:211], v222 offset:20992
    v_max_f32 v165, 0, v165
    v_max_f32 v166, 0, v166
    v_mfma_f32_16x16x32_bf16 v[148:151], v[192:195], v[100:103], v[148:151]
    ds_read_b64_tr_b16 v[212:213], v223 offset:20480
    v_max_f32 v167, 0, v167
    v_mul_f32 v160, v160, v176
    v_mul_f32 v161, v161, v177
    v_mfma_f32_16x16x32_bf16 v[152:155], v[196:199], v[96:99], v[152:155]
    ds_read_b64_tr_b16 v[214:215], v223 offset:20992
    v_mul_f32 v162, v162, v178
    v_mul_f32 v163, v163, v179
    v_mfma_f32_16x16x32_bf16 v[156:159], v[196:199], v[100:103], v[156:159]
    ds_read_b64_tr_b16 v[192:193], v222 offset:8192
    v_mul_f32 v164, v164, v180
    v_mul_f32 v165, v165, v181
    v_mul_f32 v166, v166, v182
    s_waitcnt lgkmcnt(5)
    v_mfma_f32_16x16x32_bf16 v[128:131], v[200:203], v[104:107], v[128:131]
    ds_read_b64_tr_b16 v[194:195], v222 offset:8704
    v_mul_f32 v167, v167, v183
    v_mul_f32 v160, v160, v254
    v_mfma_f32_16x16x32_bf16 v[132:135], v[200:203], v[108:111], v[132:135]
    ds_read_b64_tr_b16 v[196:197], v223 offset:8192
    v_mul_f32 v161, v161, v254
    v_mul_f32 v162, v162, v254
    v_mul_f32 v163, v163, v254
    v_mfma_f32_16x16x32_bf16 v[136:139], v[204:207], v[104:107], v[136:139]
    ds_read_b64_tr_b16 v[198:199], v223 offset:8704
    v_cvt_pk_bf16_f32 v224, v160, v161
    v_cvt_pk_bf16_f32 v225, v162, v163
    v_mfma_f32_16x16x32_bf16 v[140:143], v[204:207], v[108:111], v[140:143]
    ds_read_b64_tr_b16 v[200:201], v222 offset:24576
    v_mul_f32 v164, v164, v255
    v_mul_f32 v165, v165, v255
    v_mul_f32 v166, v166, v255
    s_waitcnt lgkmcnt(5)
    v_mfma_f32_16x16x32_bf16 v[144:147], v[208:211], v[104:107], v[144:147]
    ds_read_b64_tr_b16 v[202:203], v222 offset:25088
    v_mul_f32 v167, v167, v255
    v_cvt_pk_bf16_f32 v226, v164, v165
    v_mfma_f32_16x16x32_bf16 v[148:151], v[208:211], v[108:111], v[148:151]
    ds_read_b64_tr_b16 v[204:205], v223 offset:24576
    v_cvt_pk_bf16_f32 v227, v166, v167
    v_max_f32 v168, 0, v168
    v_max_f32 v169, 0, v169
    v_mfma_f32_16x16x32_bf16 v[152:155], v[212:215], v[104:107], v[152:155]
    ds_read_b64_tr_b16 v[206:207], v223 offset:25088
    v_max_f32 v170, 0, v170
    v_max_f32 v171, 0, v171
    v_mfma_f32_16x16x32_bf16 v[156:159], v[212:215], v[108:111], v[156:159]
    ds_read_b64_tr_b16 v[208:209], v222 offset:12288
    v_max_f32 v172, 0, v172
    v_max_f32 v173, 0, v173
    v_max_f32 v174, 0, v174
    s_waitcnt lgkmcnt(5)
    v_mfma_f32_16x16x32_bf16 v[128:131], v[192:195], v[112:115], v[128:131]
    ds_read_b64_tr_b16 v[210:211], v222 offset:12800
    v_max_f32 v175, 0, v175
    v_permlane16_swap_b32 v224, v226
    v_mfma_f32_16x16x32_bf16 v[132:135], v[192:195], v[116:119], v[132:135]
    ds_read_b64_tr_b16 v[212:213], v223 offset:12288
    v_permlane16_swap_b32 v225, v227
    buffer_store_dwordx4 v[224:227], v242, s[20:23], s70 offen offset:0 sc1
    v_mfma_f32_16x16x32_bf16 v[136:139], v[196:199], v[112:115], v[136:139]
    ds_read_b64_tr_b16 v[214:215], v223 offset:12800
    v_mul_f32 v168, v168, v184
    v_mul_f32 v169, v169, v185
    v_mfma_f32_16x16x32_bf16 v[140:143], v[196:199], v[116:119], v[140:143]
    ds_read_b64_tr_b16 v[192:193], v222 offset:28672
    v_mul_f32 v170, v170, v186
    v_mul_f32 v171, v171, v187
    s_waitcnt lgkmcnt(5)
    v_mfma_f32_16x16x32_bf16 v[144:147], v[200:203], v[112:115], v[144:147]
    ds_read_b64_tr_b16 v[194:195], v222 offset:29184
    v_mul_f32 v172, v172, v188
    v_mul_f32 v173, v173, v189
    v_mfma_f32_16x16x32_bf16 v[148:151], v[200:203], v[116:119], v[148:151]
    ds_read_b64_tr_b16 v[196:197], v223 offset:28672
    v_mul_f32 v174, v174, v190
    v_mul_f32 v175, v175, v191
    v_mfma_f32_16x16x32_bf16 v[152:155], v[204:207], v[112:115], v[152:155]
    ds_read_b64_tr_b16 v[198:199], v223 offset:29184
    v_mul_f32 v168, v168, v254
    v_mul_f32 v169, v169, v254
    v_mfma_f32_16x16x32_bf16 v[156:159], v[204:207], v[116:119], v[156:159]
    v_mul_f32 v170, v170, v254
    v_mul_f32 v171, v171, v254
    s_waitcnt lgkmcnt(4)
    v_mfma_f32_16x16x32_bf16 v[128:131], v[208:211], v[120:123], v[128:131]
    v_mfma_f32_16x16x32_bf16 v[132:135], v[208:211], v[124:127], v[132:135]
    s_waitcnt lgkmcnt(0)
    s_barrier
    v_readfirstlane_b32 s62, v248
    s_lshl_b32 s6, s52, 8
    s_lshl_b32 s7, s48, 3
    s_add_u32 s6, s6, s7
    s_add_u32 s6, s6, 11808800
    s_add_u32 s4, s20, s6
    s_addc_u32 s5, s21, 0
    s_mov_b32 s63, s62
    v_mfma_f32_16x16x32_bf16 v[136:139], v[212:215], v[120:123], v[136:139]
    v_cvt_pk_bf16_f32 v228, v168, v169
    v_cvt_pk_bf16_f32 v229, v170, v171
    v_mfma_f32_16x16x32_bf16 v[140:143], v[212:215], v[124:127], v[140:143]
    v_mul_f32 v172, v172, v255
    v_mul_f32 v173, v173, v255
    v_mfma_f32_16x16x32_bf16 v[144:147], v[192:195], v[120:123], v[144:147]
    v_mul_f32 v174, v174, v255
    v_mul_f32 v175, v175, v255
    v_mfma_f32_16x16x32_bf16 v[148:151], v[192:195], v[124:127], v[148:151]
    v_cvt_pk_bf16_f32 v230, v172, v173
    v_cvt_pk_bf16_f32 v231, v174, v175
    v_mfma_f32_16x16x32_bf16 v[152:155], v[196:199], v[120:123], v[152:155]
    s_nop 0
    v_permlane16_swap_b32 v228, v230
    v_mfma_f32_16x16x32_bf16 v[156:159], v[196:199], v[124:127], v[156:159]
    v_permlane16_swap_b32 v229, v231
    buffer_store_dwordx4 v[228:231], v242, s[20:23], s70 offen offset:1024 sc1
    v_max_f32 v128, 0, v128
    v_max_f32 v129, 0, v129
    v_max_f32 v130, 0, v130
    v_max_f32 v131, 0, v131
    v_max_f32 v132, 0, v132
    v_max_f32 v133, 0, v133
    v_max_f32 v134, 0, v134
    v_max_f32 v135, 0, v135
    v_mul_f32 v128, v128, v144
    v_mul_f32 v129, v129, v145
    v_mul_f32 v130, v130, v146
    v_mul_f32 v131, v131, v147
    v_mul_f32 v132, v132, v148
    v_mul_f32 v133, v133, v149
    v_mul_f32 v134, v134, v150
    v_mul_f32 v135, v135, v151
    v_mul_f32 v128, v128, v254
    v_mul_f32 v129, v129, v254
    v_mul_f32 v130, v130, v254
    v_mul_f32 v131, v131, v254
    v_cvt_pk_bf16_f32 v232, v128, v129
    v_cvt_pk_bf16_f32 v233, v130, v131
    v_mul_f32 v132, v132, v255
    v_mul_f32 v133, v133, v255
    v_mul_f32 v134, v134, v255
    v_mul_f32 v135, v135, v255
    v_cvt_pk_bf16_f32 v234, v132, v133
    v_cvt_pk_bf16_f32 v235, v134, v135
    v_max_f32 v136, 0, v136
    v_max_f32 v137, 0, v137
    v_max_f32 v138, 0, v138
    v_max_f32 v139, 0, v139
    v_max_f32 v140, 0, v140
    v_max_f32 v141, 0, v141
    v_max_f32 v142, 0, v142
    v_max_f32 v143, 0, v143
    v_permlane16_swap_b32 v232, v234
    v_permlane16_swap_b32 v233, v235
    buffer_store_dwordx4 v[232:235], v242, s[20:23], s70 offen offset:2048 sc1
    v_mul_f32 v136, v136, v152
    v_mul_f32 v137, v137, v153
    v_mul_f32 v138, v138, v154
    v_mul_f32 v139, v139, v155
    v_mul_f32 v140, v140, v156
    v_mul_f32 v141, v141, v157
    v_mul_f32 v142, v142, v158
    v_mul_f32 v143, v143, v159
    v_mul_f32 v136, v136, v254
    v_mul_f32 v137, v137, v254
    v_mul_f32 v138, v138, v254
    v_mul_f32 v139, v139, v254
    v_cvt_pk_bf16_f32 v236, v136, v137
    v_cvt_pk_bf16_f32 v237, v138, v139
    v_mul_f32 v140, v140, v255
    v_mul_f32 v141, v141, v255
    v_mul_f32 v142, v142, v255
    v_mul_f32 v143, v143, v255
    v_cvt_pk_bf16_f32 v238, v140, v141
    v_cvt_pk_bf16_f32 v239, v142, v143
    s_nop 0
    v_permlane16_swap_b32 v236, v238
    v_permlane16_swap_b32 v237, v239
    buffer_store_dwordx4 v[236:239], v242, s[20:23], s70 offen offset:3072 sc1
    s_branch L_BC
L_compY:
    s_setprio 1
    v_lshlrev_b32 v242, 4, v1
    v_lshrrev_b32 v2, 4, v1
    s_add_u32 m0, s97, 8192
    s_add_u32 s66, s96, 512
    buffer_load_dwordx4 v10, s[8:11], s66 offen lds
    v_and_b32 v3, 15, v1
    v_bfe_u32 v4, v1, 2, 2
    v_lshl_add_u32 v4, v2, 3, v4
    s_add_u32 m0, s97, 9216
    s_add_u32 s66, s96, 4608
    buffer_load_dwordx4 v11, s[8:11], s66 offen lds
    v_and_b32 v5, 3, v1
    v_lshlrev_b32 v5, 3, v5
    v_and_b32 v6, 1, v2
    s_add_u32 m0, s97, 10240
    s_add_u32 s66, s96, 8704
    buffer_load_dwordx4 v12, s[8:11], s66 offen lds
    v_lshl_add_u32 v6, v6, 5, v5
    v_lshl_add_u32 v243, v4, 6, v6
    v_xor_b32 v245, 32, v243
    s_add_u32 m0, s97, 11264
    s_add_u32 s66, s96, 12800
    buffer_load_dwordx4 v13, s[8:11], s66 offen lds
    v_bfe_u32 v6, v1, 3, 1
    v_and_b32 v7, 1, v2
    v_lshl_add_u32 v6, v6, 1, v7
    s_add_u32 m0, s97, 12288
    s_add_u32 s66, s96, 768
    buffer_load_dwordx4 v10, s[8:11], s66 offen lds
    v_lshl_add_u32 v5, v6, 5, v5
    v_lshl_add_u32 v216, v4, 7, v5
    v_add_u32 v220, 0x20000, v216
    s_add_u32 m0, s97, 13312
    s_add_u32 s66, s96, 4864
    buffer_load_dwordx4 v11, s[8:11], s66 offen lds
    v_xor_b32 v217, 32, v216
    v_xor_b32 v221, 32, v220
    v_xor_b32 v218, 64, v216
    s_add_u32 m0, s97, 14336
    s_add_u32 s66, s96, 8960
    buffer_load_dwordx4 v12, s[8:11], s66 offen lds
    v_xor_b32 v222, 64, v220
    v_xor_b32 v219, 96, v216
    v_xor_b32 v223, 96, v220
    s_add_u32 m0, s97, 15360
    s_add_u32 s66, s96, 13056
    buffer_load_dwordx4 v13, s[8:11], s66 offen lds
    v_xor_b32 v4, v2, v3
    v_lshlrev_b32 v4, 4, v4
    v_and_b32 v5, 3, v1
    v_lshl_add_u32 v4, v5, 8, v4
    v_bfe_u32 v5, v1, 2, 2
    v_lshl_add_u32 v4, v5, 10, v4
    s_lshl_b32 s6, s48, 14
    v_add_u32 v246, s6, v4
    v_xor_b32 v247, 64, v246
    v_xor_b32 v248, 128, v246
    v_xor_b32 v249, 192, v246
    v_and_b32 v4, 1, v1
    v_lshlrev_b32 v4, 4, v4
    v_mov_b32 v6, 0x3f80
    v_lshlrev_b32 v6, v4, v6
    v_cmp_eq_u32 vcc, v5, v2
    s_nop 1
    v_cndmask_b32 v6, 0, v6, vcc
    v_bfe_u32 v4, v1, 1, 1
    v_cmp_eq_u32 vcc, 0, v4
    s_nop 1
    v_cndmask_b32 v224, 0, v6, vcc
    v_cndmask_b32 v225, v6, 0, vcc
    v_mov_b32 v226, 0
    v_mov_b32 v227, 0
    v_mov_b32 v228, 0
    v_mov_b32 v229, 0
    v_mov_b32 v230, v224
    v_mov_b32 v231, v225
    s_lshl_b32 s6, s49, 2
    s_add_u32 s6, s6, s48
    s_mul_i32 s6, s6, 147456
    s_lshl_b32 s7, s3, 6
    s_add_u32 s68, s6, s7
    s_lshl_b32 s7, s4, 6
    s_add_u32 s69, s6, s7
    s_lshl_b32 s7, s5, 6
    s_add_u32 s70, s6, s7
    s_mov_b32 s74, 0x3f803f80
    s_waitcnt vmcnt(12)
    ds_read_b128 v[0:3], v246 offset:0
    ds_read_b128 v[8:11], v247 offset:0
    ds_read_b128 v[16:19], v248 offset:0
    ds_read_b128 v[24:27], v249 offset:0
    s_waitcnt lgkmcnt(3)
    v_dot2_f32_bf16 v128, v0, s74, 0
    v_dot2_f32_bf16 v130, v0, v0, 0
    v_dot2_f32_bf16 v132, v1, s74, 0
    v_dot2_f32_bf16 v134, v1, v1, 0
    v_dot2_f32_bf16 v128, v2, s74, v128
    v_dot2_f32_bf16 v130, v2, v2, v130
    v_dot2_f32_bf16 v132, v3, s74, v132
    v_dot2_f32_bf16 v134, v3, v3, v134
    s_waitcnt lgkmcnt(2)
    v_dot2_f32_bf16 v128, v8, s74, v128
    v_dot2_f32_bf16 v130, v8, v8, v130
    v_dot2_f32_bf16 v132, v9, s74, v132
    v_dot2_f32_bf16 v134, v9, v9, v134
    v_dot2_f32_bf16 v128, v10, s74, v128
    v_dot2_f32_bf16 v130, v10, v10, v130
    v_dot2_f32_bf16 v132, v11, s74, v132
    v_dot2_f32_bf16 v134, v11, v11, v134
    s_waitcnt lgkmcnt(1)
    v_dot2_f32_bf16 v128, v16, s74, v128
    v_dot2_f32_bf16 v130, v16, v16, v130
    v_dot2_f32_bf16 v132, v17, s74, v132
    v_dot2_f32_bf16 v134, v17, v17, v134
    v_dot2_f32_bf16 v128, v18, s74, v128
    v_dot2_f32_bf16 v130, v18, v18, v130
    v_dot2_f32_bf16 v132, v19, s74, v132
    v_dot2_f32_bf16 v134, v19, v19, v134
    s_waitcnt lgkmcnt(0)
    v_dot2_f32_bf16 v128, v24, s74, v128
    v_dot2_f32_bf16 v130, v24, v24, v130
    v_dot2_f32_bf16 v132, v25, s74, v132
    v_dot2_f32_bf16 v134, v25, v25, v134
    v_dot2_f32_bf16 v128, v26, s74, v128
    v_dot2_f32_bf16 v130, v26, v26, v130
    v_dot2_f32_bf16 v132, v27, s74, v132
    v_dot2_f32_bf16 v134, v27, v27, v134
    s_waitcnt vmcnt(8)
    ds_read_b128 v[32:35], v246 offset:4096
    ds_read_b128 v[40:43], v247 offset:4096
    ds_read_b128 v[48:51], v248 offset:4096
    ds_read_b128 v[56:59], v249 offset:4096
    s_waitcnt lgkmcnt(3)
    v_dot2_f32_bf16 v128, v32, s74, v128
    v_dot2_f32_bf16 v130, v32, v32, v130
    v_dot2_f32_bf16 v132, v33, s74, v132
    v_dot2_f32_bf16 v134, v33, v33, v134
    v_dot2_f32_bf16 v128, v34, s74, v128
    v_dot2_f32_bf16 v130, v34, v34, v130
    v_dot2_f32_bf16 v132, v35, s74, v132
    v_dot2_f32_bf16 v134, v35, v35, v134
    s_waitcnt lgkmcnt(2)
    v_dot2_f32_bf16 v128, v40, s74, v128
    v_dot2_f32_bf16 v130, v40, v40, v130
    v_dot2_f32_bf16 v132, v41, s74, v132
    v_dot2_f32_bf16 v134, v41, v41, v134
    v_dot2_f32_bf16 v128, v42, s74, v128
    v_dot2_f32_bf16 v130, v42, v42, v130
    v_dot2_f32_bf16 v132, v43, s74, v132
    v_dot2_f32_bf16 v134, v43, v43, v134
    s_waitcnt lgkmcnt(1)
    v_dot2_f32_bf16 v128, v48, s74, v128
    v_dot2_f32_bf16 v130, v48, v48, v130
    v_dot2_f32_bf16 v132, v49, s74, v132
    v_dot2_f32_bf16 v134, v49, v49, v134
    v_dot2_f32_bf16 v128, v50, s74, v128
    v_dot2_f32_bf16 v130, v50, v50, v130
    v_dot2_f32_bf16 v132, v51, s74, v132
    v_dot2_f32_bf16 v134, v51, v51, v134
    s_waitcnt lgkmcnt(0)
    v_dot2_f32_bf16 v128, v56, s74, v128
    v_dot2_f32_bf16 v130, v56, v56, v130
    v_dot2_f32_bf16 v132, v57, s74, v132
    v_dot2_f32_bf16 v134, v57, v57, v134
    v_dot2_f32_bf16 v128, v58, s74, v128
    v_dot2_f32_bf16 v130, v58, v58, v130
    v_dot2_f32_bf16 v132, v59, s74, v132
    v_dot2_f32_bf16 v134, v59, v59, v134
    s_waitcnt vmcnt(4)
    ds_read_b128 v[64:67], v246 offset:8192
    ds_read_b128 v[72:75], v247 offset:8192
    ds_read_b128 v[80:83], v248 offset:8192
    ds_read_b128 v[88:91], v249 offset:8192
    s_waitcnt lgkmcnt(3)
    v_dot2_f32_bf16 v128, v64, s74, v128
    v_dot2_f32_bf16 v130, v64, v64, v130
    v_dot2_f32_bf16 v132, v65, s74, v132
    v_dot2_f32_bf16 v134, v65, v65, v134
    v_dot2_f32_bf16 v128, v66, s74, v128
    v_dot2_f32_bf16 v130, v66, v66, v130
    v_dot2_f32_bf16 v132, v67, s74, v132
    v_dot2_f32_bf16 v134, v67, v67, v134
    s_waitcnt lgkmcnt(2)
    v_dot2_f32_bf16 v128, v72, s74, v128
    v_dot2_f32_bf16 v130, v72, v72, v130
    v_dot2_f32_bf16 v132, v73, s74, v132
    v_dot2_f32_bf16 v134, v73, v73, v134
    v_dot2_f32_bf16 v128, v74, s74, v128
    v_dot2_f32_bf16 v130, v74, v74, v130
    v_dot2_f32_bf16 v132, v75, s74, v132
    v_dot2_f32_bf16 v134, v75, v75, v134
    s_waitcnt lgkmcnt(1)
    v_dot2_f32_bf16 v128, v80, s74, v128
    v_dot2_f32_bf16 v130, v80, v80, v130
    v_dot2_f32_bf16 v132, v81, s74, v132
    v_dot2_f32_bf16 v134, v81, v81, v134
    v_dot2_f32_bf16 v128, v82, s74, v128
    v_dot2_f32_bf16 v130, v82, v82, v130
    v_dot2_f32_bf16 v132, v83, s74, v132
    v_dot2_f32_bf16 v134, v83, v83, v134
    s_waitcnt lgkmcnt(0)
    v_dot2_f32_bf16 v128, v88, s74, v128
    v_dot2_f32_bf16 v130, v88, v88, v130
    v_dot2_f32_bf16 v132, v89, s74, v132
    v_dot2_f32_bf16 v134, v89, v89, v134
    v_dot2_f32_bf16 v128, v90, s74, v128
    v_dot2_f32_bf16 v130, v90, v90, v130
    v_dot2_f32_bf16 v132, v91, s74, v132
    v_dot2_f32_bf16 v134, v91, v91, v134
    s_waitcnt vmcnt(0)
    ds_read_b128 v[96:99], v246 offset:12288
    ds_read_b128 v[104:107], v247 offset:12288
    ds_read_b128 v[112:115], v248 offset:12288
    ds_read_b128 v[120:123], v249 offset:12288
    v_add_u32 v246, 0x10000, v246
    v_add_u32 v247, 0x10000, v247
    v_add_u32 v248, 0x10000, v248
    v_add_u32 v249, 0x10000, v249
    s_waitcnt lgkmcnt(3)
    v_dot2_f32_bf16 v128, v96, s74, v128
    v_dot2_f32_bf16 v130, v96, v96, v130
    v_dot2_f32_bf16 v132, v97, s74, v132
    v_dot2_f32_bf16 v134, v97, v97, v134
    v_dot2_f32_bf16 v128, v98, s74, v128
    v_dot2_f32_bf16 v130, v98, v98, v130
    v_dot2_f32_bf16 v132, v99, s74, v132
    v_dot2_f32_bf16 v134, v99, v99, v134
    s_waitcnt lgkmcnt(2)
    v_dot2_f32_bf16 v128, v104, s74, v128
    v_dot2_f32_bf16 v130, v104, v104, v130
    v_dot2_f32_bf16 v132, v105, s74, v132
    v_dot2_f32_bf16 v134, v105, v105, v134
    v_dot2_f32_bf16 v128, v106, s74, v128
    v_dot2_f32_bf16 v130, v106, v106, v130
    v_dot2_f32_bf16 v132, v107, s74, v132
    v_dot2_f32_bf16 v134, v107, v107, v134
    s_waitcnt lgkmcnt(1)
    v_dot2_f32_bf16 v128, v112, s74, v128
    v_dot2_f32_bf16 v130, v112, v112, v130
    v_dot2_f32_bf16 v132, v113, s74, v132
    v_dot2_f32_bf16 v134, v113, v113, v134
    v_dot2_f32_bf16 v128, v114, s74, v128
    v_dot2_f32_bf16 v130, v114, v114, v130
    v_dot2_f32_bf16 v132, v115, s74, v132
    v_dot2_f32_bf16 v134, v115, v115, v134
    s_waitcnt lgkmcnt(0)
    v_dot2_f32_bf16 v128, v120, s74, v128
    v_dot2_f32_bf16 v130, v120, v120, v130
    v_dot2_f32_bf16 v132, v121, s74, v132
    v_dot2_f32_bf16 v134, v121, v121, v134
    v_dot2_f32_bf16 v128, v122, s74, v128
    v_dot2_f32_bf16 v130, v122, v122, v130
    v_dot2_f32_bf16 v132, v123, s74, v132
    v_dot2_f32_bf16 v134, v123, v123, v134
    s_nop 1
    v_add_f32 v128, v128, v132
    v_add_f32 v130, v130, v134
    s_nop 1
    v_permlane32_swap_b32 v128, v130
    v_add_f32 v128, v128, v130
    v_mov_b32 v130, v128
    s_nop 1
    v_permlane16_swap_b32 v128, v130
    v_add_f32 v128, v128, v130
    v_mul_f32 v128, 0x3b000000, v128
    v_mov_b32 v130, v128
    s_nop 1
    v_permlane32_swap_b32 v128, v130
    v_cvt_pk_bf16_f32 v136, -v128, -v128
    v_and_b32 v136, 0xffff0000, v136
    v_mov_b32 v137, v136
    v_mov_b32 v138, v136
    v_mov_b32 v139, v136
    s_nop 1
    v_mfma_f32_16x16x32_bf16 v[144:147], v[224:227], v[0:3], v[136:139]
    v_mov_b32 v251, 0
    v_mfma_f32_16x16x32_bf16 v[148:151], v[228:231], v[0:3], v[136:139]
    v_fma_f32 v130, -v128, v128, v130
    v_mfma_f32_16x16x32_bf16 v[152:155], v[224:227], v[8:11], v[136:139]
    v_max_f32 v130, 0, v130
    v_mfma_f32_16x16x32_bf16 v[156:159], v[228:231], v[8:11], v[136:139]
    v_cvt_pk_bf16_f32 v130, v130, v130
    v_mfma_f32_16x16x32_bf16 v[160:163], v[224:227], v[16:19], v[136:139]
    v_cvt_pk_bf16_f32 v0, v144, v145
    v_cvt_pk_bf16_f32 v1, v146, v147
    v_and_b32 v130, 0xffff0000, v130
    v_mfma_f32_16x16x32_bf16 v[164:167], v[228:231], v[16:19], v[136:139]
    v_cvt_pk_bf16_f32 v2, v148, v149
    v_cvt_pk_bf16_f32 v3, v150, v151
    v_add_f32 v130, 0x3727c5ac, v130
    v_mfma_f32_16x16x32_bf16 v[168:171], v[224:227], v[24:27], v[136:139]
    v_cvt_pk_bf16_f32 v8, v152, v153
    v_cvt_pk_bf16_f32 v9, v154, v155
    v_cvt_pk_bf16_f32 v130, v130, v130
    v_mfma_f32_16x16x32_bf16 v[172:175], v[228:231], v[24:27], v[136:139]
    v_cvt_pk_bf16_f32 v10, v156, v157
    v_cvt_pk_bf16_f32 v11, v158, v159
    v_and_b32 v130, 0xffff0000, v130
    v_mfma_f32_16x16x32_bf16 v[176:179], v[224:227], v[32:35], v[136:139]
    v_cvt_pk_bf16_f32 v16, v160, v161
    v_cvt_pk_bf16_f32 v17, v162, v163
    v_sqrt_f32 v130, v130
    v_mfma_f32_16x16x32_bf16 v[180:183], v[228:231], v[32:35], v[136:139]
    v_cvt_pk_bf16_f32 v18, v164, v165
    v_cvt_pk_bf16_f32 v19, v166, v167
    s_nop 0
    v_mfma_f32_16x16x32_bf16 v[144:147], v[224:227], v[40:43], v[136:139]
    v_cvt_pk_bf16_f32 v24, v168, v169
    v_cvt_pk_bf16_f32 v25, v170, v171
    v_cvt_pk_bf16_f32 v234, v130, v130
    v_mfma_f32_16x16x32_bf16 v[148:151], v[228:231], v[40:43], v[136:139]
    v_cvt_pk_bf16_f32 v26, v172, v173
    v_cvt_pk_bf16_f32 v27, v174, v175
    v_mov_b32 v235, v234
    v_mfma_f32_16x16x32_bf16 v[152:155], v[224:227], v[48:51], v[136:139]
    v_cvt_pk_bf16_f32 v32, v176, v177
    v_cvt_pk_bf16_f32 v33, v178, v179
    v_and_b32 v130, 0xffff0000, v234
    v_mfma_f32_16x16x32_bf16 v[156:159], v[228:231], v[48:51], v[136:139]
    v_cvt_pk_bf16_f32 v34, v180, v181
    v_cvt_pk_bf16_f32 v35, v182, v183
    v_rcp_f32 v130, v130
    v_mfma_f32_16x16x32_bf16 v[160:163], v[224:227], v[56:59], v[136:139]
    v_cvt_pk_bf16_f32 v40, v144, v145
    v_cvt_pk_bf16_f32 v41, v146, v147
    s_nop 0
    v_mfma_f32_16x16x32_bf16 v[164:167], v[228:231], v[56:59], v[136:139]
    v_cvt_pk_bf16_f32 v42, v148, v149
    v_cvt_pk_bf16_f32 v43, v150, v151
    v_mul_f32 v254, v130, v130
    v_mfma_f32_16x16x32_bf16 v[168:171], v[224:227], v[64:67], v[136:139]
    v_cvt_pk_bf16_f32 v48, v152, v153
    v_cvt_pk_bf16_f32 v49, v154, v155
    v_mfma_f32_16x16x32_bf16 v[172:175], v[228:231], v[64:67], v[136:139]
    v_cvt_pk_bf16_f32 v50, v156, v157
    v_cvt_pk_bf16_f32 v51, v158, v159
    v_mfma_f32_16x16x32_bf16 v[176:179], v[224:227], v[72:75], v[136:139]
    v_cvt_pk_bf16_f32 v56, v160, v161
    v_cvt_pk_bf16_f32 v57, v162, v163
    v_mfma_f32_16x16x32_bf16 v[180:183], v[228:231], v[72:75], v[136:139]
    v_cvt_pk_bf16_f32 v58, v164, v165
    v_cvt_pk_bf16_f32 v59, v166, v167
    v_mfma_f32_16x16x32_bf16 v[144:147], v[224:227], v[80:83], v[136:139]
    v_cvt_pk_bf16_f32 v64, v168, v169
    v_cvt_pk_bf16_f32 v65, v170, v171
    v_mfma_f32_16x16x32_bf16 v[148:151], v[228:231], v[80:83], v[136:139]
    v_cvt_pk_bf16_f32 v66, v172, v173
    v_cvt_pk_bf16_f32 v67, v174, v175
    v_mfma_f32_16x16x32_bf16 v[152:155], v[224:227], v[88:91], v[136:139]
    v_cvt_pk_bf16_f32 v72, v176, v177
    v_cvt_pk_bf16_f32 v73, v178, v179
    v_mfma_f32_16x16x32_bf16 v[156:159], v[228:231], v[88:91], v[136:139]
    v_cvt_pk_bf16_f32 v74, v180, v181
    v_cvt_pk_bf16_f32 v75, v182, v183
    v_mfma_f32_16x16x32_bf16 v[160:163], v[224:227], v[96:99], v[136:139]
    v_cvt_pk_bf16_f32 v80, v144, v145
    v_cvt_pk_bf16_f32 v81, v146, v147
    v_mfma_f32_16x16x32_bf16 v[164:167], v[228:231], v[96:99], v[136:139]
    v_cvt_pk_bf16_f32 v82, v148, v149
    v_cvt_pk_bf16_f32 v83, v150, v151
    v_mfma_f32_16x16x32_bf16 v[168:171], v[224:227], v[104:107], v[136:139]
    v_cvt_pk_bf16_f32 v88, v152, v153
    v_cvt_pk_bf16_f32 v89, v154, v155
    v_mfma_f32_16x16x32_bf16 v[172:175], v[228:231], v[104:107], v[136:139]
    v_cvt_pk_bf16_f32 v90, v156, v157
    v_cvt_pk_bf16_f32 v91, v158, v159
    v_mfma_f32_16x16x32_bf16 v[176:179], v[224:227], v[112:115], v[136:139]
    v_cvt_pk_bf16_f32 v96, v160, v161
    v_cvt_pk_bf16_f32 v97, v162, v163
    v_mfma_f32_16x16x32_bf16 v[180:183], v[228:231], v[112:115], v[136:139]
    v_cvt_pk_bf16_f32 v98, v164, v165
    v_cvt_pk_bf16_f32 v99, v166, v167
    v_mfma_f32_16x16x32_bf16 v[144:147], v[224:227], v[120:123], v[136:139]
    v_cvt_pk_bf16_f32 v104, v168, v169
    v_cvt_pk_bf16_f32 v105, v170, v171
    v_mfma_f32_16x16x32_bf16 v[148:151], v[228:231], v[120:123], v[136:139]
    v_cvt_pk_bf16_f32 v106, v172, v173
    v_cvt_pk_bf16_f32 v107, v174, v175
    v_cvt_pk_bf16_f32 v112, v176, v177
    v_cvt_pk_bf16_f32 v113, v178, v179
    v_cvt_pk_bf16_f32 v114, v180, v181
    v_cvt_pk_bf16_f32 v115, v182, v183
    s_barrier
    ds_read_b128 v[4:7], v246 offset:0
    ds_read_b128 v[12:15], v247 offset:0
    ds_read_b128 v[20:23], v248 offset:0
    ds_read_b128 v[28:31], v249 offset:0
    ds_read_b128 v[36:39], v246 offset:4096
    ds_read_b128 v[44:47], v247 offset:4096
    ds_read_b128 v[52:55], v248 offset:4096
    ds_read_b128 v[60:63], v249 offset:4096
    ds_read_b128 v[68:71], v246 offset:8192
    ds_read_b128 v[76:79], v247 offset:8192
    ds_read_b128 v[84:87], v248 offset:8192
    ds_read_b128 v[92:95], v249 offset:8192
    v_cvt_pk_bf16_f32 v120, v144, v145
    v_cvt_pk_bf16_f32 v121, v146, v147
    v_cvt_pk_bf16_f32 v122, v148, v149
    v_cvt_pk_bf16_f32 v123, v150, v151
    s_waitcnt lgkmcnt(11)
    v_dot2_f32_bf16 v129, v4, s74, 0
    v_dot2_f32_bf16 v131, v4, v4, 0
    v_dot2_f32_bf16 v133, v5, s74, 0
    v_dot2_f32_bf16 v135, v5, v5, 0
    v_dot2_f32_bf16 v129, v6, s74, v129
    v_dot2_f32_bf16 v131, v6, v6, v131
    v_dot2_f32_bf16 v133, v7, s74, v133
    v_dot2_f32_bf16 v135, v7, v7, v135
    s_waitcnt lgkmcnt(10)
    v_dot2_f32_bf16 v129, v12, s74, v129
    v_dot2_f32_bf16 v131, v12, v12, v131
    v_dot2_f32_bf16 v133, v13, s74, v133
    v_dot2_f32_bf16 v135, v13, v13, v135
    v_dot2_f32_bf16 v129, v14, s74, v129
    v_dot2_f32_bf16 v131, v14, v14, v131
    v_dot2_f32_bf16 v133, v15, s74, v133
    v_dot2_f32_bf16 v135, v15, v15, v135
    s_waitcnt lgkmcnt(9)
    v_dot2_f32_bf16 v129, v20, s74, v129
    v_dot2_f32_bf16 v131, v20, v20, v131
    v_dot2_f32_bf16 v133, v21, s74, v133
    v_dot2_f32_bf16 v135, v21, v21, v135
    v_dot2_f32_bf16 v129, v22, s74, v129
    v_dot2_f32_bf16 v131, v22, v22, v131
    v_dot2_f32_bf16 v133, v23, s74, v133
    v_dot2_f32_bf16 v135, v23, v23, v135
    s_waitcnt lgkmcnt(8)
    v_dot2_f32_bf16 v129, v28, s74, v129
    v_dot2_f32_bf16 v131, v28, v28, v131
    v_dot2_f32_bf16 v133, v29, s74, v133
    v_dot2_f32_bf16 v135, v29, v29, v135
    v_dot2_f32_bf16 v129, v30, s74, v129
    v_dot2_f32_bf16 v131, v30, v30, v131
    v_dot2_f32_bf16 v133, v31, s74, v133
    v_dot2_f32_bf16 v135, v31, v31, v135
    ds_read_b128 v[100:103], v246 offset:12288
    ds_read_b128 v[108:111], v247 offset:12288
    ds_read_b128 v[116:119], v248 offset:12288
    ds_read_b128 v[124:127], v249 offset:12288
    s_waitcnt lgkmcnt(11)
    v_dot2_f32_bf16 v129, v36, s74, v129
    v_dot2_f32_bf16 v131, v36, v36, v131
    v_dot2_f32_bf16 v133, v37, s74, v133
    v_dot2_f32_bf16 v135, v37, v37, v135
    v_dot2_f32_bf16 v129, v38, s74, v129
    v_dot2_f32_bf16 v131, v38, v38, v131
    v_dot2_f32_bf16 v133, v39, s74, v133
    v_dot2_f32_bf16 v135, v39, v39, v135
    s_waitcnt lgkmcnt(10)
    v_dot2_f32_bf16 v129, v44, s74, v129
    v_dot2_f32_bf16 v131, v44, v44, v131
    v_dot2_f32_bf16 v133, v45, s74, v133
    v_dot2_f32_bf16 v135, v45, v45, v135
    v_dot2_f32_bf16 v129, v46, s74, v129
    v_dot2_f32_bf16 v131, v46, v46, v131
    v_dot2_f32_bf16 v133, v47, s74, v133
    v_dot2_f32_bf16 v135, v47, v47, v135
    s_waitcnt lgkmcnt(9)
    v_dot2_f32_bf16 v129, v52, s74, v129
    v_dot2_f32_bf16 v131, v52, v52, v131
    v_dot2_f32_bf16 v133, v53, s74, v133
    v_dot2_f32_bf16 v135, v53, v53, v135
    v_dot2_f32_bf16 v129, v54, s74, v129
    v_dot2_f32_bf16 v131, v54, v54, v131
    v_dot2_f32_bf16 v133, v55, s74, v133
    v_dot2_f32_bf16 v135, v55, v55, v135
    s_waitcnt lgkmcnt(8)
    v_dot2_f32_bf16 v129, v60, s74, v129
    v_dot2_f32_bf16 v131, v60, v60, v131
    v_dot2_f32_bf16 v133, v61, s74, v133
    v_dot2_f32_bf16 v135, v61, v61, v135
    v_dot2_f32_bf16 v129, v62, s74, v129
    v_dot2_f32_bf16 v131, v62, v62, v131
    v_dot2_f32_bf16 v133, v63, s74, v133
    v_dot2_f32_bf16 v135, v63, v63, v135
    s_waitcnt lgkmcnt(7)
    v_dot2_f32_bf16 v129, v68, s74, v129
    v_dot2_f32_bf16 v131, v68, v68, v131
    v_dot2_f32_bf16 v133, v69, s74, v133
    v_dot2_f32_bf16 v135, v69, v69, v135
    v_dot2_f32_bf16 v129, v70, s74, v129
    v_dot2_f32_bf16 v131, v70, v70, v131
    v_dot2_f32_bf16 v133, v71, s74, v133
    v_dot2_f32_bf16 v135, v71, v71, v135
    s_waitcnt lgkmcnt(6)
    v_dot2_f32_bf16 v129, v76, s74, v129
    v_dot2_f32_bf16 v131, v76, v76, v131
    v_dot2_f32_bf16 v133, v77, s74, v133
    v_dot2_f32_bf16 v135, v77, v77, v135
    v_dot2_f32_bf16 v129, v78, s74, v129
    v_dot2_f32_bf16 v131, v78, v78, v131
    v_dot2_f32_bf16 v133, v79, s74, v133
    v_dot2_f32_bf16 v135, v79, v79, v135
    s_waitcnt lgkmcnt(5)
    v_dot2_f32_bf16 v129, v84, s74, v129
    v_dot2_f32_bf16 v131, v84, v84, v131
    v_dot2_f32_bf16 v133, v85, s74, v133
    v_dot2_f32_bf16 v135, v85, v85, v135
    v_dot2_f32_bf16 v129, v86, s74, v129
    v_dot2_f32_bf16 v131, v86, v86, v131
    v_dot2_f32_bf16 v133, v87, s74, v133
    v_dot2_f32_bf16 v135, v87, v87, v135
    s_waitcnt lgkmcnt(4)
    v_dot2_f32_bf16 v129, v92, s74, v129
    v_dot2_f32_bf16 v131, v92, v92, v131
    v_dot2_f32_bf16 v133, v93, s74, v133
    v_dot2_f32_bf16 v135, v93, v93, v135
    v_dot2_f32_bf16 v129, v94, s74, v129
    v_dot2_f32_bf16 v131, v94, v94, v131
    v_dot2_f32_bf16 v133, v95, s74, v133
    v_dot2_f32_bf16 v135, v95, v95, v135
    s_waitcnt lgkmcnt(3)
    v_dot2_f32_bf16 v129, v100, s74, v129
    v_dot2_f32_bf16 v131, v100, v100, v131
    v_dot2_f32_bf16 v133, v101, s74, v133
    v_dot2_f32_bf16 v135, v101, v101, v135
    v_dot2_f32_bf16 v129, v102, s74, v129
    v_dot2_f32_bf16 v131, v102, v102, v131
    v_dot2_f32_bf16 v133, v103, s74, v133
    v_dot2_f32_bf16 v135, v103, v103, v135
    s_waitcnt lgkmcnt(2)
    v_dot2_f32_bf16 v129, v108, s74, v129
    v_dot2_f32_bf16 v131, v108, v108, v131
    v_dot2_f32_bf16 v133, v109, s74, v133
    v_dot2_f32_bf16 v135, v109, v109, v135
    v_dot2_f32_bf16 v129, v110, s74, v129
    v_dot2_f32_bf16 v131, v110, v110, v131
    v_dot2_f32_bf16 v133, v111, s74, v133
    v_dot2_f32_bf16 v135, v111, v111, v135
    s_waitcnt lgkmcnt(1)
    v_dot2_f32_bf16 v129, v116, s74, v129
    v_dot2_f32_bf16 v131, v116, v116, v131
    v_dot2_f32_bf16 v133, v117, s74, v133
    v_dot2_f32_bf16 v135, v117, v117, v135
    v_dot2_f32_bf16 v129, v118, s74, v129
    v_dot2_f32_bf16 v131, v118, v118, v131
    v_dot2_f32_bf16 v133, v119, s74, v133
    v_dot2_f32_bf16 v135, v119, v119, v135
    s_waitcnt lgkmcnt(0)
    v_dot2_f32_bf16 v129, v124, s74, v129
    v_dot2_f32_bf16 v131, v124, v124, v131
    v_dot2_f32_bf16 v133, v125, s74, v133
    v_dot2_f32_bf16 v135, v125, v125, v135
    v_dot2_f32_bf16 v129, v126, s74, v129
    v_dot2_f32_bf16 v131, v126, v126, v131
    v_dot2_f32_bf16 v133, v127, s74, v133
    v_dot2_f32_bf16 v135, v127, v127, v135
    s_barrier
    s_nop 0
    v_add_f32 v129, v129, v133
    v_add_f32 v131, v131, v135
    s_nop 1
    v_permlane32_swap_b32 v129, v131
    v_add_f32 v129, v129, v131
    v_mov_b32 v131, v129
    s_nop 1
    v_permlane16_swap_b32 v129, v131
    v_add_f32 v129, v129, v131
    v_mul_f32 v129, 0x3b000000, v129
    v_mov_b32 v131, v129
    s_nop 1
    v_permlane32_swap_b32 v129, v131
    v_cvt_pk_bf16_f32 v140, -v129, -v129
    v_and_b32 v140, 0xffff0000, v140
    v_mov_b32 v141, v140
    v_mov_b32 v142, v140
    v_mov_b32 v143, v140
    s_nop 1
    v_mfma_f32_16x16x32_bf16 v[144:147], v[224:227], v[4:7], v[140:143]
    v_fma_f32 v131, -v129, v129, v131
    v_mfma_f32_16x16x32_bf16 v[148:151], v[228:231], v[4:7], v[140:143]
    v_max_f32 v131, 0, v131
    v_mfma_f32_16x16x32_bf16 v[152:155], v[224:227], v[12:15], v[140:143]
    v_cvt_pk_bf16_f32 v131, v131, v131
    v_mfma_f32_16x16x32_bf16 v[156:159], v[228:231], v[12:15], v[140:143]
    v_and_b32 v131, 0xffff0000, v131
    v_mfma_f32_16x16x32_bf16 v[160:163], v[224:227], v[20:23], v[140:143]
    v_cvt_pk_bf16_f32 v4, v144, v145
    v_cvt_pk_bf16_f32 v5, v146, v147
    v_add_f32 v131, 0x3727c5ac, v131
    v_mfma_f32_16x16x32_bf16 v[164:167], v[228:231], v[20:23], v[140:143]
    v_cvt_pk_bf16_f32 v6, v148, v149
    v_cvt_pk_bf16_f32 v7, v150, v151
    v_cvt_pk_bf16_f32 v131, v131, v131
    v_mfma_f32_16x16x32_bf16 v[168:171], v[224:227], v[28:31], v[140:143]
    v_cvt_pk_bf16_f32 v12, v152, v153
    v_cvt_pk_bf16_f32 v13, v154, v155
    v_and_b32 v131, 0xffff0000, v131
    v_mfma_f32_16x16x32_bf16 v[172:175], v[228:231], v[28:31], v[140:143]
    v_cvt_pk_bf16_f32 v14, v156, v157
    v_cvt_pk_bf16_f32 v15, v158, v159
    v_sqrt_f32 v131, v131
    v_mfma_f32_16x16x32_bf16 v[176:179], v[224:227], v[36:39], v[140:143]
    v_cvt_pk_bf16_f32 v20, v160, v161
    v_cvt_pk_bf16_f32 v21, v162, v163
    s_nop 0
    v_mfma_f32_16x16x32_bf16 v[180:183], v[228:231], v[36:39], v[140:143]
    v_cvt_pk_bf16_f32 v22, v164, v165
    v_cvt_pk_bf16_f32 v23, v166, v167
    v_cvt_pk_bf16_f32 v236, v131, v131
    v_mfma_f32_16x16x32_bf16 v[144:147], v[224:227], v[44:47], v[140:143]
    v_cvt_pk_bf16_f32 v28, v168, v169
    v_cvt_pk_bf16_f32 v29, v170, v171
    v_mov_b32 v237, v236
    v_mfma_f32_16x16x32_bf16 v[148:151], v[228:231], v[44:47], v[140:143]
    v_cvt_pk_bf16_f32 v30, v172, v173
    v_cvt_pk_bf16_f32 v31, v174, v175
    v_and_b32 v131, 0xffff0000, v236
    v_mfma_f32_16x16x32_bf16 v[152:155], v[224:227], v[52:55], v[140:143]
    v_cvt_pk_bf16_f32 v36, v176, v177
    v_cvt_pk_bf16_f32 v37, v178, v179
    v_rcp_f32 v131, v131
    v_mfma_f32_16x16x32_bf16 v[156:159], v[228:231], v[52:55], v[140:143]
    v_cvt_pk_bf16_f32 v38, v180, v181
    v_cvt_pk_bf16_f32 v39, v182, v183
    s_nop 0
    v_mfma_f32_16x16x32_bf16 v[160:163], v[224:227], v[60:63], v[140:143]
    v_cvt_pk_bf16_f32 v44, v144, v145
    v_cvt_pk_bf16_f32 v45, v146, v147
    v_mul_f32 v255, v131, v131
    v_mfma_f32_16x16x32_bf16 v[164:167], v[228:231], v[60:63], v[140:143]
    v_cvt_pk_bf16_f32 v46, v148, v149
    v_cvt_pk_bf16_f32 v47, v150, v151
    v_mfma_f32_16x16x32_bf16 v[168:171], v[224:227], v[68:71], v[140:143]
    v_cvt_pk_bf16_f32 v52, v152, v153
    v_cvt_pk_bf16_f32 v53, v154, v155
    v_mfma_f32_16x16x32_bf16 v[172:175], v[228:231], v[68:71], v[140:143]
    v_cvt_pk_bf16_f32 v54, v156, v157
    v_cvt_pk_bf16_f32 v55, v158, v159
    v_mfma_f32_16x16x32_bf16 v[176:179], v[224:227], v[76:79], v[140:143]
    v_cvt_pk_bf16_f32 v60, v160, v161
    v_cvt_pk_bf16_f32 v61, v162, v163
    v_mfma_f32_16x16x32_bf16 v[180:183], v[228:231], v[76:79], v[140:143]
    v_cvt_pk_bf16_f32 v62, v164, v165
    v_cvt_pk_bf16_f32 v63, v166, v167
    v_mfma_f32_16x16x32_bf16 v[144:147], v[224:227], v[84:87], v[140:143]
    v_cvt_pk_bf16_f32 v68, v168, v169
    v_cvt_pk_bf16_f32 v69, v170, v171
    v_mfma_f32_16x16x32_bf16 v[148:151], v[228:231], v[84:87], v[140:143]
    v_cvt_pk_bf16_f32 v70, v172, v173
    v_cvt_pk_bf16_f32 v71, v174, v175
    v_mfma_f32_16x16x32_bf16 v[152:155], v[224:227], v[92:95], v[140:143]
    v_cvt_pk_bf16_f32 v76, v176, v177
    v_cvt_pk_bf16_f32 v77, v178, v179
    v_mfma_f32_16x16x32_bf16 v[156:159], v[228:231], v[92:95], v[140:143]
    v_cvt_pk_bf16_f32 v78, v180, v181
    v_cvt_pk_bf16_f32 v79, v182, v183
    v_mfma_f32_16x16x32_bf16 v[160:163], v[224:227], v[100:103], v[140:143]
    v_cvt_pk_bf16_f32 v84, v144, v145
    v_cvt_pk_bf16_f32 v85, v146, v147
    v_mfma_f32_16x16x32_bf16 v[164:167], v[228:231], v[100:103], v[140:143]
    v_cvt_pk_bf16_f32 v86, v148, v149
    v_cvt_pk_bf16_f32 v87, v150, v151
    s_waitcnt lgkmcnt(0)
    s_barrier
    v_mfma_f32_16x16x32_bf16 v[168:171], v[224:227], v[108:111], v[140:143]
    v_cvt_pk_bf16_f32 v92, v152, v153
    v_cvt_pk_bf16_f32 v93, v154, v155
    v_mfma_f32_16x16x32_bf16 v[172:175], v[228:231], v[108:111], v[140:143]
    v_cvt_pk_bf16_f32 v94, v156, v157
    v_cvt_pk_bf16_f32 v95, v158, v159
    v_mfma_f32_16x16x32_bf16 v[176:179], v[224:227], v[116:119], v[140:143]
    v_cvt_pk_bf16_f32 v100, v160, v161
    v_cvt_pk_bf16_f32 v101, v162, v163
    v_mfma_f32_16x16x32_bf16 v[180:183], v[228:231], v[116:119], v[140:143]
    v_cvt_pk_bf16_f32 v102, v164, v165
    v_cvt_pk_bf16_f32 v103, v166, v167
    ds_read_b64_tr_b16 v[192:193], v220 offset:0
    ds_read_b64_tr_b16 v[194:195], v220 offset:512
    ds_read_b64_tr_b16 v[196:197], v221 offset:0
    ds_read_b64_tr_b16 v[198:199], v221 offset:512
    ds_read_b64_tr_b16 v[200:201], v220 offset:16384
    ds_read_b64_tr_b16 v[202:203], v220 offset:16896
    ds_read_b64_tr_b16 v[204:205], v221 offset:16384
    ds_read_b64_tr_b16 v[206:207], v221 offset:16896
    ds_read_b64_tr_b16 v[208:209], v220 offset:4096
    ds_read_b64_tr_b16 v[210:211], v220 offset:4608
    v_mfma_f32_16x16x32_bf16 v[144:147], v[224:227], v[124:127], v[140:143]
    v_cvt_pk_bf16_f32 v108, v168, v169
    v_cvt_pk_bf16_f32 v109, v170, v171
    v_mfma_f32_16x16x32_bf16 v[148:151], v[228:231], v[124:127], v[140:143]
    v_cvt_pk_bf16_f32 v110, v172, v173
    v_cvt_pk_bf16_f32 v111, v174, v175
    v_cvt_pk_bf16_f32 v116, v176, v177
    v_cvt_pk_bf16_f32 v117, v178, v179
    v_cvt_pk_bf16_f32 v118, v180, v181
    v_cvt_pk_bf16_f32 v119, v182, v183
    v_cvt_pk_bf16_f32 v124, v144, v145
    v_cvt_pk_bf16_f32 v125, v146, v147
    v_cvt_pk_bf16_f32 v126, v148, v149
    v_cvt_pk_bf16_f32 v127, v150, v151
    s_waitcnt lgkmcnt(6)
    v_mfma_f32_16x16x32_bf16 v[128:131], v[192:195], v[0:3], 0
    v_mfma_f32_16x16x32_bf16 v[132:135], v[192:195], v[4:7], 0
    ds_read_b64_tr_b16 v[212:213], v221 offset:4096
    v_mfma_f32_16x16x32_bf16 v[136:139], v[196:199], v[0:3], 0
    ds_read_b64_tr_b16 v[214:215], v221 offset:4608
    v_mfma_f32_16x16x32_bf16 v[140:143], v[196:199], v[4:7], 0
    ds_read_b64_tr_b16 v[192:193], v220 offset:20480
    s_waitcnt lgkmcnt(5)
    v_mfma_f32_16x16x32_bf16 v[144:147], v[200:203], v[0:3], 0
    ds_read_b64_tr_b16 v[194:195], v220 offset:20992
    v_mfma_f32_16x16x32_bf16 v[148:151], v[200:203], v[4:7], 0
    ds_read_b64_tr_b16 v[196:197], v221 offset:20480
    v_mfma_f32_16x16x32_bf16 v[152:155], v[204:207], v[0:3], 0
    ds_read_b64_tr_b16 v[198:199], v221 offset:20992
    v_mfma_f32_16x16x32_bf16 v[156:159], v[204:207], v[4:7], 0
    ds_read_b64_tr_b16 v[200:201], v220 offset:8192
    s_waitcnt lgkmcnt(5)
    v_mfma_f32_16x16x32_bf16 v[128:131], v[208:211], v[8:11], v[128:131]
    ds_read_b64_tr_b16 v[202:203], v220 offset:8704
    v_mfma_f32_16x16x32_bf16 v[132:135], v[208:211], v[12:15], v[132:135]
    ds_read_b64_tr_b16 v[204:205], v221 offset:8192
    v_mfma_f32_16x16x32_bf16 v[136:139], v[212:215], v[8:11], v[136:139]
    ds_read_b64_tr_b16 v[206:207], v221 offset:8704
    v_mfma_f32_16x16x32_bf16 v[140:143], v[212:215], v[12:15], v[140:143]
    ds_read_b64_tr_b16 v[208:209], v220 offset:24576
    s_waitcnt lgkmcnt(5)
    v_mfma_f32_16x16x32_bf16 v[144:147], v[192:195], v[8:11], v[144:147]
    ds_read_b64_tr_b16 v[210:211], v220 offset:25088
    v_mfma_f32_16x16x32_bf16 v[148:151], v[192:195], v[12:15], v[148:151]
    ds_read_b64_tr_b16 v[212:213], v221 offset:24576
    v_mfma_f32_16x16x32_bf16 v[152:155], v[196:199], v[8:11], v[152:155]
    ds_read_b64_tr_b16 v[214:215], v221 offset:25088
    v_mfma_f32_16x16x32_bf16 v[156:159], v[196:199], v[12:15], v[156:159]
    ds_read_b64_tr_b16 v[192:193], v220 offset:12288
    s_waitcnt lgkmcnt(5)
    v_mfma_f32_16x16x32_bf16 v[128:131], v[200:203], v[16:19], v[128:131]
    ds_read_b64_tr_b16 v[194:195], v220 offset:12800
    v_mfma_f32_16x16x32_bf16 v[132:135], v[200:203], v[20:23], v[132:135]
    ds_read_b64_tr_b16 v[196:197], v221 offset:12288
    v_mfma_f32_16x16x32_bf16 v[136:139], v[204:207], v[16:19], v[136:139]
    ds_read_b64_tr_b16 v[198:199], v221 offset:12800
    v_mfma_f32_16x16x32_bf16 v[140:143], v[204:207], v[20:23], v[140:143]
    ds_read_b64_tr_b16 v[200:201], v220 offset:28672
    s_waitcnt lgkmcnt(5)
    v_mfma_f32_16x16x32_bf16 v[144:147], v[208:211], v[16:19], v[144:147]
    ds_read_b64_tr_b16 v[202:203], v220 offset:29184
    v_mfma_f32_16x16x32_bf16 v[148:151], v[208:211], v[20:23], v[148:151]
    ds_read_b64_tr_b16 v[204:205], v221 offset:28672
    v_mfma_f32_16x16x32_bf16 v[152:155], v[212:215], v[16:19], v[152:155]
    ds_read_b64_tr_b16 v[206:207], v221 offset:29184
    v_mfma_f32_16x16x32_bf16 v[156:159], v[212:215], v[20:23], v[156:159]
    ds_read_b64_tr_b16 v[208:209], v222 offset:0
    s_waitcnt lgkmcnt(5)
    v_mfma_f32_16x16x32_bf16 v[128:131], v[192:195], v[24:27], v[128:131]
    ds_read_b64_tr_b16 v[210:211], v222 offset:512
    v_mfma_f32_16x16x32_bf16 v[132:135], v[192:195], v[28:31], v[132:135]
    ds_read_b64_tr_b16 v[212:213], v223 offset:0
    v_mfma_f32_16x16x32_bf16 v[136:139], v[196:199], v[24:27], v[136:139]
    ds_read_b64_tr_b16 v[214:215], v223 offset:512
    v_mfma_f32_16x16x32_bf16 v[140:143], v[196:199], v[28:31], v[140:143]
    ds_read_b64_tr_b16 v[192:193], v222 offset:16384
    s_waitcnt lgkmcnt(5)
    v_mfma_f32_16x16x32_bf16 v[144:147], v[200:203], v[24:27], v[144:147]
    ds_read_b64_tr_b16 v[194:195], v222 offset:16896
    v_mfma_f32_16x16x32_bf16 v[148:151], v[200:203], v[28:31], v[148:151]
    ds_read_b64_tr_b16 v[196:197], v223 offset:16384
    v_mfma_f32_16x16x32_bf16 v[152:155], v[204:207], v[24:27], v[152:155]
    ds_read_b64_tr_b16 v[198:199], v223 offset:16896
    v_mfma_f32_16x16x32_bf16 v[156:159], v[204:207], v[28:31], v[156:159]
    ds_read_b64_tr_b16 v[200:201], v222 offset:4096
    s_waitcnt lgkmcnt(5)
    v_mfma_f32_16x16x32_bf16 v[160:163], v[208:211], v[0:3], 0
    ds_read_b64_tr_b16 v[202:203], v222 offset:4608
    v_mfma_f32_16x16x32_bf16 v[164:167], v[208:211], v[4:7], 0
    ds_read_b64_tr_b16 v[204:205], v223 offset:4096
    v_mfma_f32_16x16x32_bf16 v[168:171], v[212:215], v[0:3], 0
    ds_read_b64_tr_b16 v[206:207], v223 offset:4608
    v_mfma_f32_16x16x32_bf16 v[172:175], v[212:215], v[4:7], 0
    ds_read_b64_tr_b16 v[208:209], v222 offset:20480
    s_waitcnt lgkmcnt(5)
    v_mfma_f32_16x16x32_bf16 v[176:179], v[192:195], v[0:3], 0
    ds_read_b64_tr_b16 v[210:211], v222 offset:20992
    v_mfma_f32_16x16x32_bf16 v[180:183], v[192:195], v[4:7], 0
    ds_read_b64_tr_b16 v[212:213], v223 offset:20480
    v_mfma_f32_16x16x32_bf16 v[184:187], v[196:199], v[0:3], 0
    ds_read_b64_tr_b16 v[214:215], v223 offset:20992
    v_mfma_f32_16x16x32_bf16 v[188:191], v[196:199], v[4:7], 0
    ds_read_b64_tr_b16 v[192:193], v222 offset:8192
    s_waitcnt lgkmcnt(5)
    v_mfma_f32_16x16x32_bf16 v[160:163], v[200:203], v[8:11], v[160:163]
    ds_read_b64_tr_b16 v[194:195], v222 offset:8704
    v_mfma_f32_16x16x32_bf16 v[164:167], v[200:203], v[12:15], v[164:167]
    ds_read_b64_tr_b16 v[196:197], v223 offset:8192
    v_mfma_f32_16x16x32_bf16 v[168:171], v[204:207], v[8:11], v[168:171]
    ds_read_b64_tr_b16 v[198:199], v223 offset:8704
    v_mfma_f32_16x16x32_bf16 v[172:175], v[204:207], v[12:15], v[172:175]
    ds_read_b64_tr_b16 v[200:201], v222 offset:24576
    s_waitcnt lgkmcnt(5)
    v_mfma_f32_16x16x32_bf16 v[176:179], v[208:211], v[8:11], v[176:179]
    ds_read_b64_tr_b16 v[202:203], v222 offset:25088
    v_mfma_f32_16x16x32_bf16 v[180:183], v[208:211], v[12:15], v[180:183]
    ds_read_b64_tr_b16 v[204:205], v223 offset:24576
    v_mfma_f32_16x16x32_bf16 v[184:187], v[212:215], v[8:11], v[184:187]
    ds_read_b64_tr_b16 v[206:207], v223 offset:25088
    v_mfma_f32_16x16x32_bf16 v[188:191], v[212:215], v[12:15], v[188:191]
    ds_read_b64_tr_b16 v[208:209], v222 offset:12288
    s_waitcnt lgkmcnt(5)
    v_mfma_f32_16x16x32_bf16 v[160:163], v[192:195], v[16:19], v[160:163]
    ds_read_b64_tr_b16 v[210:211], v222 offset:12800
    v_mfma_f32_16x16x32_bf16 v[164:167], v[192:195], v[20:23], v[164:167]
    ds_read_b64_tr_b16 v[212:213], v223 offset:12288
    v_mfma_f32_16x16x32_bf16 v[168:171], v[196:199], v[16:19], v[168:171]
    ds_read_b64_tr_b16 v[214:215], v223 offset:12800
    v_mfma_f32_16x16x32_bf16 v[172:175], v[196:199], v[20:23], v[172:175]
    ds_read_b64_tr_b16 v[192:193], v222 offset:28672
    s_waitcnt lgkmcnt(5)
    v_mfma_f32_16x16x32_bf16 v[176:179], v[200:203], v[16:19], v[176:179]
    ds_read_b64_tr_b16 v[194:195], v222 offset:29184
    v_mfma_f32_16x16x32_bf16 v[180:183], v[200:203], v[20:23], v[180:183]
    ds_read_b64_tr_b16 v[196:197], v223 offset:28672
    v_mfma_f32_16x16x32_bf16 v[184:187], v[204:207], v[16:19], v[184:187]
    ds_read_b64_tr_b16 v[198:199], v223 offset:29184
    v_mfma_f32_16x16x32_bf16 v[188:191], v[204:207], v[20:23], v[188:191]
    s_waitcnt lgkmcnt(4)
    v_mfma_f32_16x16x32_bf16 v[160:163], v[208:211], v[24:27], v[160:163]
    v_mfma_f32_16x16x32_bf16 v[164:167], v[208:211], v[28:31], v[164:167]
    s_waitcnt lgkmcnt(0)
    s_barrier
    ds_read_b64_tr_b16 v[200:201], v216 offset:0
    ds_read_b64_tr_b16 v[202:203], v216 offset:512
    ds_read_b64_tr_b16 v[204:205], v217 offset:0
    ds_read_b64_tr_b16 v[206:207], v217 offset:512
    v_mfma_f32_16x16x32_bf16 v[168:171], v[212:215], v[24:27], v[168:171]
    v_mfma_f32_16x16x32_bf16 v[172:175], v[212:215], v[28:31], v[172:175]
    ds_read_b64_tr_b16 v[208:209], v216 offset:16384
    v_mfma_f32_16x16x32_bf16 v[176:179], v[192:195], v[24:27], v[176:179]
    ds_read_b64_tr_b16 v[210:211], v216 offset:16896
    v_mfma_f32_16x16x32_bf16 v[180:183], v[192:195], v[28:31], v[180:183]
    ds_read_b64_tr_b16 v[212:213], v217 offset:16384
    v_mfma_f32_16x16x32_bf16 v[184:187], v[196:199], v[24:27], v[184:187]
    ds_read_b64_tr_b16 v[214:215], v217 offset:16896
    v_mfma_f32_16x16x32_bf16 v[188:191], v[196:199], v[28:31], v[188:191]
    ds_read_b64_tr_b16 v[192:193], v216 offset:4096
    s_waitcnt lgkmcnt(5)
    v_mfma_f32_16x16x32_bf16 v[128:131], v[200:203], v[32:35], v[128:131]
    ds_read_b64_tr_b16 v[194:195], v216 offset:4608
    v_mfma_f32_16x16x32_bf16 v[132:135], v[200:203], v[36:39], v[132:135]
    ds_read_b64_tr_b16 v[196:197], v217 offset:4096
    v_mfma_f32_16x16x32_bf16 v[136:139], v[204:207], v[32:35], v[136:139]
    ds_read_b64_tr_b16 v[198:199], v217 offset:4608
    v_mfma_f32_16x16x32_bf16 v[140:143], v[204:207], v[36:39], v[140:143]
    ds_read_b64_tr_b16 v[200:201], v216 offset:20480
    s_waitcnt lgkmcnt(5)
    v_mfma_f32_16x16x32_bf16 v[144:147], v[208:211], v[32:35], v[144:147]
    ds_read_b64_tr_b16 v[202:203], v216 offset:20992
    v_mfma_f32_16x16x32_bf16 v[148:151], v[208:211], v[36:39], v[148:151]
    ds_read_b64_tr_b16 v[204:205], v217 offset:20480
    v_mfma_f32_16x16x32_bf16 v[152:155], v[212:215], v[32:35], v[152:155]
    ds_read_b64_tr_b16 v[206:207], v217 offset:20992
    v_mfma_f32_16x16x32_bf16 v[156:159], v[212:215], v[36:39], v[156:159]
    ds_read_b64_tr_b16 v[208:209], v216 offset:8192
    buffer_load_dword v248, v251, s[40:43], 0 offen sc1
    s_waitcnt lgkmcnt(5)
    v_mfma_f32_16x16x32_bf16 v[128:131], v[192:195], v[40:43], v[128:131]
    ds_read_b64_tr_b16 v[210:211], v216 offset:8704
    v_mfma_f32_16x16x32_bf16 v[132:135], v[192:195], v[44:47], v[132:135]
    ds_read_b64_tr_b16 v[212:213], v217 offset:8192
    s_lshl_b32 s6, s49, 2
    v_mfma_f32_16x16x32_bf16 v[136:139], v[196:199], v[40:43], v[136:139]
    ds_read_b64_tr_b16 v[214:215], v217 offset:8704
    v_mfma_f32_16x16x32_bf16 v[140:143], v[196:199], v[44:47], v[140:143]
    ds_read_b64_tr_b16 v[192:193], v216 offset:24576
    s_add_u32 s6, s6, s48
    s_waitcnt lgkmcnt(5)
    v_mfma_f32_16x16x32_bf16 v[144:147], v[200:203], v[40:43], v[144:147]
    ds_read_b64_tr_b16 v[194:195], v216 offset:25088
    v_mfma_f32_16x16x32_bf16 v[148:151], v[200:203], v[44:47], v[148:151]
    ds_read_b64_tr_b16 v[196:197], v217 offset:24576
    s_lshl_b32 s6, s6, 5
    v_mfma_f32_16x16x32_bf16 v[152:155], v[204:207], v[40:43], v[152:155]
    ds_read_b64_tr_b16 v[198:199], v217 offset:25088
    v_mfma_f32_16x16x32_bf16 v[156:159], v[204:207], v[44:47], v[156:159]
    ds_read_b64_tr_b16 v[200:201], v216 offset:12288
    s_add_u32 s6, s6, s50
    s_waitcnt lgkmcnt(5)
    v_mfma_f32_16x16x32_bf16 v[128:131], v[208:211], v[48:51], v[128:131]
    ds_read_b64_tr_b16 v[202:203], v216 offset:12800
    v_mfma_f32_16x16x32_bf16 v[132:135], v[208:211], v[52:55], v[132:135]
    ds_read_b64_tr_b16 v[204:205], v217 offset:12288
    s_add_u32 s6, s6, 8
    v_mfma_f32_16x16x32_bf16 v[136:139], v[212:215], v[48:51], v[136:139]
    ds_read_b64_tr_b16 v[206:207], v217 offset:12800
    v_mfma_f32_16x16x32_bf16 v[140:143], v[212:215], v[52:55], v[140:143]
    ds_read_b64_tr_b16 v[208:209], v216 offset:28672
    s_lshl_b32 s6, s6, 2
    s_waitcnt lgkmcnt(5)
    v_mfma_f32_16x16x32_bf16 v[144:147], v[192:195], v[48:51], v[144:147]
    ds_read_b64_tr_b16 v[210:211], v216 offset:29184
    v_mfma_f32_16x16x32_bf16 v[148:151], v[192:195], v[52:55], v[148:151]
    ds_read_b64_tr_b16 v[212:213], v217 offset:28672
    s_add_u32 s6, s6, 11800576
    v_mfma_f32_16x16x32_bf16 v[152:155], v[196:199], v[48:51], v[152:155]
    ds_read_b64_tr_b16 v[214:215], v217 offset:29184
    v_mfma_f32_16x16x32_bf16 v[156:159], v[196:199], v[52:55], v[156:159]
    ds_read_b64_tr_b16 v[192:193], v218 offset:0
    v_mov_b32 v252, s6
    s_waitcnt lgkmcnt(5)
    v_mfma_f32_16x16x32_bf16 v[128:131], v[200:203], v[56:59], v[128:131]
    ds_read_b64_tr_b16 v[194:195], v218 offset:512
    v_mfma_f32_16x16x32_bf16 v[132:135], v[200:203], v[60:63], v[132:135]
    ds_read_b64_tr_b16 v[196:197], v219 offset:0
    s_mov_b32 s72, 8192
    v_mfma_f32_16x16x32_bf16 v[136:139], v[204:207], v[56:59], v[136:139]
    ds_read_b64_tr_b16 v[198:199], v219 offset:512
    v_mfma_f32_16x16x32_bf16 v[140:143], v[204:207], v[60:63], v[140:143]
    ds_read_b64_tr_b16 v[200:201], v218 offset:16384
    s_waitcnt lgkmcnt(5)
    v_mfma_f32_16x16x32_bf16 v[144:147], v[208:211], v[56:59], v[144:147]
    ds_read_b64_tr_b16 v[202:203], v218 offset:16896
    v_mfma_f32_16x16x32_bf16 v[148:151], v[208:211], v[60:63], v[148:151]
    ds_read_b64_tr_b16 v[204:205], v219 offset:16384
    v_mfma_f32_16x16x32_bf16 v[152:155], v[212:215], v[56:59], v[152:155]
    ds_read_b64_tr_b16 v[206:207], v219 offset:16896
    v_mfma_f32_16x16x32_bf16 v[156:159], v[212:215], v[60:63], v[156:159]
    ds_read_b64_tr_b16 v[208:209], v218 offset:4096
    s_waitcnt lgkmcnt(5)
    v_mfma_f32_16x16x32_bf16 v[160:163], v[192:195], v[32:35], v[160:163]
    ds_read_b64_tr_b16 v[210:211], v218 offset:4608
    v_mfma_f32_16x16x32_bf16 v[164:167], v[192:195], v[36:39], v[164:167]
    ds_read_b64_tr_b16 v[212:213], v219 offset:4096
    v_mfma_f32_16x16x32_bf16 v[168:171], v[196:199], v[32:35], v[168:171]
    ds_read_b64_tr_b16 v[214:215], v219 offset:4608
    v_mfma_f32_16x16x32_bf16 v[172:175], v[196:199], v[36:39], v[172:175]
    ds_read_b64_tr_b16 v[192:193], v218 offset:20480
    s_waitcnt lgkmcnt(5)
    v_mfma_f32_16x16x32_bf16 v[176:179], v[200:203], v[32:35], v[176:179]
    ds_read_b64_tr_b16 v[194:195], v218 offset:20992
    v_mfma_f32_16x16x32_bf16 v[180:183], v[200:203], v[36:39], v[180:183]
    ds_read_b64_tr_b16 v[196:197], v219 offset:20480
    v_mfma_f32_16x16x32_bf16 v[184:187], v[204:207], v[32:35], v[184:187]
    ds_read_b64_tr_b16 v[198:199], v219 offset:20992
    v_mfma_f32_16x16x32_bf16 v[188:191], v[204:207], v[36:39], v[188:191]
    ds_read_b64_tr_b16 v[200:201], v218 offset:8192
    s_waitcnt lgkmcnt(5)
    v_mfma_f32_16x16x32_bf16 v[160:163], v[208:211], v[40:43], v[160:163]
    ds_read_b64_tr_b16 v[202:203], v218 offset:8704
    v_mfma_f32_16x16x32_bf16 v[164:167], v[208:211], v[44:47], v[164:167]
    ds_read_b64_tr_b16 v[204:205], v219 offset:8192
    v_mfma_f32_16x16x32_bf16 v[168:171], v[212:215], v[40:43], v[168:171]
    ds_read_b64_tr_b16 v[206:207], v219 offset:8704
    v_mfma_f32_16x16x32_bf16 v[172:175], v[212:215], v[44:47], v[172:175]
    ds_read_b64_tr_b16 v[208:209], v218 offset:24576
    s_waitcnt lgkmcnt(5)
    v_mfma_f32_16x16x32_bf16 v[176:179], v[192:195], v[40:43], v[176:179]
    ds_read_b64_tr_b16 v[210:211], v218 offset:25088
    v_mfma_f32_16x16x32_bf16 v[180:183], v[192:195], v[44:47], v[180:183]
    ds_read_b64_tr_b16 v[212:213], v219 offset:24576
    v_mfma_f32_16x16x32_bf16 v[184:187], v[196:199], v[40:43], v[184:187]
    ds_read_b64_tr_b16 v[214:215], v219 offset:25088
    v_mfma_f32_16x16x32_bf16 v[188:191], v[196:199], v[44:47], v[188:191]
    ds_read_b64_tr_b16 v[192:193], v218 offset:12288
    s_waitcnt lgkmcnt(5)
    v_mfma_f32_16x16x32_bf16 v[160:163], v[200:203], v[48:51], v[160:163]
    ds_read_b64_tr_b16 v[194:195], v218 offset:12800
    v_mfma_f32_16x16x32_bf16 v[164:167], v[200:203], v[52:55], v[164:167]
    ds_read_b64_tr_b16 v[196:197], v219 offset:12288
    v_mfma_f32_16x16x32_bf16 v[168:171], v[204:207], v[48:51], v[168:171]
    ds_read_b64_tr_b16 v[198:199], v219 offset:12800
    v_mfma_f32_16x16x32_bf16 v[172:175], v[204:207], v[52:55], v[172:175]
    ds_read_b64_tr_b16 v[200:201], v218 offset:28672
    s_waitcnt lgkmcnt(5)
    v_mfma_f32_16x16x32_bf16 v[176:179], v[208:211], v[48:51], v[176:179]
    ds_read_b64_tr_b16 v[202:203], v218 offset:29184
    v_mfma_f32_16x16x32_bf16 v[180:183], v[208:211], v[52:55], v[180:183]
    ds_read_b64_tr_b16 v[204:205], v219 offset:28672
    v_mfma_f32_16x16x32_bf16 v[184:187], v[212:215], v[48:51], v[184:187]
    ds_read_b64_tr_b16 v[206:207], v219 offset:29184
    v_mfma_f32_16x16x32_bf16 v[188:191], v[212:215], v[52:55], v[188:191]
    s_waitcnt lgkmcnt(4)
    v_mfma_f32_16x16x32_bf16 v[160:163], v[192:195], v[56:59], v[160:163]
    v_mfma_f32_16x16x32_bf16 v[164:167], v[192:195], v[60:63], v[164:167]
    s_waitcnt lgkmcnt(0)
    s_barrier
    ds_read_b64_tr_b16 v[208:209], v216 offset:32768
    ds_read_b64_tr_b16 v[210:211], v216 offset:33280
    ds_read_b64_tr_b16 v[212:213], v217 offset:32768
    ds_read_b64_tr_b16 v[214:215], v217 offset:33280
    v_mfma_f32_16x16x32_bf16 v[168:171], v[196:199], v[56:59], v[168:171]
    v_mfma_f32_16x16x32_bf16 v[172:175], v[196:199], v[60:63], v[172:175]
    ds_read_b64_tr_b16 v[192:193], v216 offset:49152
    v_mfma_f32_16x16x32_bf16 v[176:179], v[200:203], v[56:59], v[176:179]
    ds_read_b64_tr_b16 v[194:195], v216 offset:49664
    v_mfma_f32_16x16x32_bf16 v[180:183], v[200:203], v[60:63], v[180:183]
    ds_read_b64_tr_b16 v[196:197], v217 offset:49152
    v_mfma_f32_16x16x32_bf16 v[184:187], v[204:207], v[56:59], v[184:187]
    ds_read_b64_tr_b16 v[198:199], v217 offset:49664
    v_mfma_f32_16x16x32_bf16 v[188:191], v[204:207], v[60:63], v[188:191]
    ds_read_b64_tr_b16 v[200:201], v216 offset:36864
    s_waitcnt lgkmcnt(5)
    v_mfma_f32_16x16x32_bf16 v[128:131], v[208:211], v[64:67], v[128:131]
    ds_read_b64_tr_b16 v[202:203], v216 offset:37376
    v_mfma_f32_16x16x32_bf16 v[132:135], v[208:211], v[68:71], v[132:135]
    ds_read_b64_tr_b16 v[204:205], v217 offset:36864
    v_mfma_f32_16x16x32_bf16 v[136:139], v[212:215], v[64:67], v[136:139]
    ds_read_b64_tr_b16 v[206:207], v217 offset:37376
    v_mfma_f32_16x16x32_bf16 v[140:143], v[212:215], v[68:71], v[140:143]
    ds_read_b64_tr_b16 v[208:209], v216 offset:53248
    s_waitcnt lgkmcnt(5)
    v_mfma_f32_16x16x32_bf16 v[144:147], v[192:195], v[64:67], v[144:147]
    ds_read_b64_tr_b16 v[210:211], v216 offset:53760
    v_mfma_f32_16x16x32_bf16 v[148:151], v[192:195], v[68:71], v[148:151]
    ds_read_b64_tr_b16 v[212:213], v217 offset:53248
    v_mfma_f32_16x16x32_bf16 v[152:155], v[196:199], v[64:67], v[152:155]
    ds_read_b64_tr_b16 v[214:215], v217 offset:53760
    v_mfma_f32_16x16x32_bf16 v[156:159], v[196:199], v[68:71], v[156:159]
    ds_read_b64_tr_b16 v[192:193], v216 offset:40960
    s_waitcnt lgkmcnt(5)
    v_mfma_f32_16x16x32_bf16 v[128:131], v[200:203], v[72:75], v[128:131]
    ds_read_b64_tr_b16 v[194:195], v216 offset:41472
    v_mfma_f32_16x16x32_bf16 v[132:135], v[200:203], v[76:79], v[132:135]
    ds_read_b64_tr_b16 v[196:197], v217 offset:40960
    v_mfma_f32_16x16x32_bf16 v[136:139], v[204:207], v[72:75], v[136:139]
    ds_read_b64_tr_b16 v[198:199], v217 offset:41472
    v_mfma_f32_16x16x32_bf16 v[140:143], v[204:207], v[76:79], v[140:143]
    ds_read_b64_tr_b16 v[200:201], v216 offset:57344
    s_waitcnt lgkmcnt(5)
    v_mfma_f32_16x16x32_bf16 v[144:147], v[208:211], v[72:75], v[144:147]
    ds_read_b64_tr_b16 v[202:203], v216 offset:57856
    v_mfma_f32_16x16x32_bf16 v[148:151], v[208:211], v[76:79], v[148:151]
    ds_read_b64_tr_b16 v[204:205], v217 offset:57344
    v_mfma_f32_16x16x32_bf16 v[152:155], v[212:215], v[72:75], v[152:155]
    ds_read_b64_tr_b16 v[206:207], v217 offset:57856
    v_mfma_f32_16x16x32_bf16 v[156:159], v[212:215], v[76:79], v[156:159]
    ds_read_b64_tr_b16 v[208:209], v216 offset:45056
    s_waitcnt lgkmcnt(5)
    v_mfma_f32_16x16x32_bf16 v[128:131], v[192:195], v[80:83], v[128:131]
    ds_read_b64_tr_b16 v[210:211], v216 offset:45568
    v_mfma_f32_16x16x32_bf16 v[132:135], v[192:195], v[84:87], v[132:135]
    ds_read_b64_tr_b16 v[212:213], v217 offset:45056
    v_mfma_f32_16x16x32_bf16 v[136:139], v[196:199], v[80:83], v[136:139]
    ds_read_b64_tr_b16 v[214:215], v217 offset:45568
    v_mfma_f32_16x16x32_bf16 v[140:143], v[196:199], v[84:87], v[140:143]
    ds_read_b64_tr_b16 v[192:193], v216 offset:61440
    s_waitcnt lgkmcnt(5)
    v_mfma_f32_16x16x32_bf16 v[144:147], v[200:203], v[80:83], v[144:147]
    ds_read_b64_tr_b16 v[194:195], v216 offset:61952
    v_mfma_f32_16x16x32_bf16 v[148:151], v[200:203], v[84:87], v[148:151]
    ds_read_b64_tr_b16 v[196:197], v217 offset:61440
    v_mfma_f32_16x16x32_bf16 v[152:155], v[204:207], v[80:83], v[152:155]
    ds_read_b64_tr_b16 v[198:199], v217 offset:61952
    v_mfma_f32_16x16x32_bf16 v[156:159], v[204:207], v[84:87], v[156:159]
    ds_read_b64_tr_b16 v[200:201], v218 offset:32768
    s_waitcnt lgkmcnt(5)
    v_mfma_f32_16x16x32_bf16 v[128:131], v[208:211], v[88:91], v[128:131]
    ds_read_b64_tr_b16 v[202:203], v218 offset:33280
    v_mfma_f32_16x16x32_bf16 v[132:135], v[208:211], v[92:95], v[132:135]
    ds_read_b64_tr_b16 v[204:205], v219 offset:32768
    v_mfma_f32_16x16x32_bf16 v[136:139], v[212:215], v[88:91], v[136:139]
    ds_read_b64_tr_b16 v[206:207], v219 offset:33280
    v_mfma_f32_16x16x32_bf16 v[140:143], v[212:215], v[92:95], v[140:143]
    ds_read_b64_tr_b16 v[208:209], v218 offset:49152
    s_waitcnt lgkmcnt(5)
    v_mfma_f32_16x16x32_bf16 v[144:147], v[192:195], v[88:91], v[144:147]
    ds_read_b64_tr_b16 v[210:211], v218 offset:49664
    v_mfma_f32_16x16x32_bf16 v[148:151], v[192:195], v[92:95], v[148:151]
    ds_read_b64_tr_b16 v[212:213], v219 offset:49152
    v_mfma_f32_16x16x32_bf16 v[152:155], v[196:199], v[88:91], v[152:155]
    ds_read_b64_tr_b16 v[214:215], v219 offset:49664
    v_mfma_f32_16x16x32_bf16 v[156:159], v[196:199], v[92:95], v[156:159]
    ds_read_b64_tr_b16 v[192:193], v218 offset:36864
    s_waitcnt lgkmcnt(5)
    v_mfma_f32_16x16x32_bf16 v[160:163], v[200:203], v[64:67], v[160:163]
    ds_read_b64_tr_b16 v[194:195], v218 offset:37376
    v_mfma_f32_16x16x32_bf16 v[164:167], v[200:203], v[68:71], v[164:167]
    ds_read_b64_tr_b16 v[196:197], v219 offset:36864
    v_mfma_f32_16x16x32_bf16 v[168:171], v[204:207], v[64:67], v[168:171]
    ds_read_b64_tr_b16 v[198:199], v219 offset:37376
    v_mfma_f32_16x16x32_bf16 v[172:175], v[204:207], v[68:71], v[172:175]
    ds_read_b64_tr_b16 v[200:201], v218 offset:53248
    s_waitcnt lgkmcnt(5)
    v_mfma_f32_16x16x32_bf16 v[176:179], v[208:211], v[64:67], v[176:179]
    ds_read_b64_tr_b16 v[202:203], v218 offset:53760
    v_mfma_f32_16x16x32_bf16 v[180:183], v[208:211], v[68:71], v[180:183]
    ds_read_b64_tr_b16 v[204:205], v219 offset:53248
    v_mfma_f32_16x16x32_bf16 v[184:187], v[212:215], v[64:67], v[184:187]
    ds_read_b64_tr_b16 v[206:207], v219 offset:53760
    v_mfma_f32_16x16x32_bf16 v[188:191], v[212:215], v[68:71], v[188:191]
    ds_read_b64_tr_b16 v[208:209], v218 offset:40960
    s_waitcnt lgkmcnt(5)
    v_mfma_f32_16x16x32_bf16 v[160:163], v[192:195], v[72:75], v[160:163]
    ds_read_b64_tr_b16 v[210:211], v218 offset:41472
    v_mfma_f32_16x16x32_bf16 v[164:167], v[192:195], v[76:79], v[164:167]
    ds_read_b64_tr_b16 v[212:213], v219 offset:40960
    v_mfma_f32_16x16x32_bf16 v[168:171], v[196:199], v[72:75], v[168:171]
    ds_read_b64_tr_b16 v[214:215], v219 offset:41472
    v_mfma_f32_16x16x32_bf16 v[172:175], v[196:199], v[76:79], v[172:175]
    ds_read_b64_tr_b16 v[192:193], v218 offset:57344
    s_waitcnt lgkmcnt(5)
    v_mfma_f32_16x16x32_bf16 v[176:179], v[200:203], v[72:75], v[176:179]
    ds_read_b64_tr_b16 v[194:195], v218 offset:57856
    v_mfma_f32_16x16x32_bf16 v[180:183], v[200:203], v[76:79], v[180:183]
    ds_read_b64_tr_b16 v[196:197], v219 offset:57344
    v_mfma_f32_16x16x32_bf16 v[184:187], v[204:207], v[72:75], v[184:187]
    ds_read_b64_tr_b16 v[198:199], v219 offset:57856
    v_mfma_f32_16x16x32_bf16 v[188:191], v[204:207], v[76:79], v[188:191]
    ds_read_b64_tr_b16 v[200:201], v218 offset:45056
    s_waitcnt lgkmcnt(5)
    v_mfma_f32_16x16x32_bf16 v[160:163], v[208:211], v[80:83], v[160:163]
    ds_read_b64_tr_b16 v[202:203], v218 offset:45568
    v_mfma_f32_16x16x32_bf16 v[164:167], v[208:211], v[84:87], v[164:167]
    ds_read_b64_tr_b16 v[204:205], v219 offset:45056
    v_mfma_f32_16x16x32_bf16 v[168:171], v[212:215], v[80:83], v[168:171]
    ds_read_b64_tr_b16 v[206:207], v219 offset:45568
    v_mfma_f32_16x16x32_bf16 v[172:175], v[212:215], v[84:87], v[172:175]
    ds_read_b64_tr_b16 v[208:209], v218 offset:61440
    s_waitcnt lgkmcnt(5)
    v_mfma_f32_16x16x32_bf16 v[176:179], v[192:195], v[80:83], v[176:179]
    ds_read_b64_tr_b16 v[210:211], v218 offset:61952
    v_mfma_f32_16x16x32_bf16 v[180:183], v[192:195], v[84:87], v[180:183]
    ds_read_b64_tr_b16 v[212:213], v219 offset:61440
    v_mfma_f32_16x16x32_bf16 v[184:187], v[196:199], v[80:83], v[184:187]
    ds_read_b64_tr_b16 v[214:215], v219 offset:61952
    v_mfma_f32_16x16x32_bf16 v[188:191], v[196:199], v[84:87], v[188:191]
    s_waitcnt lgkmcnt(4)
    v_mfma_f32_16x16x32_bf16 v[160:163], v[200:203], v[88:91], v[160:163]
    v_mfma_f32_16x16x32_bf16 v[164:167], v[200:203], v[92:95], v[164:167]
    s_waitcnt lgkmcnt(0)
    s_barrier
    ds_read_b64_tr_b16 v[192:193], v220 offset:0
    ds_read_b64_tr_b16 v[194:195], v220 offset:512
    ds_read_b64_tr_b16 v[196:197], v221 offset:0
    ds_read_b64_tr_b16 v[198:199], v221 offset:512
    v_mfma_f32_16x16x32_bf16 v[168:171], v[204:207], v[88:91], v[168:171]
    v_mfma_f32_16x16x32_bf16 v[172:175], v[204:207], v[92:95], v[172:175]
    ds_read_b64_tr_b16 v[200:201], v220 offset:16384
    v_mfma_f32_16x16x32_bf16 v[176:179], v[208:211], v[88:91], v[176:179]
    ds_read_b64_tr_b16 v[202:203], v220 offset:16896
    v_mfma_f32_16x16x32_bf16 v[180:183], v[208:211], v[92:95], v[180:183]
    ds_read_b64_tr_b16 v[204:205], v221 offset:16384
    v_mfma_f32_16x16x32_bf16 v[184:187], v[212:215], v[88:91], v[184:187]
    ds_read_b64_tr_b16 v[206:207], v221 offset:16896
    v_mfma_f32_16x16x32_bf16 v[188:191], v[212:215], v[92:95], v[188:191]
    ds_read_b64_tr_b16 v[208:209], v220 offset:4096
    s_waitcnt lgkmcnt(5)
    v_mfma_f32_16x16x32_bf16 v[128:131], v[192:195], v[96:99], v[128:131]
    ds_read_b64_tr_b16 v[210:211], v220 offset:4608
    v_mfma_f32_16x16x32_bf16 v[132:135], v[192:195], v[100:103], v[132:135]
    ds_read_b64_tr_b16 v[212:213], v221 offset:4096
    v_mfma_f32_16x16x32_bf16 v[136:139], v[196:199], v[96:99], v[136:139]
    ds_read_b64_tr_b16 v[214:215], v221 offset:4608
    v_mfma_f32_16x16x32_bf16 v[140:143], v[196:199], v[100:103], v[140:143]
    ds_read_b64_tr_b16 v[192:193], v220 offset:20480
    s_waitcnt lgkmcnt(5)
    v_mfma_f32_16x16x32_bf16 v[144:147], v[200:203], v[96:99], v[144:147]
    ds_read_b64_tr_b16 v[194:195], v220 offset:20992
    v_mfma_f32_16x16x32_bf16 v[148:151], v[200:203], v[100:103], v[148:151]
    ds_read_b64_tr_b16 v[196:197], v221 offset:20480
    v_mfma_f32_16x16x32_bf16 v[152:155], v[204:207], v[96:99], v[152:155]
    ds_read_b64_tr_b16 v[198:199], v221 offset:20992
    v_mfma_f32_16x16x32_bf16 v[156:159], v[204:207], v[100:103], v[156:159]
    ds_read_b64_tr_b16 v[200:201], v220 offset:8192
    s_waitcnt lgkmcnt(5)
    v_mfma_f32_16x16x32_bf16 v[128:131], v[208:211], v[104:107], v[128:131]
    ds_read_b64_tr_b16 v[202:203], v220 offset:8704
    v_mfma_f32_16x16x32_bf16 v[132:135], v[208:211], v[108:111], v[132:135]
    ds_read_b64_tr_b16 v[204:205], v221 offset:8192
    s_waitcnt vmcnt(0)
    v_cmp_eq_u32 vcc, 0, v248
    s_nop 0
    s_cbranch_vccz L_nonYc_x
    s_mov_b32 s75, 0
L_nonYc:
    buffer_load_dword v248, v251, s[40:43], 0 offen sc1
    s_waitcnt vmcnt(0)
    s_add_u32 s75, s75, 1
    s_cmp_gt_u32 s75, 1048576
    s_cbranch_scc1 L_nonYc_x
    v_cmp_eq_u32 vcc, 0, v248
    s_nop 0
    s_cbranch_vccnz L_nonYc
L_nonYc_x:
    v_mfma_f32_16x16x32_bf16 v[136:139], v[212:215], v[104:107], v[136:139]
    ds_read_b64_tr_b16 v[206:207], v221 offset:8704
    v_mfma_f32_16x16x32_bf16 v[140:143], v[212:215], v[108:111], v[140:143]
    ds_read_b64_tr_b16 v[208:209], v220 offset:24576
    s_waitcnt lgkmcnt(5)
    v_mfma_f32_16x16x32_bf16 v[144:147], v[192:195], v[104:107], v[144:147]
    ds_read_b64_tr_b16 v[210:211], v220 offset:25088
    v_mfma_f32_16x16x32_bf16 v[148:151], v[192:195], v[108:111], v[148:151]
    ds_read_b64_tr_b16 v[212:213], v221 offset:24576
    v_mfma_f32_16x16x32_bf16 v[152:155], v[196:199], v[104:107], v[152:155]
    ds_read_b64_tr_b16 v[214:215], v221 offset:25088
    v_mfma_f32_16x16x32_bf16 v[156:159], v[196:199], v[108:111], v[156:159]
    ds_read_b64_tr_b16 v[192:193], v220 offset:12288
    s_waitcnt lgkmcnt(5)
    v_mfma_f32_16x16x32_bf16 v[128:131], v[200:203], v[112:115], v[128:131]
    ds_read_b64_tr_b16 v[194:195], v220 offset:12800
    v_mfma_f32_16x16x32_bf16 v[132:135], v[200:203], v[116:119], v[132:135]
    ds_read_b64_tr_b16 v[196:197], v221 offset:12288
    v_mfma_f32_16x16x32_bf16 v[136:139], v[204:207], v[112:115], v[136:139]
    ds_read_b64_tr_b16 v[198:199], v221 offset:12800
    v_mfma_f32_16x16x32_bf16 v[140:143], v[204:207], v[116:119], v[140:143]
    ds_read_b64_tr_b16 v[200:201], v220 offset:28672
    s_waitcnt lgkmcnt(5)
    v_mfma_f32_16x16x32_bf16 v[144:147], v[208:211], v[112:115], v[144:147]
    ds_read_b64_tr_b16 v[202:203], v220 offset:29184
    v_mfma_f32_16x16x32_bf16 v[148:151], v[208:211], v[116:119], v[148:151]
    ds_read_b64_tr_b16 v[204:205], v221 offset:28672
    v_mfma_f32_16x16x32_bf16 v[152:155], v[212:215], v[112:115], v[152:155]
    ds_read_b64_tr_b16 v[206:207], v221 offset:29184
    v_mfma_f32_16x16x32_bf16 v[156:159], v[212:215], v[116:119], v[156:159]
    ds_read_b64_tr_b16 v[208:209], v222 offset:0
    s_waitcnt lgkmcnt(5)
    v_mfma_f32_16x16x32_bf16 v[128:131], v[192:195], v[120:123], v[128:131]
    ds_read_b64_tr_b16 v[210:211], v222 offset:512
    v_mfma_f32_16x16x32_bf16 v[132:135], v[192:195], v[124:127], v[132:135]
    ds_read_b64_tr_b16 v[212:213], v223 offset:0
    v_mfma_f32_16x16x32_bf16 v[136:139], v[196:199], v[120:123], v[136:139]
    ds_read_b64_tr_b16 v[214:215], v223 offset:512
    v_mfma_f32_16x16x32_bf16 v[140:143], v[196:199], v[124:127], v[140:143]
    ds_read_b64_tr_b16 v[192:193], v222 offset:16384
    s_waitcnt lgkmcnt(5)
    v_mfma_f32_16x16x32_bf16 v[144:147], v[200:203], v[120:123], v[144:147]
    ds_read_b64_tr_b16 v[194:195], v222 offset:16896
    v_mfma_f32_16x16x32_bf16 v[148:151], v[200:203], v[124:127], v[148:151]
    ds_read_b64_tr_b16 v[196:197], v223 offset:16384
    v_mfma_f32_16x16x32_bf16 v[152:155], v[204:207], v[120:123], v[152:155]
    ds_read_b64_tr_b16 v[198:199], v223 offset:16896
    v_mfma_f32_16x16x32_bf16 v[156:159], v[204:207], v[124:127], v[156:159]
    ds_read_b64_tr_b16 v[200:201], v222 offset:4096
    s_waitcnt lgkmcnt(5)
    v_mfma_f32_16x16x32_bf16 v[160:163], v[208:211], v[96:99], v[160:163]
    ds_read_b64_tr_b16 v[202:203], v222 offset:4608
    v_mfma_f32_16x16x32_bf16 v[164:167], v[208:211], v[100:103], v[164:167]
    ds_read_b64_tr_b16 v[204:205], v223 offset:4096
    v_mfma_f32_16x16x32_bf16 v[168:171], v[212:215], v[96:99], v[168:171]
    ds_read_b64_tr_b16 v[206:207], v223 offset:4608
    v_max_f32 v128, 0, v128
    v_max_f32 v129, 0, v129
    v_mfma_f32_16x16x32_bf16 v[172:175], v[212:215], v[100:103], v[172:175]
    ds_read_b64_tr_b16 v[208:209], v222 offset:20480
    v_max_f32 v130, 0, v130
    v_max_f32 v131, 0, v131
    v_max_f32 v132, 0, v132
    s_waitcnt lgkmcnt(5)
    v_mfma_f32_16x16x32_bf16 v[176:179], v[192:195], v[96:99], v[176:179]
    ds_read_b64_tr_b16 v[210:211], v222 offset:20992
    v_max_f32 v133, 0, v133
    v_max_f32 v134, 0, v134
    v_mfma_f32_16x16x32_bf16 v[180:183], v[192:195], v[100:103], v[180:183]
    ds_read_b64_tr_b16 v[212:213], v223 offset:20480
    v_max_f32 v135, 0, v135
    v_mul_f32 v128, v128, v144
    v_mul_f32 v129, v129, v145
    v_mfma_f32_16x16x32_bf16 v[184:187], v[196:199], v[96:99], v[184:187]
    ds_read_b64_tr_b16 v[214:215], v223 offset:20992
    v_mul_f32 v130, v130, v146
    v_mul_f32 v131, v131, v147
    v_mfma_f32_16x16x32_bf16 v[188:191], v[196:199], v[100:103], v[188:191]
    ds_read_b64_tr_b16 v[192:193], v222 offset:8192
    v_mul_f32 v132, v132, v148
    v_mul_f32 v133, v133, v149
    v_mul_f32 v134, v134, v150
    s_waitcnt lgkmcnt(5)
    v_mfma_f32_16x16x32_bf16 v[160:163], v[200:203], v[104:107], v[160:163]
    ds_read_b64_tr_b16 v[194:195], v222 offset:8704
    v_mul_f32 v135, v135, v151
    v_mul_f32 v128, v128, v254
    v_mfma_f32_16x16x32_bf16 v[164:167], v[200:203], v[108:111], v[164:167]
    ds_read_b64_tr_b16 v[196:197], v223 offset:8192
    v_mul_f32 v129, v129, v254
    v_mul_f32 v130, v130, v254
    v_mul_f32 v131, v131, v254
    v_mfma_f32_16x16x32_bf16 v[168:171], v[204:207], v[104:107], v[168:171]
    ds_read_b64_tr_b16 v[198:199], v223 offset:8704
    v_cvt_pk_bf16_f32 v224, v128, v129
    v_cvt_pk_bf16_f32 v225, v130, v131
    v_mfma_f32_16x16x32_bf16 v[172:175], v[204:207], v[108:111], v[172:175]
    ds_read_b64_tr_b16 v[200:201], v222 offset:24576
    v_mul_f32 v132, v132, v255
    v_mul_f32 v133, v133, v255
    v_mul_f32 v134, v134, v255
    s_waitcnt lgkmcnt(5)
    v_mfma_f32_16x16x32_bf16 v[176:179], v[208:211], v[104:107], v[176:179]
    ds_read_b64_tr_b16 v[202:203], v222 offset:25088
    v_mul_f32 v135, v135, v255
    v_cvt_pk_bf16_f32 v226, v132, v133
    v_mfma_f32_16x16x32_bf16 v[180:183], v[208:211], v[108:111], v[180:183]
    ds_read_b64_tr_b16 v[204:205], v223 offset:24576
    v_cvt_pk_bf16_f32 v227, v134, v135
    v_max_f32 v136, 0, v136
    v_mfma_f32_16x16x32_bf16 v[184:187], v[212:215], v[104:107], v[184:187]
    ds_read_b64_tr_b16 v[206:207], v223 offset:25088
    v_max_f32 v137, 0, v137
    v_max_f32 v138, 0, v138
    v_mfma_f32_16x16x32_bf16 v[188:191], v[212:215], v[108:111], v[188:191]
    ds_read_b64_tr_b16 v[208:209], v222 offset:12288
    v_max_f32 v139, 0, v139
    v_max_f32 v140, 0, v140
    s_waitcnt lgkmcnt(5)
    v_mfma_f32_16x16x32_bf16 v[160:163], v[192:195], v[112:115], v[160:163]
    ds_read_b64_tr_b16 v[210:211], v222 offset:12800
    v_max_f32 v141, 0, v141
    v_max_f32 v142, 0, v142
    v_mfma_f32_16x16x32_bf16 v[164:167], v[192:195], v[116:119], v[164:167]
    ds_read_b64_tr_b16 v[212:213], v223 offset:12288
    v_max_f32 v143, 0, v143
    v_permlane16_swap_b32 v224, v226
    v_mfma_f32_16x16x32_bf16 v[168:171], v[196:199], v[112:115], v[168:171]
    ds_read_b64_tr_b16 v[214:215], v223 offset:12800
    v_permlane16_swap_b32 v225, v227
    v_mul_f32 v136, v136, v152
    v_mfma_f32_16x16x32_bf16 v[172:175], v[196:199], v[116:119], v[172:175]
    ds_read_b64_tr_b16 v[192:193], v222 offset:28672
    v_mul_f32 v137, v137, v153
    v_mul_f32 v138, v138, v154
    s_waitcnt lgkmcnt(5)
    v_mfma_f32_16x16x32_bf16 v[176:179], v[200:203], v[112:115], v[176:179]
    ds_read_b64_tr_b16 v[194:195], v222 offset:29184
    v_mul_f32 v139, v139, v155
    v_mul_f32 v140, v140, v156
    v_mfma_f32_16x16x32_bf16 v[180:183], v[200:203], v[116:119], v[180:183]
    ds_read_b64_tr_b16 v[196:197], v223 offset:28672
    v_mul_f32 v141, v141, v157
    v_mul_f32 v142, v142, v158
    v_mfma_f32_16x16x32_bf16 v[184:187], v[204:207], v[112:115], v[184:187]
    ds_read_b64_tr_b16 v[198:199], v223 offset:29184
    v_mul_f32 v143, v143, v159
    v_mul_f32 v136, v136, v254
    v_mfma_f32_16x16x32_bf16 v[188:191], v[204:207], v[116:119], v[188:191]
    v_mul_f32 v137, v137, v254
    v_mul_f32 v138, v138, v254
    s_waitcnt lgkmcnt(4)
    v_mfma_f32_16x16x32_bf16 v[160:163], v[208:211], v[120:123], v[160:163]
    v_mfma_f32_16x16x32_bf16 v[164:167], v[208:211], v[124:127], v[164:167]
    s_waitcnt lgkmcnt(0)
    s_barrier
    ds_read_b64_tr_b16 v[200:201], v243 offset:0
    ds_read_b64_tr_b16 v[202:203], v243 offset:256
    ds_read_b64_tr_b16 v[204:205], v245 offset:0
    ds_read_b64_tr_b16 v[206:207], v245 offset:256
    v_mfma_f32_16x16x32_bf16 v[168:171], v[212:215], v[120:123], v[168:171]
    v_mul_f32 v139, v139, v254
    v_cvt_pk_bf16_f32 v228, v136, v137
    v_mfma_f32_16x16x32_bf16 v[172:175], v[212:215], v[124:127], v[172:175]
    ds_read_b64_tr_b16 v[208:209], v243 offset:16384
    v_cvt_pk_bf16_f32 v229, v138, v139
    v_mul_f32 v140, v140, v255
    v_mfma_f32_16x16x32_bf16 v[176:179], v[192:195], v[120:123], v[176:179]
    ds_read_b64_tr_b16 v[210:211], v243 offset:16640
    v_mul_f32 v141, v141, v255
    v_mul_f32 v142, v142, v255
    v_mfma_f32_16x16x32_bf16 v[180:183], v[192:195], v[124:127], v[180:183]
    ds_read_b64_tr_b16 v[212:213], v245 offset:16384
    v_mul_f32 v143, v143, v255
    v_cvt_pk_bf16_f32 v230, v140, v141
    v_mfma_f32_16x16x32_bf16 v[184:187], v[196:199], v[120:123], v[184:187]
    ds_read_b64_tr_b16 v[214:215], v245 offset:16640
    v_cvt_pk_bf16_f32 v231, v142, v143
    s_nop 0
    v_mfma_f32_16x16x32_bf16 v[188:191], v[196:199], v[124:127], v[188:191]
    ds_read_b64_tr_b16 v[192:193], v243 offset:2048
    v_permlane16_swap_b32 v228, v230
    v_permlane16_swap_b32 v229, v231
    s_waitcnt lgkmcnt(5)
    v_mfma_f32_16x16x32_bf16 v[128:131], v[200:203], v[0:3], 0
    ds_read_b64_tr_b16 v[194:195], v243 offset:2304
    v_mfma_f32_16x16x32_bf16 v[132:135], v[200:203], v[4:7], 0
    ds_read_b64_tr_b16 v[196:197], v245 offset:2048
    v_mfma_f32_16x16x32_bf16 v[136:139], v[204:207], v[0:3], 0
    ds_read_b64_tr_b16 v[198:199], v245 offset:2304
    v_max_f32 v160, 0, v160
    v_mfma_f32_16x16x32_bf16 v[140:143], v[204:207], v[4:7], 0
    ds_read_b64_tr_b16 v[200:201], v243 offset:18432
    v_max_f32 v161, 0, v161
    v_max_f32 v162, 0, v162
    s_waitcnt lgkmcnt(5)
    v_mfma_f32_16x16x32_bf16 v[144:147], v[208:211], v[0:3], 0
    ds_read_b64_tr_b16 v[202:203], v243 offset:18688
    v_max_f32 v163, 0, v163
    v_mfma_f32_16x16x32_bf16 v[148:151], v[208:211], v[4:7], 0
    ds_read_b64_tr_b16 v[204:205], v245 offset:18432
    v_max_f32 v164, 0, v164
    v_max_f32 v165, 0, v165
    v_mfma_f32_16x16x32_bf16 v[152:155], v[212:215], v[0:3], 0
    ds_read_b64_tr_b16 v[206:207], v245 offset:18688
    v_max_f32 v166, 0, v166
    v_mfma_f32_16x16x32_bf16 v[156:159], v[212:215], v[4:7], 0
    ds_read_b64_tr_b16 v[208:209], v243 offset:4096
    v_max_f32 v167, 0, v167
    v_mul_f32 v160, v160, v176
    s_waitcnt lgkmcnt(5)
    v_mfma_f32_16x16x32_bf16 v[128:131], v[192:195], v[8:11], v[128:131]
    ds_read_b64_tr_b16 v[210:211], v243 offset:4352
    v_mul_f32 v161, v161, v177
    v_mfma_f32_16x16x32_bf16 v[132:135], v[192:195], v[12:15], v[132:135]
    ds_read_b64_tr_b16 v[212:213], v245 offset:4096
    v_mul_f32 v162, v162, v178
    v_mul_f32 v163, v163, v179
    v_mfma_f32_16x16x32_bf16 v[136:139], v[196:199], v[8:11], v[136:139]
    ds_read_b64_tr_b16 v[214:215], v245 offset:4352
    v_mul_f32 v164, v164, v180
    v_mfma_f32_16x16x32_bf16 v[140:143], v[196:199], v[12:15], v[140:143]
    ds_read_b64_tr_b16 v[192:193], v243 offset:20480
    v_mul_f32 v165, v165, v181
    v_mul_f32 v166, v166, v182
    s_waitcnt lgkmcnt(5)
    v_mfma_f32_16x16x32_bf16 v[144:147], v[200:203], v[8:11], v[144:147]
    ds_read_b64_tr_b16 v[194:195], v243 offset:20736
    v_mul_f32 v167, v167, v183
    v_mfma_f32_16x16x32_bf16 v[148:151], v[200:203], v[12:15], v[148:151]
    ds_read_b64_tr_b16 v[196:197], v245 offset:20480
    v_mul_f32 v160, v160, v254
    v_mul_f32 v161, v161, v254
    v_mfma_f32_16x16x32_bf16 v[152:155], v[204:207], v[8:11], v[152:155]
    ds_read_b64_tr_b16 v[198:199], v245 offset:20736
    v_mul_f32 v162, v162, v254
    v_mfma_f32_16x16x32_bf16 v[156:159], v[204:207], v[12:15], v[156:159]
    ds_read_b64_tr_b16 v[200:201], v243 offset:6144
    v_mul_f32 v163, v163, v254
    v_cvt_pk_bf16_f32 v232, v160, v161
    s_waitcnt lgkmcnt(5)
    v_mfma_f32_16x16x32_bf16 v[128:131], v[208:211], v[16:19], v[128:131]
    ds_read_b64_tr_b16 v[202:203], v243 offset:6400
    v_cvt_pk_bf16_f32 v233, v162, v163
    v_mfma_f32_16x16x32_bf16 v[132:135], v[208:211], v[20:23], v[132:135]
    ds_read_b64_tr_b16 v[204:205], v245 offset:6144
    v_mul_f32 v164, v164, v255
    v_mul_f32 v165, v165, v255
    v_mfma_f32_16x16x32_bf16 v[136:139], v[212:215], v[16:19], v[136:139]
    ds_read_b64_tr_b16 v[206:207], v245 offset:6400
    v_mul_f32 v166, v166, v255
    v_mfma_f32_16x16x32_bf16 v[140:143], v[212:215], v[20:23], v[140:143]
    ds_read_b64_tr_b16 v[208:209], v243 offset:22528
    v_mul_f32 v167, v167, v255
    v_cvt_pk_bf16_f32 v234, v164, v165
    s_waitcnt lgkmcnt(5)
    v_mfma_f32_16x16x32_bf16 v[144:147], v[192:195], v[16:19], v[144:147]
    ds_read_b64_tr_b16 v[210:211], v243 offset:22784
    v_cvt_pk_bf16_f32 v235, v166, v167
    v_mfma_f32_16x16x32_bf16 v[148:151], v[192:195], v[20:23], v[148:151]
    ds_read_b64_tr_b16 v[212:213], v245 offset:22528
    v_max_f32 v168, 0, v168
    v_max_f32 v169, 0, v169
    v_mfma_f32_16x16x32_bf16 v[152:155], v[196:199], v[16:19], v[152:155]
    ds_read_b64_tr_b16 v[214:215], v245 offset:22784
    v_max_f32 v170, 0, v170
    v_mfma_f32_16x16x32_bf16 v[156:159], v[196:199], v[20:23], v[156:159]
    ds_read_b64_tr_b16 v[192:193], v243 offset:8192
    v_max_f32 v171, 0, v171
    v_max_f32 v172, 0, v172
    s_waitcnt lgkmcnt(5)
    v_mfma_f32_16x16x32_bf16 v[128:131], v[200:203], v[24:27], v[128:131]
    ds_read_b64_tr_b16 v[194:195], v243 offset:8448
    v_max_f32 v173, 0, v173
    v_mfma_f32_16x16x32_bf16 v[132:135], v[200:203], v[28:31], v[132:135]
    ds_read_b64_tr_b16 v[196:197], v245 offset:8192
    v_max_f32 v174, 0, v174
    v_max_f32 v175, 0, v175
    v_mfma_f32_16x16x32_bf16 v[136:139], v[204:207], v[24:27], v[136:139]
    ds_read_b64_tr_b16 v[198:199], v245 offset:8448
    v_permlane16_swap_b32 v232, v234
    v_mfma_f32_16x16x32_bf16 v[140:143], v[204:207], v[28:31], v[140:143]
    ds_read_b64_tr_b16 v[200:201], v243 offset:24576
    v_permlane16_swap_b32 v233, v235
    v_mul_f32 v168, v168, v184
    s_waitcnt lgkmcnt(5)
    v_mfma_f32_16x16x32_bf16 v[144:147], v[208:211], v[24:27], v[144:147]
    ds_read_b64_tr_b16 v[202:203], v243 offset:24832
    v_mul_f32 v169, v169, v185
    v_mfma_f32_16x16x32_bf16 v[148:151], v[208:211], v[28:31], v[148:151]
    ds_read_b64_tr_b16 v[204:205], v245 offset:24576
    v_mul_f32 v170, v170, v186
    v_mul_f32 v171, v171, v187
    v_mfma_f32_16x16x32_bf16 v[152:155], v[212:215], v[24:27], v[152:155]
    ds_read_b64_tr_b16 v[206:207], v245 offset:24832
    v_mul_f32 v172, v172, v188
    v_mfma_f32_16x16x32_bf16 v[156:159], v[212:215], v[28:31], v[156:159]
    ds_read_b64_tr_b16 v[208:209], v243 offset:10240
    v_mul_f32 v173, v173, v189
    v_mul_f32 v174, v174, v190
    s_waitcnt lgkmcnt(5)
    v_mfma_f32_16x16x32_bf16 v[128:131], v[192:195], v[32:35], v[128:131]
    ds_read_b64_tr_b16 v[210:211], v243 offset:10496
    v_mul_f32 v175, v175, v191
    v_mfma_f32_16x16x32_bf16 v[132:135], v[192:195], v[36:39], v[132:135]
    ds_read_b64_tr_b16 v[212:213], v245 offset:10240
    v_mul_f32 v168, v168, v254
    v_mul_f32 v169, v169, v254
    v_mfma_f32_16x16x32_bf16 v[136:139], v[196:199], v[32:35], v[136:139]
    ds_read_b64_tr_b16 v[214:215], v245 offset:10496
    v_mul_f32 v170, v170, v254
    v_mfma_f32_16x16x32_bf16 v[140:143], v[196:199], v[36:39], v[140:143]
    ds_read_b64_tr_b16 v[192:193], v243 offset:26624
    v_mul_f32 v171, v171, v254
    v_cvt_pk_bf16_f32 v236, v168, v169
    s_waitcnt lgkmcnt(5)
    v_mfma_f32_16x16x32_bf16 v[144:147], v[200:203], v[32:35], v[144:147]
    ds_read_b64_tr_b16 v[194:195], v243 offset:26880
    v_cvt_pk_bf16_f32 v237, v170, v171
    v_mfma_f32_16x16x32_bf16 v[148:151], v[200:203], v[36:39], v[148:151]
    ds_read_b64_tr_b16 v[196:197], v245 offset:26624
    v_mul_f32 v172, v172, v255
    v_mfma_f32_16x16x32_bf16 v[152:155], v[204:207], v[32:35], v[152:155]
    ds_read_b64_tr_b16 v[198:199], v245 offset:26880
    v_mul_f32 v173, v173, v255
    v_mfma_f32_16x16x32_bf16 v[156:159], v[204:207], v[36:39], v[156:159]
    ds_read_b64_tr_b16 v[200:201], v243 offset:12288
    buffer_store_dwordx4 v[224:227], v242, s[20:23], s68 offen offset:0 sc1
    v_mul_f32 v174, v174, v255
    s_waitcnt lgkmcnt(5)
    v_mfma_f32_16x16x32_bf16 v[128:131], v[208:211], v[40:43], v[128:131]
    ds_read_b64_tr_b16 v[202:203], v243 offset:12544
    v_mul_f32 v175, v175, v255
    v_mfma_f32_16x16x32_bf16 v[132:135], v[208:211], v[44:47], v[132:135]
    ds_read_b64_tr_b16 v[204:205], v245 offset:12288
    v_cvt_pk_bf16_f32 v238, v172, v173
    v_mfma_f32_16x16x32_bf16 v[136:139], v[212:215], v[40:43], v[136:139]
    ds_read_b64_tr_b16 v[206:207], v245 offset:12544
    v_cvt_pk_bf16_f32 v239, v174, v175
    v_mfma_f32_16x16x32_bf16 v[140:143], v[212:215], v[44:47], v[140:143]
    ds_read_b64_tr_b16 v[208:209], v243 offset:28672
    buffer_store_dwordx4 v[228:231], v242, s[20:23], s68 offen offset:1024 sc1
    s_nop 0
    s_waitcnt lgkmcnt(5)
    v_mfma_f32_16x16x32_bf16 v[144:147], v[192:195], v[40:43], v[144:147]
    ds_read_b64_tr_b16 v[210:211], v243 offset:28928
    v_permlane16_swap_b32 v236, v238
    v_mfma_f32_16x16x32_bf16 v[148:151], v[192:195], v[44:47], v[148:151]
    ds_read_b64_tr_b16 v[212:213], v245 offset:28672
    v_permlane16_swap_b32 v237, v239
    v_mfma_f32_16x16x32_bf16 v[152:155], v[196:199], v[40:43], v[152:155]
    ds_read_b64_tr_b16 v[214:215], v245 offset:28928
    v_mfma_f32_16x16x32_bf16 v[156:159], v[196:199], v[44:47], v[156:159]
    ds_read_b64_tr_b16 v[192:193], v243 offset:14336
    buffer_store_dwordx4 v[232:235], v242, s[20:23], s68 offen offset:2048 sc1
    s_waitcnt lgkmcnt(5)
    v_mfma_f32_16x16x32_bf16 v[128:131], v[200:203], v[48:51], v[128:131]
    ds_read_b64_tr_b16 v[194:195], v243 offset:14592
    v_mfma_f32_16x16x32_bf16 v[132:135], v[200:203], v[52:55], v[132:135]
    ds_read_b64_tr_b16 v[196:197], v245 offset:14336
    buffer_store_dwordx4 v[236:239], v242, s[20:23], s68 offen offset:3072 sc1
    v_mfma_f32_16x16x32_bf16 v[136:139], v[204:207], v[48:51], v[136:139]
    ds_read_b64_tr_b16 v[198:199], v245 offset:14592
    v_mfma_f32_16x16x32_bf16 v[140:143], v[204:207], v[52:55], v[140:143]
    ds_read_b64_tr_b16 v[200:201], v243 offset:30720
    s_waitcnt lgkmcnt(5)
    v_mfma_f32_16x16x32_bf16 v[144:147], v[208:211], v[48:51], v[144:147]
    ds_read_b64_tr_b16 v[202:203], v243 offset:30976
    v_mfma_f32_16x16x32_bf16 v[148:151], v[208:211], v[52:55], v[148:151]
    ds_read_b64_tr_b16 v[204:205], v245 offset:30720
    v_mfma_f32_16x16x32_bf16 v[152:155], v[212:215], v[48:51], v[152:155]
    ds_read_b64_tr_b16 v[206:207], v245 offset:30976
    v_mfma_f32_16x16x32_bf16 v[156:159], v[212:215], v[52:55], v[156:159]
    s_waitcnt lgkmcnt(4)
    v_mfma_f32_16x16x32_bf16 v[128:131], v[192:195], v[56:59], v[128:131]
    v_mfma_f32_16x16x32_bf16 v[132:135], v[192:195], v[60:63], v[132:135]
    s_waitcnt lgkmcnt(0)
    s_barrier
    ds_read_b64_tr_b16 v[208:209], v243 offset:32768
    ds_read_b64_tr_b16 v[210:211], v243 offset:33024
    ds_read_b64_tr_b16 v[212:213], v245 offset:32768
    ds_read_b64_tr_b16 v[214:215], v245 offset:33024
    v_mfma_f32_16x16x32_bf16 v[136:139], v[196:199], v[56:59], v[136:139]
    v_mfma_f32_16x16x32_bf16 v[140:143], v[196:199], v[60:63], v[140:143]
    ds_read_b64_tr_b16 v[192:193], v243 offset:49152
    v_mfma_f32_16x16x32_bf16 v[144:147], v[200:203], v[56:59], v[144:147]
    ds_read_b64_tr_b16 v[194:195], v243 offset:49408
    v_mfma_f32_16x16x32_bf16 v[148:151], v[200:203], v[60:63], v[148:151]
    ds_read_b64_tr_b16 v[196:197], v245 offset:49152
    v_mfma_f32_16x16x32_bf16 v[152:155], v[204:207], v[56:59], v[152:155]
    ds_read_b64_tr_b16 v[198:199], v245 offset:49408
    v_mfma_f32_16x16x32_bf16 v[156:159], v[204:207], v[60:63], v[156:159]
    ds_read_b64_tr_b16 v[200:201], v243 offset:34816
    s_waitcnt lgkmcnt(5)
    v_mfma_f32_16x16x32_bf16 v[128:131], v[208:211], v[64:67], v[128:131]
    ds_read_b64_tr_b16 v[202:203], v243 offset:35072
    v_mfma_f32_16x16x32_bf16 v[132:135], v[208:211], v[68:71], v[132:135]
    ds_read_b64_tr_b16 v[204:205], v245 offset:34816
    v_mfma_f32_16x16x32_bf16 v[136:139], v[212:215], v[64:67], v[136:139]
    ds_read_b64_tr_b16 v[206:207], v245 offset:35072
    v_mfma_f32_16x16x32_bf16 v[140:143], v[212:215], v[68:71], v[140:143]
    ds_read_b64_tr_b16 v[208:209], v243 offset:51200
    s_waitcnt lgkmcnt(5)
    v_mfma_f32_16x16x32_bf16 v[144:147], v[192:195], v[64:67], v[144:147]
    ds_read_b64_tr_b16 v[210:211], v243 offset:51456
    v_mfma_f32_16x16x32_bf16 v[148:151], v[192:195], v[68:71], v[148:151]
    ds_read_b64_tr_b16 v[212:213], v245 offset:51200
    v_mfma_f32_16x16x32_bf16 v[152:155], v[196:199], v[64:67], v[152:155]
    ds_read_b64_tr_b16 v[214:215], v245 offset:51456
    v_mfma_f32_16x16x32_bf16 v[156:159], v[196:199], v[68:71], v[156:159]
    ds_read_b64_tr_b16 v[192:193], v243 offset:36864
    s_waitcnt lgkmcnt(5)
    v_mfma_f32_16x16x32_bf16 v[128:131], v[200:203], v[72:75], v[128:131]
    ds_read_b64_tr_b16 v[194:195], v243 offset:37120
    v_mfma_f32_16x16x32_bf16 v[132:135], v[200:203], v[76:79], v[132:135]
    ds_read_b64_tr_b16 v[196:197], v245 offset:36864
    v_mfma_f32_16x16x32_bf16 v[136:139], v[204:207], v[72:75], v[136:139]
    ds_read_b64_tr_b16 v[198:199], v245 offset:37120
    v_mfma_f32_16x16x32_bf16 v[140:143], v[204:207], v[76:79], v[140:143]
    ds_read_b64_tr_b16 v[200:201], v243 offset:53248
    s_waitcnt lgkmcnt(5)
    v_mfma_f32_16x16x32_bf16 v[144:147], v[208:211], v[72:75], v[144:147]
    ds_read_b64_tr_b16 v[202:203], v243 offset:53504
    v_mfma_f32_16x16x32_bf16 v[148:151], v[208:211], v[76:79], v[148:151]
    ds_read_b64_tr_b16 v[204:205], v245 offset:53248
    v_mfma_f32_16x16x32_bf16 v[152:155], v[212:215], v[72:75], v[152:155]
    ds_read_b64_tr_b16 v[206:207], v245 offset:53504
    v_mfma_f32_16x16x32_bf16 v[156:159], v[212:215], v[76:79], v[156:159]
    ds_read_b64_tr_b16 v[208:209], v243 offset:38912
    s_waitcnt lgkmcnt(5)
    v_mfma_f32_16x16x32_bf16 v[128:131], v[192:195], v[80:83], v[128:131]
    ds_read_b64_tr_b16 v[210:211], v243 offset:39168
    v_mfma_f32_16x16x32_bf16 v[132:135], v[192:195], v[84:87], v[132:135]
    ds_read_b64_tr_b16 v[212:213], v245 offset:38912
    v_mfma_f32_16x16x32_bf16 v[136:139], v[196:199], v[80:83], v[136:139]
    ds_read_b64_tr_b16 v[214:215], v245 offset:39168
    v_mfma_f32_16x16x32_bf16 v[140:143], v[196:199], v[84:87], v[140:143]
    ds_read_b64_tr_b16 v[192:193], v243 offset:55296
    s_waitcnt lgkmcnt(5)
    v_mfma_f32_16x16x32_bf16 v[144:147], v[200:203], v[80:83], v[144:147]
    ds_read_b64_tr_b16 v[194:195], v243 offset:55552
    v_mfma_f32_16x16x32_bf16 v[148:151], v[200:203], v[84:87], v[148:151]
    ds_read_b64_tr_b16 v[196:197], v245 offset:55296
    v_mfma_f32_16x16x32_bf16 v[152:155], v[204:207], v[80:83], v[152:155]
    ds_read_b64_tr_b16 v[198:199], v245 offset:55552
    v_mfma_f32_16x16x32_bf16 v[156:159], v[204:207], v[84:87], v[156:159]
    ds_read_b64_tr_b16 v[200:201], v243 offset:40960
    s_waitcnt lgkmcnt(5)
    v_mfma_f32_16x16x32_bf16 v[128:131], v[208:211], v[88:91], v[128:131]
    ds_read_b64_tr_b16 v[202:203], v243 offset:41216
    v_mfma_f32_16x16x32_bf16 v[132:135], v[208:211], v[92:95], v[132:135]
    ds_read_b64_tr_b16 v[204:205], v245 offset:40960
    v_mfma_f32_16x16x32_bf16 v[136:139], v[212:215], v[88:91], v[136:139]
    ds_read_b64_tr_b16 v[206:207], v245 offset:41216
    v_mfma_f32_16x16x32_bf16 v[140:143], v[212:215], v[92:95], v[140:143]
    ds_read_b64_tr_b16 v[208:209], v243 offset:57344
    s_waitcnt lgkmcnt(5)
    v_mfma_f32_16x16x32_bf16 v[144:147], v[192:195], v[88:91], v[144:147]
    ds_read_b64_tr_b16 v[210:211], v243 offset:57600
    v_mfma_f32_16x16x32_bf16 v[148:151], v[192:195], v[92:95], v[148:151]
    ds_read_b64_tr_b16 v[212:213], v245 offset:57344
    v_mfma_f32_16x16x32_bf16 v[152:155], v[196:199], v[88:91], v[152:155]
    ds_read_b64_tr_b16 v[214:215], v245 offset:57600
    v_mfma_f32_16x16x32_bf16 v[156:159], v[196:199], v[92:95], v[156:159]
    ds_read_b64_tr_b16 v[192:193], v243 offset:43008
    s_waitcnt lgkmcnt(5)
    v_mfma_f32_16x16x32_bf16 v[128:131], v[200:203], v[96:99], v[128:131]
    ds_read_b64_tr_b16 v[194:195], v243 offset:43264
    v_mfma_f32_16x16x32_bf16 v[132:135], v[200:203], v[100:103], v[132:135]
    ds_read_b64_tr_b16 v[196:197], v245 offset:43008
    v_mfma_f32_16x16x32_bf16 v[136:139], v[204:207], v[96:99], v[136:139]
    ds_read_b64_tr_b16 v[198:199], v245 offset:43264
    v_mfma_f32_16x16x32_bf16 v[140:143], v[204:207], v[100:103], v[140:143]
    ds_read_b64_tr_b16 v[200:201], v243 offset:59392
    s_waitcnt lgkmcnt(5)
    v_mfma_f32_16x16x32_bf16 v[144:147], v[208:211], v[96:99], v[144:147]
    ds_read_b64_tr_b16 v[202:203], v243 offset:59648
    v_mfma_f32_16x16x32_bf16 v[148:151], v[208:211], v[100:103], v[148:151]
    ds_read_b64_tr_b16 v[204:205], v245 offset:59392
    v_mfma_f32_16x16x32_bf16 v[152:155], v[212:215], v[96:99], v[152:155]
    ds_read_b64_tr_b16 v[206:207], v245 offset:59648
    v_mfma_f32_16x16x32_bf16 v[156:159], v[212:215], v[100:103], v[156:159]
    ds_read_b64_tr_b16 v[208:209], v243 offset:45056
    s_waitcnt lgkmcnt(5)
    v_mfma_f32_16x16x32_bf16 v[128:131], v[192:195], v[104:107], v[128:131]
    ds_read_b64_tr_b16 v[210:211], v243 offset:45312
    v_mfma_f32_16x16x32_bf16 v[132:135], v[192:195], v[108:111], v[132:135]
    ds_read_b64_tr_b16 v[212:213], v245 offset:45056
    v_mfma_f32_16x16x32_bf16 v[136:139], v[196:199], v[104:107], v[136:139]
    ds_read_b64_tr_b16 v[214:215], v245 offset:45312
    v_mfma_f32_16x16x32_bf16 v[140:143], v[196:199], v[108:111], v[140:143]
    ds_read_b64_tr_b16 v[192:193], v243 offset:61440
    s_waitcnt lgkmcnt(5)
    v_mfma_f32_16x16x32_bf16 v[144:147], v[200:203], v[104:107], v[144:147]
    ds_read_b64_tr_b16 v[194:195], v243 offset:61696
    v_mfma_f32_16x16x32_bf16 v[148:151], v[200:203], v[108:111], v[148:151]
    ds_read_b64_tr_b16 v[196:197], v245 offset:61440
    v_mfma_f32_16x16x32_bf16 v[152:155], v[204:207], v[104:107], v[152:155]
    ds_read_b64_tr_b16 v[198:199], v245 offset:61696
    v_mfma_f32_16x16x32_bf16 v[156:159], v[204:207], v[108:111], v[156:159]
    ds_read_b64_tr_b16 v[200:201], v243 offset:47104
    s_waitcnt lgkmcnt(5)
    v_mfma_f32_16x16x32_bf16 v[128:131], v[208:211], v[112:115], v[128:131]
    ds_read_b64_tr_b16 v[202:203], v243 offset:47360
    v_mfma_f32_16x16x32_bf16 v[132:135], v[208:211], v[116:119], v[132:135]
    ds_read_b64_tr_b16 v[204:205], v245 offset:47104
    v_mfma_f32_16x16x32_bf16 v[136:139], v[212:215], v[112:115], v[136:139]
    ds_read_b64_tr_b16 v[206:207], v245 offset:47360
    v_mfma_f32_16x16x32_bf16 v[140:143], v[212:215], v[116:119], v[140:143]
    ds_read_b64_tr_b16 v[208:209], v243 offset:63488
    s_waitcnt lgkmcnt(5)
    v_mfma_f32_16x16x32_bf16 v[144:147], v[192:195], v[112:115], v[144:147]
    ds_read_b64_tr_b16 v[210:211], v243 offset:63744
    v_mfma_f32_16x16x32_bf16 v[148:151], v[192:195], v[116:119], v[148:151]
    ds_read_b64_tr_b16 v[212:213], v245 offset:63488
    v_mfma_f32_16x16x32_bf16 v[152:155], v[196:199], v[112:115], v[152:155]
    ds_read_b64_tr_b16 v[214:215], v245 offset:63744
    v_mfma_f32_16x16x32_bf16 v[156:159], v[196:199], v[116:119], v[156:159]
    s_waitcnt lgkmcnt(4)
    v_mfma_f32_16x16x32_bf16 v[128:131], v[200:203], v[120:123], v[128:131]
    v_mfma_f32_16x16x32_bf16 v[132:135], v[200:203], v[124:127], v[132:135]
    s_waitcnt lgkmcnt(0)
    s_barrier
    ds_read_b64_tr_b16 v[192:193], v220 offset:0
    ds_read_b64_tr_b16 v[194:195], v220 offset:512
    ds_read_b64_tr_b16 v[196:197], v221 offset:0
    ds_read_b64_tr_b16 v[198:199], v221 offset:512
    v_mfma_f32_16x16x32_bf16 v[136:139], v[204:207], v[120:123], v[136:139]
    v_mfma_f32_16x16x32_bf16 v[140:143], v[204:207], v[124:127], v[140:143]
    ds_read_b64_tr_b16 v[200:201], v220 offset:16384
    v_mfma_f32_16x16x32_bf16 v[144:147], v[208:211], v[120:123], v[144:147]
    ds_read_b64_tr_b16 v[202:203], v220 offset:16896
    v_mfma_f32_16x16x32_bf16 v[148:151], v[208:211], v[124:127], v[148:151]
    ds_read_b64_tr_b16 v[204:205], v221 offset:16384
    v_mfma_f32_16x16x32_bf16 v[152:155], v[212:215], v[120:123], v[152:155]
    ds_read_b64_tr_b16 v[206:207], v221 offset:16896
    v_mfma_f32_16x16x32_bf16 v[156:159], v[212:215], v[124:127], v[156:159]
    ds_read_b64_tr_b16 v[208:209], v220 offset:4096
    s_waitcnt lgkmcnt(5)
    v_mfma_f32_16x16x32_bf16 v[160:163], v[192:195], v[0:3], 0
    ds_read_b64_tr_b16 v[210:211], v220 offset:4608
    v_mfma_f32_16x16x32_bf16 v[164:167], v[192:195], v[4:7], 0
    ds_read_b64_tr_b16 v[212:213], v221 offset:4096
    v_mfma_f32_16x16x32_bf16 v[168:171], v[196:199], v[0:3], 0
    ds_read_b64_tr_b16 v[214:215], v221 offset:4608
    v_max_f32 v128, 0, v128
    v_max_f32 v129, 0, v129
    v_mfma_f32_16x16x32_bf16 v[172:175], v[196:199], v[4:7], 0
    ds_read_b64_tr_b16 v[192:193], v220 offset:20480
    v_max_f32 v130, 0, v130
    v_max_f32 v131, 0, v131
    v_max_f32 v132, 0, v132
    s_waitcnt lgkmcnt(5)
    v_mfma_f32_16x16x32_bf16 v[176:179], v[200:203], v[0:3], 0
    ds_read_b64_tr_b16 v[194:195], v220 offset:20992
    v_max_f32 v133, 0, v133
    v_max_f32 v134, 0, v134
    v_mfma_f32_16x16x32_bf16 v[180:183], v[200:203], v[4:7], 0
    ds_read_b64_tr_b16 v[196:197], v221 offset:20480
    v_max_f32 v135, 0, v135
    v_mul_f32 v128, v128, v144
    v_mfma_f32_16x16x32_bf16 v[184:187], v[204:207], v[0:3], 0
    ds_read_b64_tr_b16 v[198:199], v221 offset:20992
    v_mul_f32 v129, v129, v145
    v_mul_f32 v130, v130, v146
    v_mfma_f32_16x16x32_bf16 v[188:191], v[204:207], v[4:7], 0
    ds_read_b64_tr_b16 v[200:201], v220 offset:8192
    v_mul_f32 v131, v131, v147
    v_mul_f32 v132, v132, v148
    s_waitcnt lgkmcnt(5)
    v_mfma_f32_16x16x32_bf16 v[160:163], v[208:211], v[8:11], v[160:163]
    ds_read_b64_tr_b16 v[202:203], v220 offset:8704
    v_mul_f32 v133, v133, v149
    v_mul_f32 v134, v134, v150
    v_mfma_f32_16x16x32_bf16 v[164:167], v[208:211], v[12:15], v[164:167]
    ds_read_b64_tr_b16 v[204:205], v221 offset:8192
    v_mul_f32 v135, v135, v151
    v_mul_f32 v128, v128, v254
    v_mfma_f32_16x16x32_bf16 v[168:171], v[212:215], v[8:11], v[168:171]
    ds_read_b64_tr_b16 v[206:207], v221 offset:8704
    v_mul_f32 v129, v129, v254
    v_mul_f32 v130, v130, v254
    v_mfma_f32_16x16x32_bf16 v[172:175], v[212:215], v[12:15], v[172:175]
    ds_read_b64_tr_b16 v[208:209], v220 offset:24576
    v_mul_f32 v131, v131, v254
    v_cvt_pk_bf16_f32 v224, v128, v129
    s_waitcnt lgkmcnt(5)
    v_mfma_f32_16x16x32_bf16 v[176:179], v[192:195], v[8:11], v[176:179]
    ds_read_b64_tr_b16 v[210:211], v220 offset:25088
    v_cvt_pk_bf16_f32 v225, v130, v131
    v_mul_f32 v132, v132, v255
    v_mfma_f32_16x16x32_bf16 v[180:183], v[192:195], v[12:15], v[180:183]
    ds_read_b64_tr_b16 v[212:213], v221 offset:24576
    v_mul_f32 v133, v133, v255
    v_mul_f32 v134, v134, v255
    v_mfma_f32_16x16x32_bf16 v[184:187], v[196:199], v[8:11], v[184:187]
    ds_read_b64_tr_b16 v[214:215], v221 offset:25088
    v_mul_f32 v135, v135, v255
    v_cvt_pk_bf16_f32 v226, v132, v133
    v_mfma_f32_16x16x32_bf16 v[188:191], v[196:199], v[12:15], v[188:191]
    ds_read_b64_tr_b16 v[192:193], v220 offset:12288
    v_cvt_pk_bf16_f32 v227, v134, v135
    v_max_f32 v136, 0, v136
    s_waitcnt lgkmcnt(5)
    v_mfma_f32_16x16x32_bf16 v[160:163], v[200:203], v[16:19], v[160:163]
    ds_read_b64_tr_b16 v[194:195], v220 offset:12800
    v_max_f32 v137, 0, v137
    v_max_f32 v138, 0, v138
    v_mfma_f32_16x16x32_bf16 v[164:167], v[200:203], v[20:23], v[164:167]
    ds_read_b64_tr_b16 v[196:197], v221 offset:12288
    v_max_f32 v139, 0, v139
    v_max_f32 v140, 0, v140
    v_mfma_f32_16x16x32_bf16 v[168:171], v[204:207], v[16:19], v[168:171]
    ds_read_b64_tr_b16 v[198:199], v221 offset:12800
    v_max_f32 v141, 0, v141
    v_max_f32 v142, 0, v142
    v_mfma_f32_16x16x32_bf16 v[172:175], v[204:207], v[20:23], v[172:175]
    ds_read_b64_tr_b16 v[200:201], v220 offset:28672
    v_max_f32 v143, 0, v143
    v_permlane16_swap_b32 v224, v226
    s_waitcnt lgkmcnt(5)
    v_mfma_f32_16x16x32_bf16 v[176:179], v[208:211], v[16:19], v[176:179]
    ds_read_b64_tr_b16 v[202:203], v220 offset:29184
    v_permlane16_swap_b32 v225, v227
    v_mul_f32 v136, v136, v152
    v_mfma_f32_16x16x32_bf16 v[180:183], v[208:211], v[20:23], v[180:183]
    ds_read_b64_tr_b16 v[204:205], v221 offset:28672
    v_mul_f32 v137, v137, v153
    v_mul_f32 v138, v138, v154
    v_mfma_f32_16x16x32_bf16 v[184:187], v[212:215], v[16:19], v[184:187]
    ds_read_b64_tr_b16 v[206:207], v221 offset:29184
    v_mul_f32 v139, v139, v155
    v_mul_f32 v140, v140, v156
    v_mfma_f32_16x16x32_bf16 v[188:191], v[212:215], v[20:23], v[188:191]
    ds_read_b64_tr_b16 v[208:209], v222 offset:0
    v_mul_f32 v141, v141, v157
    v_mul_f32 v142, v142, v158
    s_waitcnt lgkmcnt(5)
    v_mfma_f32_16x16x32_bf16 v[160:163], v[192:195], v[24:27], v[160:163]
    ds_read_b64_tr_b16 v[210:211], v222 offset:512
    v_mul_f32 v143, v143, v159
    v_mul_f32 v136, v136, v254
    v_mfma_f32_16x16x32_bf16 v[164:167], v[192:195], v[28:31], v[164:167]
    ds_read_b64_tr_b16 v[212:213], v223 offset:0
    v_mul_f32 v137, v137, v254
    v_mul_f32 v138, v138, v254
    v_mfma_f32_16x16x32_bf16 v[168:171], v[196:199], v[24:27], v[168:171]
    ds_read_b64_tr_b16 v[214:215], v223 offset:512
    v_mul_f32 v139, v139, v254
    v_cvt_pk_bf16_f32 v228, v136, v137
    v_mfma_f32_16x16x32_bf16 v[172:175], v[196:199], v[28:31], v[172:175]
    ds_read_b64_tr_b16 v[192:193], v222 offset:16384
    v_cvt_pk_bf16_f32 v229, v138, v139
    v_mul_f32 v140, v140, v255
    s_waitcnt lgkmcnt(5)
    v_mfma_f32_16x16x32_bf16 v[176:179], v[200:203], v[24:27], v[176:179]
    ds_read_b64_tr_b16 v[194:195], v222 offset:16896
    v_mul_f32 v141, v141, v255
    v_mul_f32 v142, v142, v255
    v_mfma_f32_16x16x32_bf16 v[180:183], v[200:203], v[28:31], v[180:183]
    ds_read_b64_tr_b16 v[196:197], v223 offset:16384
    v_mul_f32 v143, v143, v255
    v_cvt_pk_bf16_f32 v230, v140, v141
    v_mfma_f32_16x16x32_bf16 v[184:187], v[204:207], v[24:27], v[184:187]
    ds_read_b64_tr_b16 v[198:199], v223 offset:16896
    v_cvt_pk_bf16_f32 v231, v142, v143
    s_nop 0
    v_mfma_f32_16x16x32_bf16 v[188:191], v[204:207], v[28:31], v[188:191]
    ds_read_b64_tr_b16 v[200:201], v222 offset:4096
    v_permlane16_swap_b32 v228, v230
    v_permlane16_swap_b32 v229, v231
    s_waitcnt lgkmcnt(5)
    v_mfma_f32_16x16x32_bf16 v[128:131], v[208:211], v[0:3], 0
    ds_read_b64_tr_b16 v[202:203], v222 offset:4608
    v_mfma_f32_16x16x32_bf16 v[132:135], v[208:211], v[4:7], 0
    ds_read_b64_tr_b16 v[204:205], v223 offset:4096
    v_mfma_f32_16x16x32_bf16 v[136:139], v[212:215], v[0:3], 0
    ds_read_b64_tr_b16 v[206:207], v223 offset:4608
    v_mfma_f32_16x16x32_bf16 v[140:143], v[212:215], v[4:7], 0
    ds_read_b64_tr_b16 v[208:209], v222 offset:20480
    s_waitcnt lgkmcnt(5)
    v_mfma_f32_16x16x32_bf16 v[144:147], v[192:195], v[0:3], 0
    ds_read_b64_tr_b16 v[210:211], v222 offset:20992
    v_mfma_f32_16x16x32_bf16 v[148:151], v[192:195], v[4:7], 0
    ds_read_b64_tr_b16 v[212:213], v223 offset:20480
    v_mfma_f32_16x16x32_bf16 v[152:155], v[196:199], v[0:3], 0
    ds_read_b64_tr_b16 v[214:215], v223 offset:20992
    v_mfma_f32_16x16x32_bf16 v[156:159], v[196:199], v[4:7], 0
    ds_read_b64_tr_b16 v[192:193], v222 offset:8192
    s_waitcnt lgkmcnt(5)
    v_mfma_f32_16x16x32_bf16 v[128:131], v[200:203], v[8:11], v[128:131]
    ds_read_b64_tr_b16 v[194:195], v222 offset:8704
    v_mfma_f32_16x16x32_bf16 v[132:135], v[200:203], v[12:15], v[132:135]
    ds_read_b64_tr_b16 v[196:197], v223 offset:8192
    v_mfma_f32_16x16x32_bf16 v[136:139], v[204:207], v[8:11], v[136:139]
    ds_read_b64_tr_b16 v[198:199], v223 offset:8704
    v_mfma_f32_16x16x32_bf16 v[140:143], v[204:207], v[12:15], v[140:143]
    ds_read_b64_tr_b16 v[200:201], v222 offset:24576
    buffer_store_dwordx4 v[224:227], v242, s[20:23], s69 offen offset:0 sc1
    s_waitcnt lgkmcnt(5)
    v_mfma_f32_16x16x32_bf16 v[144:147], v[208:211], v[8:11], v[144:147]
    ds_read_b64_tr_b16 v[202:203], v222 offset:25088
    v_mfma_f32_16x16x32_bf16 v[148:151], v[208:211], v[12:15], v[148:151]
    ds_read_b64_tr_b16 v[204:205], v223 offset:24576
    v_mfma_f32_16x16x32_bf16 v[152:155], v[212:215], v[8:11], v[152:155]
    ds_read_b64_tr_b16 v[206:207], v223 offset:25088
    v_mfma_f32_16x16x32_bf16 v[156:159], v[212:215], v[12:15], v[156:159]
    ds_read_b64_tr_b16 v[208:209], v222 offset:12288
    s_waitcnt lgkmcnt(5)
    v_mfma_f32_16x16x32_bf16 v[128:131], v[192:195], v[16:19], v[128:131]
    ds_read_b64_tr_b16 v[210:211], v222 offset:12800
    v_mfma_f32_16x16x32_bf16 v[132:135], v[192:195], v[20:23], v[132:135]
    ds_read_b64_tr_b16 v[212:213], v223 offset:12288
    buffer_store_dwordx4 v[228:231], v242, s[20:23], s69 offen offset:1024 sc1
    v_mfma_f32_16x16x32_bf16 v[136:139], v[196:199], v[16:19], v[136:139]
    ds_read_b64_tr_b16 v[214:215], v223 offset:12800
    v_mfma_f32_16x16x32_bf16 v[140:143], v[196:199], v[20:23], v[140:143]
    ds_read_b64_tr_b16 v[192:193], v222 offset:28672
    s_waitcnt lgkmcnt(5)
    v_mfma_f32_16x16x32_bf16 v[144:147], v[200:203], v[16:19], v[144:147]
    ds_read_b64_tr_b16 v[194:195], v222 offset:29184
    v_mfma_f32_16x16x32_bf16 v[148:151], v[200:203], v[20:23], v[148:151]
    ds_read_b64_tr_b16 v[196:197], v223 offset:28672
    v_mfma_f32_16x16x32_bf16 v[152:155], v[204:207], v[16:19], v[152:155]
    ds_read_b64_tr_b16 v[198:199], v223 offset:29184
    v_mfma_f32_16x16x32_bf16 v[156:159], v[204:207], v[20:23], v[156:159]
    s_waitcnt lgkmcnt(4)
    v_mfma_f32_16x16x32_bf16 v[128:131], v[208:211], v[24:27], v[128:131]
    v_mfma_f32_16x16x32_bf16 v[132:135], v[208:211], v[28:31], v[132:135]
    s_waitcnt lgkmcnt(0)
    s_barrier
    ds_read_b64_tr_b16 v[200:201], v216 offset:0
    ds_read_b64_tr_b16 v[202:203], v216 offset:512
    ds_read_b64_tr_b16 v[204:205], v217 offset:0
    ds_read_b64_tr_b16 v[206:207], v217 offset:512
    v_mfma_f32_16x16x32_bf16 v[136:139], v[212:215], v[24:27], v[136:139]
    v_mfma_f32_16x16x32_bf16 v[140:143], v[212:215], v[28:31], v[140:143]
    ds_read_b64_tr_b16 v[208:209], v216 offset:16384
    v_mfma_f32_16x16x32_bf16 v[144:147], v[192:195], v[24:27], v[144:147]
    ds_read_b64_tr_b16 v[210:211], v216 offset:16896
    v_mfma_f32_16x16x32_bf16 v[148:151], v[192:195], v[28:31], v[148:151]
    ds_read_b64_tr_b16 v[212:213], v217 offset:16384
    v_mfma_f32_16x16x32_bf16 v[152:155], v[196:199], v[24:27], v[152:155]
    ds_read_b64_tr_b16 v[214:215], v217 offset:16896
    v_mfma_f32_16x16x32_bf16 v[156:159], v[196:199], v[28:31], v[156:159]
    ds_read_b64_tr_b16 v[192:193], v216 offset:4096
    s_waitcnt lgkmcnt(5)
    v_mfma_f32_16x16x32_bf16 v[160:163], v[200:203], v[32:35], v[160:163]
    ds_read_b64_tr_b16 v[194:195], v216 offset:4608
    v_mfma_f32_16x16x32_bf16 v[164:167], v[200:203], v[36:39], v[164:167]
    ds_read_b64_tr_b16 v[196:197], v217 offset:4096
    v_mfma_f32_16x16x32_bf16 v[168:171], v[204:207], v[32:35], v[168:171]
    ds_read_b64_tr_b16 v[198:199], v217 offset:4608
    v_mfma_f32_16x16x32_bf16 v[172:175], v[204:207], v[36:39], v[172:175]
    ds_read_b64_tr_b16 v[200:201], v216 offset:20480
    s_waitcnt lgkmcnt(5)
    v_mfma_f32_16x16x32_bf16 v[176:179], v[208:211], v[32:35], v[176:179]
    ds_read_b64_tr_b16 v[202:203], v216 offset:20992
    v_mfma_f32_16x16x32_bf16 v[180:183], v[208:211], v[36:39], v[180:183]
    ds_read_b64_tr_b16 v[204:205], v217 offset:20480
    v_mfma_f32_16x16x32_bf16 v[184:187], v[212:215], v[32:35], v[184:187]
    ds_read_b64_tr_b16 v[206:207], v217 offset:20992
    v_mfma_f32_16x16x32_bf16 v[188:191], v[212:215], v[36:39], v[188:191]
    ds_read_b64_tr_b16 v[208:209], v216 offset:8192
    s_waitcnt lgkmcnt(5)
    v_mfma_f32_16x16x32_bf16 v[160:163], v[192:195], v[40:43], v[160:163]
    ds_read_b64_tr_b16 v[210:211], v216 offset:8704
    v_mfma_f32_16x16x32_bf16 v[164:167], v[192:195], v[44:47], v[164:167]
    ds_read_b64_tr_b16 v[212:213], v217 offset:8192
    v_mfma_f32_16x16x32_bf16 v[168:171], v[196:199], v[40:43], v[168:171]
    ds_read_b64_tr_b16 v[214:215], v217 offset:8704
    v_mfma_f32_16x16x32_bf16 v[172:175], v[196:199], v[44:47], v[172:175]
    ds_read_b64_tr_b16 v[192:193], v216 offset:24576
    s_waitcnt lgkmcnt(5)
    v_mfma_f32_16x16x32_bf16 v[176:179], v[200:203], v[40:43], v[176:179]
    ds_read_b64_tr_b16 v[194:195], v216 offset:25088
    v_mfma_f32_16x16x32_bf16 v[180:183], v[200:203], v[44:47], v[180:183]
    ds_read_b64_tr_b16 v[196:197], v217 offset:24576
    v_mfma_f32_16x16x32_bf16 v[184:187], v[204:207], v[40:43], v[184:187]
    ds_read_b64_tr_b16 v[198:199], v217 offset:25088
    v_mfma_f32_16x16x32_bf16 v[188:191], v[204:207], v[44:47], v[188:191]
    ds_read_b64_tr_b16 v[200:201], v216 offset:12288
    s_waitcnt lgkmcnt(5)
    v_mfma_f32_16x16x32_bf16 v[160:163], v[208:211], v[48:51], v[160:163]
    ds_read_b64_tr_b16 v[202:203], v216 offset:12800
    v_mfma_f32_16x16x32_bf16 v[164:167], v[208:211], v[52:55], v[164:167]
    ds_read_b64_tr_b16 v[204:205], v217 offset:12288
    v_mfma_f32_16x16x32_bf16 v[168:171], v[212:215], v[48:51], v[168:171]
    ds_read_b64_tr_b16 v[206:207], v217 offset:12800
    v_mfma_f32_16x16x32_bf16 v[172:175], v[212:215], v[52:55], v[172:175]
    ds_read_b64_tr_b16 v[208:209], v216 offset:28672
    s_waitcnt lgkmcnt(5)
    v_mfma_f32_16x16x32_bf16 v[176:179], v[192:195], v[48:51], v[176:179]
    ds_read_b64_tr_b16 v[210:211], v216 offset:29184
    v_mfma_f32_16x16x32_bf16 v[180:183], v[192:195], v[52:55], v[180:183]
    ds_read_b64_tr_b16 v[212:213], v217 offset:28672
    v_mfma_f32_16x16x32_bf16 v[184:187], v[196:199], v[48:51], v[184:187]
    ds_read_b64_tr_b16 v[214:215], v217 offset:29184
    v_mfma_f32_16x16x32_bf16 v[188:191], v[196:199], v[52:55], v[188:191]
    ds_read_b64_tr_b16 v[192:193], v218 offset:0
    s_waitcnt lgkmcnt(5)
    v_mfma_f32_16x16x32_bf16 v[160:163], v[200:203], v[56:59], v[160:163]
    ds_read_b64_tr_b16 v[194:195], v218 offset:512
    v_mfma_f32_16x16x32_bf16 v[164:167], v[200:203], v[60:63], v[164:167]
    ds_read_b64_tr_b16 v[196:197], v219 offset:0
    v_mfma_f32_16x16x32_bf16 v[168:171], v[204:207], v[56:59], v[168:171]
    ds_read_b64_tr_b16 v[198:199], v219 offset:512
    v_mfma_f32_16x16x32_bf16 v[172:175], v[204:207], v[60:63], v[172:175]
    ds_read_b64_tr_b16 v[200:201], v218 offset:16384
    s_waitcnt lgkmcnt(5)
    v_mfma_f32_16x16x32_bf16 v[176:179], v[208:211], v[56:59], v[176:179]
    ds_read_b64_tr_b16 v[202:203], v218 offset:16896
    v_mfma_f32_16x16x32_bf16 v[180:183], v[208:211], v[60:63], v[180:183]
    ds_read_b64_tr_b16 v[204:205], v219 offset:16384
    v_mfma_f32_16x16x32_bf16 v[184:187], v[212:215], v[56:59], v[184:187]
    ds_read_b64_tr_b16 v[206:207], v219 offset:16896
    v_mfma_f32_16x16x32_bf16 v[188:191], v[212:215], v[60:63], v[188:191]
    ds_read_b64_tr_b16 v[208:209], v218 offset:4096
    s_waitcnt lgkmcnt(5)
    v_mfma_f32_16x16x32_bf16 v[128:131], v[192:195], v[32:35], v[128:131]
    ds_read_b64_tr_b16 v[210:211], v218 offset:4608
    v_mfma_f32_16x16x32_bf16 v[132:135], v[192:195], v[36:39], v[132:135]
    ds_read_b64_tr_b16 v[212:213], v219 offset:4096
    v_mfma_f32_16x16x32_bf16 v[136:139], v[196:199], v[32:35], v[136:139]
    ds_read_b64_tr_b16 v[214:215], v219 offset:4608
    v_mfma_f32_16x16x32_bf16 v[140:143], v[196:199], v[36:39], v[140:143]
    ds_read_b64_tr_b16 v[192:193], v218 offset:20480
    s_waitcnt lgkmcnt(5)
    v_mfma_f32_16x16x32_bf16 v[144:147], v[200:203], v[32:35], v[144:147]
    ds_read_b64_tr_b16 v[194:195], v218 offset:20992
    v_mfma_f32_16x16x32_bf16 v[148:151], v[200:203], v[36:39], v[148:151]
    ds_read_b64_tr_b16 v[196:197], v219 offset:20480
    v_mfma_f32_16x16x32_bf16 v[152:155], v[204:207], v[32:35], v[152:155]
    ds_read_b64_tr_b16 v[198:199], v219 offset:20992
    v_mfma_f32_16x16x32_bf16 v[156:159], v[204:207], v[36:39], v[156:159]
    ds_read_b64_tr_b16 v[200:201], v218 offset:8192
    s_waitcnt lgkmcnt(5)
    v_mfma_f32_16x16x32_bf16 v[128:131], v[208:211], v[40:43], v[128:131]
    ds_read_b64_tr_b16 v[202:203], v218 offset:8704
    v_mfma_f32_16x16x32_bf16 v[132:135], v[208:211], v[44:47], v[132:135]
    ds_read_b64_tr_b16 v[204:205], v219 offset:8192
    s_waitcnt vmcnt(0)
    s_mov_b64 exec, 1
    buffer_store_dword v248, v252, s[20:23], s72 offen sc1
    s_mov_b64 exec, -1
    v_mfma_f32_16x16x32_bf16 v[136:139], v[212:215], v[40:43], v[136:139]
    ds_read_b64_tr_b16 v[206:207], v219 offset:8704
    v_mfma_f32_16x16x32_bf16 v[140:143], v[212:215], v[44:47], v[140:143]
    ds_read_b64_tr_b16 v[208:209], v218 offset:24576
    s_waitcnt lgkmcnt(5)
    v_mfma_f32_16x16x32_bf16 v[144:147], v[192:195], v[40:43], v[144:147]
    ds_read_b64_tr_b16 v[210:211], v218 offset:25088
    v_mfma_f32_16x16x32_bf16 v[148:151], v[192:195], v[44:47], v[148:151]
    ds_read_b64_tr_b16 v[212:213], v219 offset:24576
    v_mfma_f32_16x16x32_bf16 v[152:155], v[196:199], v[40:43], v[152:155]
    ds_read_b64_tr_b16 v[214:215], v219 offset:25088
    v_mfma_f32_16x16x32_bf16 v[156:159], v[196:199], v[44:47], v[156:159]
    ds_read_b64_tr_b16 v[192:193], v218 offset:12288
    s_waitcnt lgkmcnt(5)
    v_mfma_f32_16x16x32_bf16 v[128:131], v[200:203], v[48:51], v[128:131]
    ds_read_b64_tr_b16 v[194:195], v218 offset:12800
    v_mfma_f32_16x16x32_bf16 v[132:135], v[200:203], v[52:55], v[132:135]
    ds_read_b64_tr_b16 v[196:197], v219 offset:12288
    v_mfma_f32_16x16x32_bf16 v[136:139], v[204:207], v[48:51], v[136:139]
    ds_read_b64_tr_b16 v[198:199], v219 offset:12800
    v_mfma_f32_16x16x32_bf16 v[140:143], v[204:207], v[52:55], v[140:143]
    ds_read_b64_tr_b16 v[200:201], v218 offset:28672
    s_waitcnt lgkmcnt(5)
    v_mfma_f32_16x16x32_bf16 v[144:147], v[208:211], v[48:51], v[144:147]
    ds_read_b64_tr_b16 v[202:203], v218 offset:29184
    v_mfma_f32_16x16x32_bf16 v[148:151], v[208:211], v[52:55], v[148:151]
    ds_read_b64_tr_b16 v[204:205], v219 offset:28672
    v_mfma_f32_16x16x32_bf16 v[152:155], v[212:215], v[48:51], v[152:155]
    ds_read_b64_tr_b16 v[206:207], v219 offset:29184
    v_mfma_f32_16x16x32_bf16 v[156:159], v[212:215], v[52:55], v[156:159]
    s_waitcnt lgkmcnt(4)
    v_mfma_f32_16x16x32_bf16 v[128:131], v[192:195], v[56:59], v[128:131]
    v_mfma_f32_16x16x32_bf16 v[132:135], v[192:195], v[60:63], v[132:135]
    s_waitcnt lgkmcnt(0)
    s_barrier
    ds_read_b64_tr_b16 v[208:209], v216 offset:32768
    ds_read_b64_tr_b16 v[210:211], v216 offset:33280
    ds_read_b64_tr_b16 v[212:213], v217 offset:32768
    ds_read_b64_tr_b16 v[214:215], v217 offset:33280
    v_mfma_f32_16x16x32_bf16 v[136:139], v[196:199], v[56:59], v[136:139]
    v_mfma_f32_16x16x32_bf16 v[140:143], v[196:199], v[60:63], v[140:143]
    ds_read_b64_tr_b16 v[192:193], v216 offset:49152
    v_mfma_f32_16x16x32_bf16 v[144:147], v[200:203], v[56:59], v[144:147]
    ds_read_b64_tr_b16 v[194:195], v216 offset:49664
    v_mfma_f32_16x16x32_bf16 v[148:151], v[200:203], v[60:63], v[148:151]
    ds_read_b64_tr_b16 v[196:197], v217 offset:49152
    v_mfma_f32_16x16x32_bf16 v[152:155], v[204:207], v[56:59], v[152:155]
    ds_read_b64_tr_b16 v[198:199], v217 offset:49664
    v_mfma_f32_16x16x32_bf16 v[156:159], v[204:207], v[60:63], v[156:159]
    ds_read_b64_tr_b16 v[200:201], v216 offset:36864
    s_waitcnt lgkmcnt(5)
    v_mfma_f32_16x16x32_bf16 v[160:163], v[208:211], v[64:67], v[160:163]
    ds_read_b64_tr_b16 v[202:203], v216 offset:37376
    v_mfma_f32_16x16x32_bf16 v[164:167], v[208:211], v[68:71], v[164:167]
    ds_read_b64_tr_b16 v[204:205], v217 offset:36864
    v_mfma_f32_16x16x32_bf16 v[168:171], v[212:215], v[64:67], v[168:171]
    ds_read_b64_tr_b16 v[206:207], v217 offset:37376
    v_mfma_f32_16x16x32_bf16 v[172:175], v[212:215], v[68:71], v[172:175]
    ds_read_b64_tr_b16 v[208:209], v216 offset:53248
    s_waitcnt lgkmcnt(5)
    v_mfma_f32_16x16x32_bf16 v[176:179], v[192:195], v[64:67], v[176:179]
    ds_read_b64_tr_b16 v[210:211], v216 offset:53760
    v_mfma_f32_16x16x32_bf16 v[180:183], v[192:195], v[68:71], v[180:183]
    ds_read_b64_tr_b16 v[212:213], v217 offset:53248
    v_mfma_f32_16x16x32_bf16 v[184:187], v[196:199], v[64:67], v[184:187]
    ds_read_b64_tr_b16 v[214:215], v217 offset:53760
    v_lshrrev_b32 v249, 4, v242
    v_mfma_f32_16x16x32_bf16 v[188:191], v[196:199], v[68:71], v[188:191]
    ds_read_b64_tr_b16 v[192:193], v216 offset:40960
    v_lshrrev_b32 v250, 5, v249
    s_waitcnt lgkmcnt(5)
    v_mfma_f32_16x16x32_bf16 v[160:163], v[200:203], v[72:75], v[160:163]
    ds_read_b64_tr_b16 v[194:195], v216 offset:41472
    v_bfe_u32 v244, v249, 2, 2
    v_mfma_f32_16x16x32_bf16 v[164:167], v[200:203], v[76:79], v[164:167]
    ds_read_b64_tr_b16 v[196:197], v217 offset:40960
    v_lshl_add_u32 v244, v250, 3, v244
    v_mfma_f32_16x16x32_bf16 v[168:171], v[204:207], v[72:75], v[168:171]
    ds_read_b64_tr_b16 v[198:199], v217 offset:41472
    v_lshlrev_b32 v244, 7, v244
    v_mfma_f32_16x16x32_bf16 v[172:175], v[204:207], v[76:79], v[172:175]
    ds_read_b64_tr_b16 v[200:201], v216 offset:57344
    v_bfe_u32 v250, v249, 3, 1
    s_waitcnt lgkmcnt(5)
    v_mfma_f32_16x16x32_bf16 v[176:179], v[208:211], v[72:75], v[176:179]
    ds_read_b64_tr_b16 v[202:203], v216 offset:57856
    v_lshl_add_u32 v244, v250, 6, v244
    v_mfma_f32_16x16x32_bf16 v[180:183], v[208:211], v[76:79], v[180:183]
    ds_read_b64_tr_b16 v[204:205], v217 offset:57344
    v_bfe_u32 v250, v249, 4, 1
    v_mfma_f32_16x16x32_bf16 v[184:187], v[212:215], v[72:75], v[184:187]
    ds_read_b64_tr_b16 v[206:207], v217 offset:57856
    v_lshl_add_u32 v244, v250, 5, v244
    v_mfma_f32_16x16x32_bf16 v[188:191], v[212:215], v[76:79], v[188:191]
    ds_read_b64_tr_b16 v[208:209], v216 offset:45056
    v_and_b32 v250, 3, v249
    s_waitcnt lgkmcnt(5)
    v_mfma_f32_16x16x32_bf16 v[160:163], v[192:195], v[80:83], v[160:163]
    ds_read_b64_tr_b16 v[210:211], v216 offset:45568
    v_lshl_add_u32 v244, v250, 3, v244
    v_mfma_f32_16x16x32_bf16 v[164:167], v[192:195], v[84:87], v[164:167]
    ds_read_b64_tr_b16 v[212:213], v217 offset:45056
    v_add_u32 v244, s81, v244
    v_mfma_f32_16x16x32_bf16 v[168:171], v[196:199], v[80:83], v[168:171]
    ds_read_b64_tr_b16 v[214:215], v217 offset:45568
    v_xor_b32 v246, 64, v244
    v_mfma_f32_16x16x32_bf16 v[172:175], v[196:199], v[84:87], v[172:175]
    ds_read_b64_tr_b16 v[192:193], v216 offset:61440
    v_lshrrev_b32 v250, 3, v249
    s_waitcnt lgkmcnt(5)
    v_mfma_f32_16x16x32_bf16 v[176:179], v[200:203], v[80:83], v[176:179]
    ds_read_b64_tr_b16 v[194:195], v216 offset:61952
    v_mfma_f32_16x16x32_bf16 v[180:183], v[200:203], v[84:87], v[180:183]
    ds_read_b64_tr_b16 v[196:197], v217 offset:61440
    v_bfe_u32 v243, v249, 4, 1
    v_mfma_f32_16x16x32_bf16 v[184:187], v[204:207], v[80:83], v[184:187]
    ds_read_b64_tr_b16 v[198:199], v217 offset:61952
    v_mfma_f32_16x16x32_bf16 v[188:191], v[204:207], v[84:87], v[188:191]
    ds_read_b64_tr_b16 v[200:201], v218 offset:32768
    v_lshlrev_b32 v243, 2, v243
    s_waitcnt lgkmcnt(5)
    v_mfma_f32_16x16x32_bf16 v[160:163], v[208:211], v[88:91], v[160:163]
    ds_read_b64_tr_b16 v[202:203], v218 offset:33280
    v_mfma_f32_16x16x32_bf16 v[164:167], v[208:211], v[92:95], v[164:167]
    ds_read_b64_tr_b16 v[204:205], v219 offset:32768
    v_xor_b32 v243, v249, v243
    v_mfma_f32_16x16x32_bf16 v[168:171], v[212:215], v[88:91], v[168:171]
    ds_read_b64_tr_b16 v[206:207], v219 offset:33280
    v_mfma_f32_16x16x32_bf16 v[172:175], v[212:215], v[92:95], v[172:175]
    ds_read_b64_tr_b16 v[208:209], v218 offset:49152
    v_and_b32 v243, 7, v243
    s_waitcnt lgkmcnt(5)
    v_mfma_f32_16x16x32_bf16 v[176:179], v[192:195], v[88:91], v[176:179]
    ds_read_b64_tr_b16 v[210:211], v218 offset:49664
    v_mfma_f32_16x16x32_bf16 v[180:183], v[192:195], v[92:95], v[180:183]
    ds_read_b64_tr_b16 v[212:213], v219 offset:49152
    v_lshlrev_b32 v243, 4, v243
    v_mfma_f32_16x16x32_bf16 v[184:187], v[196:199], v[88:91], v[184:187]
    ds_read_b64_tr_b16 v[214:215], v219 offset:49664
    v_mfma_f32_16x16x32_bf16 v[188:191], v[196:199], v[92:95], v[188:191]
    ds_read_b64_tr_b16 v[192:193], v218 offset:36864
    v_lshl_add_u32 v243, v250, 10, v243
    s_waitcnt lgkmcnt(5)
    v_mfma_f32_16x16x32_bf16 v[128:131], v[200:203], v[64:67], v[128:131]
    ds_read_b64_tr_b16 v[194:195], v218 offset:37376
    v_mfma_f32_16x16x32_bf16 v[132:135], v[200:203], v[68:71], v[132:135]
    ds_read_b64_tr_b16 v[196:197], v219 offset:36864
    v_and_b32 v250, 1, v249
    v_mfma_f32_16x16x32_bf16 v[136:139], v[204:207], v[64:67], v[136:139]
    ds_read_b64_tr_b16 v[198:199], v219 offset:37376
    v_mfma_f32_16x16x32_bf16 v[140:143], v[204:207], v[68:71], v[140:143]
    ds_read_b64_tr_b16 v[200:201], v218 offset:53248
    v_lshlrev_b32 v250, 2, v250
    s_waitcnt lgkmcnt(5)
    v_mfma_f32_16x16x32_bf16 v[144:147], v[208:211], v[64:67], v[144:147]
    ds_read_b64_tr_b16 v[202:203], v218 offset:53760
    v_mfma_f32_16x16x32_bf16 v[148:151], v[208:211], v[68:71], v[148:151]
    ds_read_b64_tr_b16 v[204:205], v219 offset:53248
    v_bfe_u32 v253, v249, 1, 1
    v_mfma_f32_16x16x32_bf16 v[152:155], v[212:215], v[64:67], v[152:155]
    ds_read_b64_tr_b16 v[206:207], v219 offset:53760
    v_mfma_f32_16x16x32_bf16 v[156:159], v[212:215], v[68:71], v[156:159]
    ds_read_b64_tr_b16 v[208:209], v218 offset:40960
    v_lshl_add_u32 v253, v253, 7, v250
    s_waitcnt lgkmcnt(5)
    v_mfma_f32_16x16x32_bf16 v[128:131], v[192:195], v[72:75], v[128:131]
    ds_read_b64_tr_b16 v[210:211], v218 offset:41472
    v_mfma_f32_16x16x32_bf16 v[132:135], v[192:195], v[76:79], v[132:135]
    ds_read_b64_tr_b16 v[212:213], v219 offset:40960
    s_lshl_b32 s6, s52, 8
    v_mfma_f32_16x16x32_bf16 v[136:139], v[196:199], v[72:75], v[136:139]
    ds_read_b64_tr_b16 v[214:215], v219 offset:41472
    v_mfma_f32_16x16x32_bf16 v[140:143], v[196:199], v[76:79], v[140:143]
    ds_read_b64_tr_b16 v[192:193], v218 offset:57344
    s_lshl_b32 s7, s48, 3
    s_waitcnt lgkmcnt(5)
    v_mfma_f32_16x16x32_bf16 v[144:147], v[200:203], v[72:75], v[144:147]
    ds_read_b64_tr_b16 v[194:195], v218 offset:57856
    v_mfma_f32_16x16x32_bf16 v[148:151], v[200:203], v[76:79], v[148:151]
    ds_read_b64_tr_b16 v[196:197], v219 offset:57344
    s_add_u32 s6, s6, s7
    v_mfma_f32_16x16x32_bf16 v[152:155], v[204:207], v[72:75], v[152:155]
    ds_read_b64_tr_b16 v[198:199], v219 offset:57856
    v_mfma_f32_16x16x32_bf16 v[156:159], v[204:207], v[76:79], v[156:159]
    ds_read_b64_tr_b16 v[200:201], v218 offset:45056
    s_add_u32 s6, s6, 11808800
    s_waitcnt lgkmcnt(5)
    v_mfma_f32_16x16x32_bf16 v[128:131], v[208:211], v[80:83], v[128:131]
    ds_read_b64_tr_b16 v[202:203], v218 offset:45568
    v_mfma_f32_16x16x32_bf16 v[132:135], v[208:211], v[84:87], v[132:135]
    ds_read_b64_tr_b16 v[204:205], v219 offset:45056
    v_add_u32 v253, s6, v253
    v_mfma_f32_16x16x32_bf16 v[136:139], v[212:215], v[80:83], v[136:139]
    ds_read_b64_tr_b16 v[206:207], v219 offset:45568
    v_mfma_f32_16x16x32_bf16 v[140:143], v[212:215], v[84:87], v[140:143]
    ds_read_b64_tr_b16 v[208:209], v218 offset:61440
    s_waitcnt lgkmcnt(5)
    v_mfma_f32_16x16x32_bf16 v[144:147], v[192:195], v[80:83], v[144:147]
    ds_read_b64_tr_b16 v[210:211], v218 offset:61952
    v_mfma_f32_16x16x32_bf16 v[148:151], v[192:195], v[84:87], v[148:151]
    ds_read_b64_tr_b16 v[212:213], v219 offset:61440
    v_mfma_f32_16x16x32_bf16 v[152:155], v[196:199], v[80:83], v[152:155]
    ds_read_b64_tr_b16 v[214:215], v219 offset:61952
    v_mfma_f32_16x16x32_bf16 v[156:159], v[196:199], v[84:87], v[156:159]
    s_waitcnt lgkmcnt(4)
    v_mfma_f32_16x16x32_bf16 v[128:131], v[200:203], v[88:91], v[128:131]
    v_mfma_f32_16x16x32_bf16 v[132:135], v[200:203], v[92:95], v[132:135]
    s_waitcnt lgkmcnt(0)
    s_barrier
    ds_read_b64_tr_b16 v[192:193], v220 offset:0
    ds_read_b64_tr_b16 v[194:195], v220 offset:512
    ds_read_b64_tr_b16 v[196:197], v221 offset:0
    ds_read_b64_tr_b16 v[198:199], v221 offset:512
    v_mfma_f32_16x16x32_bf16 v[136:139], v[204:207], v[88:91], v[136:139]
    v_mfma_f32_16x16x32_bf16 v[140:143], v[204:207], v[92:95], v[140:143]
    ds_read_b64_tr_b16 v[200:201], v220 offset:16384
    v_mfma_f32_16x16x32_bf16 v[144:147], v[208:211], v[88:91], v[144:147]
    ds_read_b64_tr_b16 v[202:203], v220 offset:16896
    v_mfma_f32_16x16x32_bf16 v[148:151], v[208:211], v[92:95], v[148:151]
    ds_read_b64_tr_b16 v[204:205], v221 offset:16384
    ds_read_b64_tr_b16 v[0:1], v244 offset:0
    ds_read_b64_tr_b16 v[2:3], v244 offset:512
    v_mfma_f32_16x16x32_bf16 v[152:155], v[212:215], v[88:91], v[152:155]
    ds_read_b64_tr_b16 v[206:207], v221 offset:16896
    v_mfma_f32_16x16x32_bf16 v[156:159], v[212:215], v[92:95], v[156:159]
    ds_read_b64_tr_b16 v[208:209], v220 offset:4096
    ds_read_b64_tr_b16 v[4:5], v246 offset:0
    ds_read_b64_tr_b16 v[6:7], v246 offset:512
    s_waitcnt lgkmcnt(9)
    v_mfma_f32_16x16x32_bf16 v[160:163], v[192:195], v[96:99], v[160:163]
    ds_read_b64_tr_b16 v[210:211], v220 offset:4608
    v_mfma_f32_16x16x32_bf16 v[164:167], v[192:195], v[100:103], v[164:167]
    ds_read_b64_tr_b16 v[212:213], v221 offset:4096
    ds_read_b64_tr_b16 v[8:9], v244 offset:2048
    ds_read_b64_tr_b16 v[10:11], v244 offset:2560
    v_mfma_f32_16x16x32_bf16 v[168:171], v[196:199], v[96:99], v[168:171]
    ds_read_b64_tr_b16 v[214:215], v221 offset:4608
    v_mfma_f32_16x16x32_bf16 v[172:175], v[196:199], v[100:103], v[172:175]
    ds_read_b64_tr_b16 v[192:193], v220 offset:20480
    ds_read_b64_tr_b16 v[12:13], v246 offset:2048
    ds_read_b64_tr_b16 v[14:15], v246 offset:2560
    s_waitcnt lgkmcnt(11)
    v_mfma_f32_16x16x32_bf16 v[176:179], v[200:203], v[96:99], v[176:179]
    ds_read_b64_tr_b16 v[194:195], v220 offset:20992
    v_mfma_f32_16x16x32_bf16 v[180:183], v[200:203], v[100:103], v[180:183]
    ds_read_b64_tr_b16 v[196:197], v221 offset:20480
    ds_read_b64_tr_b16 v[16:17], v244 offset:4096
    ds_read_b64_tr_b16 v[18:19], v244 offset:4608
    s_add_u32 m0, s81, 0
    s_add_u32 s64, s80, 131072
    s_waitcnt lgkmcnt(12)
    buffer_load_dwordx4 v243, s[12:15], s64 offen lds
    v_mfma_f32_16x16x32_bf16 v[184:187], v[204:207], v[96:99], v[184:187]
    ds_read_b64_tr_b16 v[198:199], v221 offset:20992
    v_mfma_f32_16x16x32_bf16 v[188:191], v[204:207], v[100:103], v[188:191]
    ds_read_b64_tr_b16 v[200:201], v220 offset:8192
    ds_read_b64_tr_b16 v[20:21], v246 offset:4096
    ds_read_b64_tr_b16 v[22:23], v246 offset:4608
    s_add_u32 m0, s81, 1024
    s_add_u32 s64, s80, 139264
    buffer_load_dwordx4 v243, s[12:15], s64 offen lds
    s_waitcnt lgkmcnt(11)
    v_mfma_f32_16x16x32_bf16 v[160:163], v[208:211], v[104:107], v[160:163]
    ds_read_b64_tr_b16 v[202:203], v220 offset:8704
    v_mfma_f32_16x16x32_bf16 v[164:167], v[208:211], v[108:111], v[164:167]
    ds_read_b64_tr_b16 v[204:205], v221 offset:8192
    buffer_load_dword v250, v253, s[20:23], 0 offen sc1
    ds_read_b64_tr_b16 v[24:25], v244 offset:6144
    ds_read_b64_tr_b16 v[26:27], v244 offset:6656
    s_add_u32 m0, s81, 2048
    s_add_u32 s64, s80, 147456
    s_waitcnt lgkmcnt(12)
    buffer_load_dwordx4 v243, s[12:15], s64 offen lds
    v_mfma_f32_16x16x32_bf16 v[168:171], v[212:215], v[104:107], v[168:171]
    ds_read_b64_tr_b16 v[206:207], v221 offset:8704
    v_mfma_f32_16x16x32_bf16 v[172:175], v[212:215], v[108:111], v[172:175]
    ds_read_b64_tr_b16 v[208:209], v220 offset:24576
    ds_read_b64_tr_b16 v[28:29], v246 offset:6144
    ds_read_b64_tr_b16 v[30:31], v246 offset:6656
    s_add_u32 m0, s81, 3072
    s_add_u32 s64, s80, 155648
    buffer_load_dwordx4 v243, s[12:15], s64 offen lds
    s_waitcnt lgkmcnt(11)
    v_mfma_f32_16x16x32_bf16 v[176:179], v[192:195], v[104:107], v[176:179]
    ds_read_b64_tr_b16 v[210:211], v220 offset:25088
    v_mfma_f32_16x16x32_bf16 v[180:183], v[192:195], v[108:111], v[180:183]
    ds_read_b64_tr_b16 v[212:213], v221 offset:24576
    ds_read_b64_tr_b16 v[32:33], v244 offset:8192
    ds_read_b64_tr_b16 v[34:35], v244 offset:8704
    s_add_u32 m0, s81, 4096
    s_add_u32 s64, s80, 163840
    s_waitcnt lgkmcnt(12)
    buffer_load_dwordx4 v243, s[12:15], s64 offen lds
    v_mfma_f32_16x16x32_bf16 v[184:187], v[196:199], v[104:107], v[184:187]
    ds_read_b64_tr_b16 v[214:215], v221 offset:25088
    v_mfma_f32_16x16x32_bf16 v[188:191], v[196:199], v[108:111], v[188:191]
    ds_read_b64_tr_b16 v[192:193], v220 offset:12288
    ds_read_b64_tr_b16 v[36:37], v246 offset:8192
    ds_read_b64_tr_b16 v[38:39], v246 offset:8704
    s_add_u32 m0, s81, 5120
    s_add_u32 s64, s80, 172032
    buffer_load_dwordx4 v243, s[12:15], s64 offen lds
    s_waitcnt lgkmcnt(11)
    v_mfma_f32_16x16x32_bf16 v[160:163], v[200:203], v[112:115], v[160:163]
    ds_read_b64_tr_b16 v[194:195], v220 offset:12800
    v_mfma_f32_16x16x32_bf16 v[164:167], v[200:203], v[116:119], v[164:167]
    ds_read_b64_tr_b16 v[196:197], v221 offset:12288
    ds_read_b64_tr_b16 v[40:41], v244 offset:10240
    ds_read_b64_tr_b16 v[42:43], v244 offset:10752
    s_add_u32 m0, s81, 6144
    s_add_u32 s64, s80, 180224
    s_waitcnt lgkmcnt(12)
    buffer_load_dwordx4 v243, s[12:15], s64 offen lds
    v_mfma_f32_16x16x32_bf16 v[168:171], v[204:207], v[112:115], v[168:171]
    ds_read_b64_tr_b16 v[198:199], v221 offset:12800
    v_mfma_f32_16x16x32_bf16 v[172:175], v[204:207], v[116:119], v[172:175]
    ds_read_b64_tr_b16 v[200:201], v220 offset:28672
    ds_read_b64_tr_b16 v[44:45], v246 offset:10240
    ds_read_b64_tr_b16 v[46:47], v246 offset:10752
    s_add_u32 m0, s81, 7168
    s_add_u32 s64, s80, 188416
    buffer_load_dwordx4 v243, s[12:15], s64 offen lds
    s_waitcnt lgkmcnt(11)
    v_mfma_f32_16x16x32_bf16 v[176:179], v[208:211], v[112:115], v[176:179]
    ds_read_b64_tr_b16 v[202:203], v220 offset:29184
    v_mfma_f32_16x16x32_bf16 v[180:183], v[208:211], v[116:119], v[180:183]
    ds_read_b64_tr_b16 v[204:205], v221 offset:28672
    ds_read_b64_tr_b16 v[48:49], v244 offset:12288
    ds_read_b64_tr_b16 v[50:51], v244 offset:12800
    s_add_u32 m0, s81, 8192
    s_add_u32 s64, s80, 65536
    s_waitcnt lgkmcnt(12)
    buffer_load_dwordx4 v243, s[12:15], s64 offen lds
    v_mfma_f32_16x16x32_bf16 v[184:187], v[212:215], v[112:115], v[184:187]
    ds_read_b64_tr_b16 v[206:207], v221 offset:29184
    v_mfma_f32_16x16x32_bf16 v[188:191], v[212:215], v[116:119], v[188:191]
    ds_read_b64_tr_b16 v[208:209], v222 offset:0
    ds_read_b64_tr_b16 v[52:53], v246 offset:12288
    ds_read_b64_tr_b16 v[54:55], v246 offset:12800
    s_add_u32 m0, s81, 9216
    s_add_u32 s64, s80, 73728
    buffer_load_dwordx4 v243, s[12:15], s64 offen lds
    s_waitcnt lgkmcnt(11)
    v_mfma_f32_16x16x32_bf16 v[160:163], v[192:195], v[120:123], v[160:163]
    ds_read_b64_tr_b16 v[210:211], v222 offset:512
    v_mfma_f32_16x16x32_bf16 v[164:167], v[192:195], v[124:127], v[164:167]
    ds_read_b64_tr_b16 v[212:213], v223 offset:0
    ds_read_b64_tr_b16 v[56:57], v244 offset:14336
    ds_read_b64_tr_b16 v[58:59], v244 offset:14848
    s_add_u32 m0, s81, 10240
    s_add_u32 s64, s80, 81920
    s_waitcnt lgkmcnt(12)
    buffer_load_dwordx4 v243, s[12:15], s64 offen lds
    v_mfma_f32_16x16x32_bf16 v[168:171], v[196:199], v[120:123], v[168:171]
    ds_read_b64_tr_b16 v[214:215], v223 offset:512
    v_mfma_f32_16x16x32_bf16 v[172:175], v[196:199], v[124:127], v[172:175]
    ds_read_b64_tr_b16 v[192:193], v222 offset:16384
    ds_read_b64_tr_b16 v[60:61], v246 offset:14336
    ds_read_b64_tr_b16 v[62:63], v246 offset:14848
    s_add_u32 m0, s81, 11264
    s_add_u32 s64, s80, 90112
    buffer_load_dwordx4 v243, s[12:15], s64 offen lds
    s_waitcnt lgkmcnt(11)
    v_mfma_f32_16x16x32_bf16 v[176:179], v[200:203], v[120:123], v[176:179]
    ds_read_b64_tr_b16 v[194:195], v222 offset:16896
    v_mfma_f32_16x16x32_bf16 v[180:183], v[200:203], v[124:127], v[180:183]
    ds_read_b64_tr_b16 v[196:197], v223 offset:16384
    s_add_u32 m0, s81, 12288
    s_add_u32 s64, s80, 98304
    s_waitcnt lgkmcnt(10)
    buffer_load_dwordx4 v243, s[12:15], s64 offen lds
    s_waitcnt vmcnt(11)
    v_cmp_ne_u32 vcc, v250, v248
    s_mov_b32 s73, 0
    s_cbranch_vccnz L_eY_x
    buffer_load_dwordx4 v[64:67], v242, s[20:23], s82 offen offset:0 sc1
    buffer_load_dwordx4 v[68:71], v242, s[20:23], s83 offen offset:0 sc1
    buffer_load_dwordx4 v[72:75], v242, s[20:23], s82 offen offset:1024 sc1
    buffer_load_dwordx4 v[76:79], v242, s[20:23], s83 offen offset:1024 sc1
    buffer_load_dwordx4 v[80:83], v242, s[20:23], s82 offen offset:2048 sc1
    buffer_load_dwordx4 v[84:87], v242, s[20:23], s83 offen offset:2048 sc1
    buffer_load_dwordx4 v[88:91], v242, s[20:23], s82 offen offset:3072 sc1
    buffer_load_dwordx4 v[92:95], v242, s[20:23], s83 offen offset:3072 sc1
    s_mov_b32 s73, 1
L_eY_x:
    v_mfma_f32_16x16x32_bf16 v[184:187], v[204:207], v[120:123], v[184:187]
    ds_read_b64_tr_b16 v[198:199], v223 offset:16896
    v_mfma_f32_16x16x32_bf16 v[188:191], v[204:207], v[124:127], v[188:191]
    ds_read_b64_tr_b16 v[200:201], v222 offset:4096
    s_add_u32 m0, s81, 13312
    s_add_u32 s64, s80, 106496
    buffer_load_dwordx4 v243, s[12:15], s64 offen lds
    s_waitcnt lgkmcnt(7)
    v_mfma_f32_16x16x32_bf16 v[128:131], v[208:211], v[96:99], v[128:131]
    ds_read_b64_tr_b16 v[202:203], v222 offset:4608
    v_mfma_f32_16x16x32_bf16 v[132:135], v[208:211], v[100:103], v[132:135]
    ds_read_b64_tr_b16 v[204:205], v223 offset:4096
    s_add_u32 m0, s81, 14336
    s_add_u32 s64, s80, 114688
    s_waitcnt lgkmcnt(6)
    buffer_load_dwordx4 v243, s[12:15], s64 offen lds
    v_mfma_f32_16x16x32_bf16 v[136:139], v[212:215], v[96:99], v[136:139]
    ds_read_b64_tr_b16 v[206:207], v223 offset:4608
    v_max_f32 v160, 0, v160
    v_max_f32 v161, 0, v161
    v_mfma_f32_16x16x32_bf16 v[140:143], v[212:215], v[100:103], v[140:143]
    ds_read_b64_tr_b16 v[208:209], v222 offset:20480
    s_add_u32 m0, s81, 15360
    s_add_u32 s64, s80, 122880
    buffer_load_dwordx4 v243, s[12:15], s64 offen lds
    v_max_f32 v162, 0, v162
    v_max_f32 v163, 0, v163
    v_max_f32 v164, 0, v164
    s_waitcnt lgkmcnt(5)
    v_mfma_f32_16x16x32_bf16 v[144:147], v[192:195], v[96:99], v[144:147]
    ds_read_b64_tr_b16 v[210:211], v222 offset:20992
    v_max_f32 v165, 0, v165
    v_max_f32 v166, 0, v166
    v_mfma_f32_16x16x32_bf16 v[148:151], v[192:195], v[100:103], v[148:151]
    ds_read_b64_tr_b16 v[212:213], v223 offset:20480
    v_max_f32 v167, 0, v167
    v_mul_f32 v160, v160, v176
    v_mul_f32 v161, v161, v177
    v_mfma_f32_16x16x32_bf16 v[152:155], v[196:199], v[96:99], v[152:155]
    ds_read_b64_tr_b16 v[214:215], v223 offset:20992
    v_mul_f32 v162, v162, v178
    v_mul_f32 v163, v163, v179
    v_mfma_f32_16x16x32_bf16 v[156:159], v[196:199], v[100:103], v[156:159]
    ds_read_b64_tr_b16 v[192:193], v222 offset:8192
    v_mul_f32 v164, v164, v180
    v_mul_f32 v165, v165, v181
    v_mul_f32 v166, v166, v182
    s_waitcnt lgkmcnt(5)
    v_mfma_f32_16x16x32_bf16 v[128:131], v[200:203], v[104:107], v[128:131]
    ds_read_b64_tr_b16 v[194:195], v222 offset:8704
    v_mul_f32 v167, v167, v183
    v_mul_f32 v160, v160, v254
    v_mfma_f32_16x16x32_bf16 v[132:135], v[200:203], v[108:111], v[132:135]
    ds_read_b64_tr_b16 v[196:197], v223 offset:8192
    v_mul_f32 v161, v161, v254
    v_mul_f32 v162, v162, v254
    v_mul_f32 v163, v163, v254
    v_mfma_f32_16x16x32_bf16 v[136:139], v[204:207], v[104:107], v[136:139]
    ds_read_b64_tr_b16 v[198:199], v223 offset:8704
    v_cvt_pk_bf16_f32 v224, v160, v161
    v_cvt_pk_bf16_f32 v225, v162, v163
    v_mfma_f32_16x16x32_bf16 v[140:143], v[204:207], v[108:111], v[140:143]
    ds_read_b64_tr_b16 v[200:201], v222 offset:24576
    v_mul_f32 v164, v164, v255
    v_mul_f32 v165, v165, v255
    v_mul_f32 v166, v166, v255
    s_waitcnt lgkmcnt(5)
    v_mfma_f32_16x16x32_bf16 v[144:147], v[208:211], v[104:107], v[144:147]
    ds_read_b64_tr_b16 v[202:203], v222 offset:25088
    v_mul_f32 v167, v167, v255
    v_cvt_pk_bf16_f32 v226, v164, v165
    v_mfma_f32_16x16x32_bf16 v[148:151], v[208:211], v[108:111], v[148:151]
    ds_read_b64_tr_b16 v[204:205], v223 offset:24576
    v_cvt_pk_bf16_f32 v227, v166, v167
    v_max_f32 v168, 0, v168
    v_max_f32 v169, 0, v169
    v_mfma_f32_16x16x32_bf16 v[152:155], v[212:215], v[104:107], v[152:155]
    ds_read_b64_tr_b16 v[206:207], v223 offset:25088
    v_max_f32 v170, 0, v170
    v_max_f32 v171, 0, v171
    v_mfma_f32_16x16x32_bf16 v[156:159], v[212:215], v[108:111], v[156:159]
    ds_read_b64_tr_b16 v[208:209], v222 offset:12288
    v_max_f32 v172, 0, v172
    v_max_f32 v173, 0, v173
    v_max_f32 v174, 0, v174
    s_waitcnt lgkmcnt(5)
    v_mfma_f32_16x16x32_bf16 v[128:131], v[192:195], v[112:115], v[128:131]
    ds_read_b64_tr_b16 v[210:211], v222 offset:12800
    v_max_f32 v175, 0, v175
    v_permlane16_swap_b32 v224, v226
    v_mfma_f32_16x16x32_bf16 v[132:135], v[192:195], v[116:119], v[132:135]
    ds_read_b64_tr_b16 v[212:213], v223 offset:12288
    v_permlane16_swap_b32 v225, v227
    buffer_store_dwordx4 v[224:227], v242, s[20:23], s70 offen offset:0 sc1
    v_mfma_f32_16x16x32_bf16 v[136:139], v[196:199], v[112:115], v[136:139]
    ds_read_b64_tr_b16 v[214:215], v223 offset:12800
    v_mul_f32 v168, v168, v184
    v_mul_f32 v169, v169, v185
    v_mfma_f32_16x16x32_bf16 v[140:143], v[196:199], v[116:119], v[140:143]
    ds_read_b64_tr_b16 v[192:193], v222 offset:28672
    v_mul_f32 v170, v170, v186
    v_mul_f32 v171, v171, v187
    s_waitcnt lgkmcnt(5)
    v_mfma_f32_16x16x32_bf16 v[144:147], v[200:203], v[112:115], v[144:147]
    ds_read_b64_tr_b16 v[194:195], v222 offset:29184
    v_mul_f32 v172, v172, v188
    v_mul_f32 v173, v173, v189
    v_mfma_f32_16x16x32_bf16 v[148:151], v[200:203], v[116:119], v[148:151]
    ds_read_b64_tr_b16 v[196:197], v223 offset:28672
    v_mul_f32 v174, v174, v190
    v_mul_f32 v175, v175, v191
    v_mfma_f32_16x16x32_bf16 v[152:155], v[204:207], v[112:115], v[152:155]
    ds_read_b64_tr_b16 v[198:199], v223 offset:29184
    v_mul_f32 v168, v168, v254
    v_mul_f32 v169, v169, v254
    v_mfma_f32_16x16x32_bf16 v[156:159], v[204:207], v[116:119], v[156:159]
    v_mul_f32 v170, v170, v254
    v_mul_f32 v171, v171, v254
    s_waitcnt lgkmcnt(4)
    v_mfma_f32_16x16x32_bf16 v[128:131], v[208:211], v[120:123], v[128:131]
    v_mfma_f32_16x16x32_bf16 v[132:135], v[208:211], v[124:127], v[132:135]
    s_waitcnt lgkmcnt(0)
    s_barrier
    v_readfirstlane_b32 s62, v248
    s_lshl_b32 s6, s52, 8
    s_lshl_b32 s7, s48, 3
    s_add_u32 s6, s6, s7
    s_add_u32 s6, s6, 11808800
    s_add_u32 s4, s20, s6
    s_addc_u32 s5, s21, 0
    s_mov_b32 s63, s62
    v_mfma_f32_16x16x32_bf16 v[136:139], v[212:215], v[120:123], v[136:139]
    v_cvt_pk_bf16_f32 v228, v168, v169
    v_cvt_pk_bf16_f32 v229, v170, v171
    v_mfma_f32_16x16x32_bf16 v[140:143], v[212:215], v[124:127], v[140:143]
    v_mul_f32 v172, v172, v255
    v_mul_f32 v173, v173, v255
    v_mfma_f32_16x16x32_bf16 v[144:147], v[192:195], v[120:123], v[144:147]
    v_mul_f32 v174, v174, v255
    v_mul_f32 v175, v175, v255
    v_mfma_f32_16x16x32_bf16 v[148:151], v[192:195], v[124:127], v[148:151]
    v_cvt_pk_bf16_f32 v230, v172, v173
    v_cvt_pk_bf16_f32 v231, v174, v175
    v_mfma_f32_16x16x32_bf16 v[152:155], v[196:199], v[120:123], v[152:155]
    s_nop 0
    v_permlane16_swap_b32 v228, v230
    v_mfma_f32_16x16x32_bf16 v[156:159], v[196:199], v[124:127], v[156:159]
    v_permlane16_swap_b32 v229, v231
    buffer_store_dwordx4 v[228:231], v242, s[20:23], s70 offen offset:1024 sc1
    v_max_f32 v128, 0, v128
    v_max_f32 v129, 0, v129
    v_max_f32 v130, 0, v130
    v_max_f32 v131, 0, v131
    v_max_f32 v132, 0, v132
    v_max_f32 v133, 0, v133
    v_max_f32 v134, 0, v134
    v_max_f32 v135, 0, v135
    v_mul_f32 v128, v128, v144
    v_mul_f32 v129, v129, v145
    v_mul_f32 v130, v130, v146
    v_mul_f32 v131, v131, v147
    v_mul_f32 v132, v132, v148
    v_mul_f32 v133, v133, v149
    v_mul_f32 v134, v134, v150
    v_mul_f32 v135, v135, v151
    v_mul_f32 v128, v128, v254
    v_mul_f32 v129, v129, v254
    v_mul_f32 v130, v130, v254
    v_mul_f32 v131, v131, v254
    v_cvt_pk_bf16_f32 v232, v128, v129
    v_cvt_pk_bf16_f32 v233, v130, v131
    v_mul_f32 v132, v132, v255
    v_mul_f32 v133, v133, v255
    v_mul_f32 v134, v134, v255
    v_mul_f32 v135, v135, v255
    v_cvt_pk_bf16_f32 v234, v132, v133
    v_cvt_pk_bf16_f32 v235, v134, v135
    v_max_f32 v136, 0, v136
    v_max_f32 v137, 0, v137
    v_max_f32 v138, 0, v138
    v_max_f32 v139, 0, v139
    v_max_f32 v140, 0, v140
    v_max_f32 v141, 0, v141
    v_max_f32 v142, 0, v142
    v_max_f32 v143, 0, v143
    v_permlane16_swap_b32 v232, v234
    v_permlane16_swap_b32 v233, v235
    buffer_store_dwordx4 v[232:235], v242, s[20:23], s70 offen offset:2048 sc1
    v_mul_f32 v136, v136, v152
    v_mul_f32 v137, v137, v153
    v_mul_f32 v138, v138, v154
    v_mul_f32 v139, v139, v155
    v_mul_f32 v140, v140, v156
    v_mul_f32 v141, v141, v157
    v_mul_f32 v142, v142, v158
    v_mul_f32 v143, v143, v159
    v_mul_f32 v136, v136, v254
    v_mul_f32 v137, v137, v254
    v_mul_f32 v138, v138, v254
    v_mul_f32 v139, v139, v254
    v_cvt_pk_bf16_f32 v236, v136, v137
    v_cvt_pk_bf16_f32 v237, v138, v139
    v_mul_f32 v140, v140, v255
    v_mul_f32 v141, v141, v255
    v_mul_f32 v142, v142, v255
    v_mul_f32 v143, v143, v255
    v_cvt_pk_bf16_f32 v238, v140, v141
    v_cvt_pk_bf16_f32 v239, v142, v143
    s_nop 0
    v_permlane16_swap_b32 v236, v238
    v_permlane16_swap_b32 v237, v239
    buffer_store_dwordx4 v[236:239], v242, s[20:23], s70 offen offset:3072 sc1
    s_branch L_BC
L_BC:
    s_setprio 3
    s_cmp_eq_u32 s73, 1
    s_cbranch_scc1 L_BC_fast
    s_waitcnt vmcnt(0)
    s_mov_b64 exec, 1
    buffer_store_dword v248, v252, s[20:23], 0 offen sc1
    s_mov_b64 exec, -1
    s_load_dwordx2 s[28:29], s[4:5], 0 glc
    s_load_dwordx2 s[30:31], s[4:5], 128 glc
    s_waitcnt lgkmcnt(0)
    s_xor_b64 s[6:7], s[28:29], s[62:63]
    s_xor_b64 s[76:77], s[30:31], s[62:63]
    s_or_b64 s[6:7], s[6:7], s[76:77]
    s_cmp_eq_u64 s[6:7], 0
    s_cbranch_scc1 L_BC_e_x
    s_mov_b32 s75, 0
L_BC_e:
    s_sleep 2
    s_load_dwordx2 s[28:29], s[4:5], 0 glc
    s_load_dwordx2 s[30:31], s[4:5], 128 glc
    s_add_u32 s75, s75, 1
    s_cmp_gt_u32 s75, 1048576
    s_cbranch_scc1 L_BC_e_y
    s_waitcnt lgkmcnt(0)
    s_xor_b64 s[6:7], s[28:29], s[62:63]
    s_xor_b64 s[76:77], s[30:31], s[62:63]
    s_or_b64 s[6:7], s[6:7], s[76:77]
    s_cmp_eq_u64 s[6:7], 0
    s_cbranch_scc0 L_BC_e
L_BC_e_y:
    s_waitcnt lgkmcnt(0)
L_BC_e_x:
    buffer_load_dwordx4 v[64:67], v242, s[20:23], s82 offen offset:0 sc1
    buffer_load_dwordx4 v[68:71], v242, s[20:23], s83 offen offset:0 sc1
    buffer_load_dwordx4 v[72:75], v242, s[20:23], s82 offen offset:1024 sc1
    buffer_load_dwordx4 v[76:79], v242, s[20:23], s83 offen offset:1024 sc1
    buffer_load_dwordx4 v[80:83], v242, s[20:23], s82 offen offset:2048 sc1
    buffer_load_dwordx4 v[84:87], v242, s[20:23], s83 offen offset:2048 sc1
    buffer_load_dwordx4 v[88:91], v242, s[20:23], s82 offen offset:3072 sc1
    buffer_load_dwordx4 v[92:95], v242, s[20:23], s83 offen offset:3072 sc1
    s_waitcnt vmcnt(0)
L_BC_fast:
    s_add_u32 s82, s82, 12288
    s_add_u32 s83, s83, 12288
    buffer_load_dwordx4 v[96:99], v242, s[20:23], s82 offen offset:0 sc1
    buffer_load_dwordx4 v[100:103], v242, s[20:23], s83 offen offset:0 sc1
    buffer_load_dwordx4 v[104:107], v242, s[20:23], s82 offen offset:1024 sc1
    buffer_load_dwordx4 v[108:111], v242, s[20:23], s83 offen offset:1024 sc1
    v_lshrrev_b32 v240, 4, v242
    v_lshrrev_b32 v247, 5, v240
    v_bfe_u32 v241, v240, 2, 2
    v_lshl_add_u32 v241, v247, 3, v241
    v_lshlrev_b32 v241, 7, v241
    v_bfe_u32 v247, v240, 3, 1
    v_lshl_add_u32 v241, v247, 6, v241
    v_bfe_u32 v247, v240, 4, 1
    v_lshl_add_u32 v241, v247, 5, v241
    v_and_b32 v247, 3, v240
    v_lshl_add_u32 v241, v247, 3, v241
    v_add_u32 v244, s81, v241
    v_xor_b32 v246, 64, v244
    s_lshl_b32 s6, s48, 13
    v_add_u32 v241, s6, v241
    v_xor_b32 v247, 64, v241
    s_sub_u32 s4, s4, 8192
    s_subb_u32 s5, s5, 0
    s_waitcnt vmcnt(8)
    v_mfma_f32_32x32x16_bf16 v[160:175], v[0:3], v[64:67], 0
    v_mfma_f32_32x32x16_bf16 v[176:191], v[0:3], v[68:71], 0
    v_mfma_f32_32x32x16_bf16 v[192:207], v[4:7], v[64:67], 0
    v_mfma_f32_32x32x16_bf16 v[208:223], v[4:7], v[68:71], 0
    v_mfma_f32_32x32x16_bf16 v[160:175], v[8:11], v[72:75], v[160:175]
    v_mfma_f32_32x32x16_bf16 v[176:191], v[8:11], v[76:79], v[176:191]
    v_mfma_f32_32x32x16_bf16 v[192:207], v[12:15], v[72:75], v[192:207]
    v_mfma_f32_32x32x16_bf16 v[208:223], v[12:15], v[76:79], v[208:223]
    v_mfma_f32_32x32x16_bf16 v[160:175], v[16:19], v[80:83], v[160:175]
    v_mfma_f32_32x32x16_bf16 v[176:191], v[16:19], v[84:87], v[176:191]
    v_mfma_f32_32x32x16_bf16 v[192:207], v[20:23], v[80:83], v[192:207]
    v_mfma_f32_32x32x16_bf16 v[208:223], v[20:23], v[84:87], v[208:223]
    s_waitcnt vmcnt(4)
    s_mov_b64 exec, 1
    buffer_store_dword v248, v252, s[20:23], 0 offen sc1
    s_mov_b64 exec, -1
    s_setprio 0
    buffer_load_dwordx4 v[112:115], v242, s[20:23], s82 offen offset:2048 sc1
    buffer_load_dwordx4 v[116:119], v242, s[20:23], s83 offen offset:2048 sc1
    buffer_load_dwordx4 v[120:123], v242, s[20:23], s82 offen offset:3072 sc1
    buffer_load_dwordx4 v[124:127], v242, s[20:23], s83 offen offset:3072 sc1
    s_sub_u32 s82, s82, 4096
    s_sub_u32 s83, s83, 4096
    buffer_load_dwordx4 v[128:131], v242, s[20:23], s82 offen offset:0 sc1
    buffer_load_dwordx4 v[132:135], v242, s[20:23], s83 offen offset:0 sc1
    v_mfma_f32_32x32x16_bf16 v[160:175], v[24:27], v[88:91], v[160:175]
    v_mfma_f32_32x32x16_bf16 v[176:191], v[24:27], v[92:95], v[176:191]
    v_mfma_f32_32x32x16_bf16 v[192:207], v[28:31], v[88:91], v[192:207]
    v_mfma_f32_32x32x16_bf16 v[208:223], v[28:31], v[92:95], v[208:223]
    buffer_load_dwordx4 v[136:139], v242, s[20:23], s82 offen offset:1024 sc1
    buffer_load_dwordx4 v[140:143], v242, s[20:23], s83 offen offset:1024 sc1
    s_load_dwordx2 s[28:29], s[4:5], 0 glc
    s_load_dwordx2 s[30:31], s[4:5], 128 glc
    s_waitcnt vmcnt(12)
    v_mfma_f32_32x32x16_bf16 v[160:175], v[32:35], v[96:99], v[160:175]
    s_waitcnt vmcnt(11)
    v_mfma_f32_32x32x16_bf16 v[176:191], v[32:35], v[100:103], v[176:191]
    v_mfma_f32_32x32x16_bf16 v[192:207], v[36:39], v[96:99], v[192:207]
    v_mfma_f32_32x32x16_bf16 v[208:223], v[36:39], v[100:103], v[208:223]
    buffer_load_dwordx4 v[144:147], v242, s[20:23], s82 offen offset:2048 sc1
    buffer_load_dwordx4 v[148:151], v242, s[20:23], s83 offen offset:2048 sc1
    s_waitcnt vmcnt(12)
    v_mfma_f32_32x32x16_bf16 v[160:175], v[40:43], v[104:107], v[160:175]
    s_waitcnt vmcnt(11)
    v_mfma_f32_32x32x16_bf16 v[176:191], v[40:43], v[108:111], v[176:191]
    v_mfma_f32_32x32x16_bf16 v[192:207], v[44:47], v[104:107], v[192:207]
    v_mfma_f32_32x32x16_bf16 v[208:223], v[44:47], v[108:111], v[208:223]
    buffer_load_dwordx4 v[152:155], v242, s[20:23], s82 offen offset:3072 sc1
    buffer_load_dwordx4 v[156:159], v242, s[20:23], s83 offen offset:3072 sc1
    s_waitcnt vmcnt(11)
    v_mfma_f32_32x32x16_bf16 v[160:175], v[48:51], v[112:115], v[160:175]
    s_waitcnt vmcnt(10)
    v_mfma_f32_32x32x16_bf16 v[176:191], v[48:51], v[116:119], v[176:191]
    v_mfma_f32_32x32x16_bf16 v[192:207], v[52:55], v[112:115], v[192:207]
    v_mfma_f32_32x32x16_bf16 v[208:223], v[52:55], v[116:119], v[208:223]
    ds_read_b64_tr_b16 v[224:225], v244 offset:0
    ds_read_b64_tr_b16 v[226:227], v244 offset:512
    ds_read_b64_tr_b16 v[228:229], v246 offset:0
    ds_read_b64_tr_b16 v[230:231], v246 offset:512
    s_waitcnt vmcnt(9)
    v_mfma_f32_32x32x16_bf16 v[160:175], v[56:59], v[120:123], v[160:175]
    s_waitcnt vmcnt(8)
    v_mfma_f32_32x32x16_bf16 v[176:191], v[56:59], v[124:127], v[176:191]
    v_mfma_f32_32x32x16_bf16 v[192:207], v[60:63], v[120:123], v[192:207]
    v_mfma_f32_32x32x16_bf16 v[208:223], v[60:63], v[124:127], v[208:223]
    s_waitcnt lgkmcnt(0)
    s_xor_b64 s[6:7], s[28:29], s[62:63]
    s_xor_b64 s[76:77], s[30:31], s[62:63]
    s_or_b64 s[6:7], s[6:7], s[76:77]
    s_cmp_eq_u64 s[6:7], 0
    s_cbranch_scc1 L_BC_f_x
    s_mov_b32 s75, 0
L_BC_f:
    s_sleep 2
    s_load_dwordx2 s[28:29], s[4:5], 0 glc
    s_load_dwordx2 s[30:31], s[4:5], 128 glc
    s_add_u32 s75, s75, 1
    s_cmp_gt_u32 s75, 1048576
    s_cbranch_scc1 L_BC_f_y
    s_waitcnt lgkmcnt(0)
    s_xor_b64 s[6:7], s[28:29], s[62:63]
    s_xor_b64 s[76:77], s[30:31], s[62:63]
    s_or_b64 s[6:7], s[6:7], s[76:77]
    s_cmp_eq_u64 s[6:7], 0
    s_cbranch_scc0 L_BC_f
L_BC_f_y:
    s_waitcnt lgkmcnt(0)
L_BC_f_x:
    s_sub_u32 s82, s82, 4096
    s_sub_u32 s83, s83, 4096
    buffer_load_dwordx4 v[0:3], v242, s[20:23], s82 offen offset:0 sc1
    buffer_load_dwordx4 v[4:7], v242, s[20:23], s83 offen offset:0 sc1
    buffer_load_dwordx4 v[8:11], v242, s[20:23], s82 offen offset:1024 sc1
    buffer_load_dwordx4 v[12:15], v242, s[20:23], s83 offen offset:1024 sc1
    ds_read_b64_tr_b16 v[232:233], v244 offset:2048
    ds_read_b64_tr_b16 v[234:235], v244 offset:2560
    ds_read_b64_tr_b16 v[236:237], v246 offset:2048
    ds_read_b64_tr_b16 v[238:239], v246 offset:2560
    s_waitcnt vmcnt(11)
    v_mfma_f32_32x32x16_bf16 v[160:175], v[224:227], v[128:131], v[160:175]
    s_waitcnt vmcnt(10)
    v_mfma_f32_32x32x16_bf16 v[176:191], v[224:227], v[132:135], v[176:191]
    v_mfma_f32_32x32x16_bf16 v[192:207], v[228:231], v[128:131], v[192:207]
    v_mfma_f32_32x32x16_bf16 v[208:223], v[228:231], v[132:135], v[208:223]
    buffer_load_dwordx4 v[16:19], v242, s[20:23], s82 offen offset:2048 sc1
    buffer_load_dwordx4 v[20:23], v242, s[20:23], s83 offen offset:2048 sc1
    buffer_load_dwordx4 v[24:27], v242, s[20:23], s82 offen offset:3072 sc1
    buffer_load_dwordx4 v[28:31], v242, s[20:23], s83 offen offset:3072 sc1
    ds_read_b64_tr_b16 v[224:225], v244 offset:4096
    ds_read_b64_tr_b16 v[226:227], v244 offset:4608
    ds_read_b64_tr_b16 v[228:229], v246 offset:4096
    ds_read_b64_tr_b16 v[230:231], v246 offset:4608
    s_waitcnt vmcnt(13) lgkmcnt(6)
    v_mfma_f32_32x32x16_bf16 v[160:175], v[232:235], v[136:139], v[160:175]
    s_waitcnt vmcnt(12)
    v_mfma_f32_32x32x16_bf16 v[176:191], v[232:235], v[140:143], v[176:191]
    s_waitcnt lgkmcnt(4)
    v_mfma_f32_32x32x16_bf16 v[192:207], v[236:239], v[136:139], v[192:207]
    v_mfma_f32_32x32x16_bf16 v[208:223], v[236:239], v[140:143], v[208:223]
    s_add_u32 s82, s82, 12288
    s_add_u32 s83, s83, 12288
    buffer_load_dwordx4 v[32:35], v242, s[20:23], s82 offen offset:0 sc1
    buffer_load_dwordx4 v[36:39], v242, s[20:23], s83 offen offset:0 sc1
    buffer_load_dwordx4 v[40:43], v242, s[20:23], s82 offen offset:1024 sc1
    buffer_load_dwordx4 v[44:47], v242, s[20:23], s83 offen offset:1024 sc1
    ds_read_b64_tr_b16 v[232:233], v244 offset:6144
    ds_read_b64_tr_b16 v[234:235], v244 offset:6656
    ds_read_b64_tr_b16 v[236:237], v246 offset:6144
    ds_read_b64_tr_b16 v[238:239], v246 offset:6656
    s_waitcnt vmcnt(15) lgkmcnt(6)
    v_mfma_f32_32x32x16_bf16 v[160:175], v[224:227], v[144:147], v[160:175]
    s_waitcnt vmcnt(14)
    v_mfma_f32_32x32x16_bf16 v[176:191], v[224:227], v[148:151], v[176:191]
    s_waitcnt lgkmcnt(4)
    v_mfma_f32_32x32x16_bf16 v[192:207], v[228:231], v[144:147], v[192:207]
    v_mfma_f32_32x32x16_bf16 v[208:223], v[228:231], v[148:151], v[208:223]
    buffer_load_dwordx4 v[48:51], v242, s[20:23], s82 offen offset:2048 sc1
    buffer_load_dwordx4 v[52:55], v242, s[20:23], s83 offen offset:2048 sc1
    buffer_load_dwordx4 v[56:59], v242, s[20:23], s82 offen offset:3072 sc1
    buffer_load_dwordx4 v[60:63], v242, s[20:23], s83 offen offset:3072 sc1
    ds_read_b64_tr_b16 v[224:225], v244 offset:8192
    ds_read_b64_tr_b16 v[226:227], v244 offset:8704
    ds_read_b64_tr_b16 v[228:229], v246 offset:8192
    ds_read_b64_tr_b16 v[230:231], v246 offset:8704
    s_waitcnt vmcnt(17) lgkmcnt(6)
    v_mfma_f32_32x32x16_bf16 v[160:175], v[232:235], v[152:155], v[160:175]
    s_waitcnt vmcnt(16)
    v_mfma_f32_32x32x16_bf16 v[176:191], v[232:235], v[156:159], v[176:191]
    s_waitcnt lgkmcnt(4)
    v_mfma_f32_32x32x16_bf16 v[192:207], v[236:239], v[152:155], v[192:207]
    v_mfma_f32_32x32x16_bf16 v[208:223], v[236:239], v[156:159], v[208:223]
    ds_read_b64_tr_b16 v[232:233], v244 offset:10240
    ds_read_b64_tr_b16 v[234:235], v244 offset:10752
    ds_read_b64_tr_b16 v[236:237], v246 offset:10240
    ds_read_b64_tr_b16 v[238:239], v246 offset:10752
    s_waitcnt vmcnt(15) lgkmcnt(6)
    v_mfma_f32_32x32x16_bf16 v[160:175], v[224:227], v[0:3], v[160:175]
    s_waitcnt vmcnt(14)
    v_mfma_f32_32x32x16_bf16 v[176:191], v[224:227], v[4:7], v[176:191]
    s_waitcnt lgkmcnt(4)
    v_mfma_f32_32x32x16_bf16 v[192:207], v[228:231], v[0:3], v[192:207]
    v_mfma_f32_32x32x16_bf16 v[208:223], v[228:231], v[4:7], v[208:223]
    v_lshrrev_b32 v252, 3, v240
    v_and_b32 v245, 7, v240
    v_lshlrev_b32 v245, 4, v245
    v_lshl_add_u32 v245, v252, 10, v245
    buffer_load_dwordx4 v[248:251], v245, s[8:11], s84 offen
    ds_read_b64_tr_b16 v[224:225], v244 offset:12288
    ds_read_b64_tr_b16 v[226:227], v244 offset:12800
    ds_read_b64_tr_b16 v[228:229], v246 offset:12288
    ds_read_b64_tr_b16 v[230:231], v246 offset:12800
    s_waitcnt vmcnt(14) lgkmcnt(6)
    v_mfma_f32_32x32x16_bf16 v[160:175], v[232:235], v[8:11], v[160:175]
    s_waitcnt vmcnt(13)
    v_mfma_f32_32x32x16_bf16 v[176:191], v[232:235], v[12:15], v[176:191]
    s_waitcnt lgkmcnt(4)
    v_mfma_f32_32x32x16_bf16 v[192:207], v[236:239], v[8:11], v[192:207]
    v_mfma_f32_32x32x16_bf16 v[208:223], v[236:239], v[12:15], v[208:223]
    ds_read_b64_tr_b16 v[232:233], v244 offset:14336
    ds_read_b64_tr_b16 v[234:235], v244 offset:14848
    ds_read_b64_tr_b16 v[236:237], v246 offset:14336
    ds_read_b64_tr_b16 v[238:239], v246 offset:14848
    s_waitcnt vmcnt(12) lgkmcnt(6)
    v_mfma_f32_32x32x16_bf16 v[160:175], v[224:227], v[16:19], v[160:175]
    s_waitcnt vmcnt(11)
    v_mfma_f32_32x32x16_bf16 v[176:191], v[224:227], v[20:23], v[176:191]
    s_waitcnt lgkmcnt(4)
    v_mfma_f32_32x32x16_bf16 v[192:207], v[228:231], v[16:19], v[192:207]
    v_mfma_f32_32x32x16_bf16 v[208:223], v[228:231], v[20:23], v[208:223]
    ds_read_b64_tr_b16 v[224:225], v241 offset:0
    ds_read_b64_tr_b16 v[226:227], v241 offset:512
    ds_read_b64_tr_b16 v[228:229], v247 offset:0
    ds_read_b64_tr_b16 v[230:231], v247 offset:512
    s_waitcnt vmcnt(10) lgkmcnt(6)
    v_mfma_f32_32x32x16_bf16 v[160:175], v[232:235], v[24:27], v[160:175]
    s_waitcnt vmcnt(9)
    v_mfma_f32_32x32x16_bf16 v[176:191], v[232:235], v[28:31], v[176:191]
    s_waitcnt lgkmcnt(4)
    v_mfma_f32_32x32x16_bf16 v[192:207], v[236:239], v[24:27], v[192:207]
    v_mfma_f32_32x32x16_bf16 v[208:223], v[236:239], v[28:31], v[208:223]
    ds_read_b64_tr_b16 v[232:233], v241 offset:2048
    ds_read_b64_tr_b16 v[234:235], v241 offset:2560
    ds_read_b64_tr_b16 v[236:237], v247 offset:2048
    ds_read_b64_tr_b16 v[238:239], v247 offset:2560
    s_waitcnt vmcnt(8) lgkmcnt(6)
    v_mfma_f32_32x32x16_bf16 v[160:175], v[224:227], v[32:35], v[160:175]
    s_waitcnt vmcnt(7)
    v_mfma_f32_32x32x16_bf16 v[176:191], v[224:227], v[36:39], v[176:191]
    s_waitcnt lgkmcnt(4)
    v_mfma_f32_32x32x16_bf16 v[192:207], v[228:231], v[32:35], v[192:207]
    v_mfma_f32_32x32x16_bf16 v[208:223], v[228:231], v[36:39], v[208:223]
    ds_read_b64_tr_b16 v[224:225], v241 offset:4096
    ds_read_b64_tr_b16 v[226:227], v241 offset:4608
    ds_read_b64_tr_b16 v[228:229], v247 offset:4096
    ds_read_b64_tr_b16 v[230:231], v247 offset:4608
    s_waitcnt vmcnt(6) lgkmcnt(6)
    v_mfma_f32_32x32x16_bf16 v[160:175], v[232:235], v[40:43], v[160:175]
    s_waitcnt vmcnt(5)
    v_mfma_f32_32x32x16_bf16 v[176:191], v[232:235], v[44:47], v[176:191]
    s_waitcnt lgkmcnt(4)
    v_mfma_f32_32x32x16_bf16 v[192:207], v[236:239], v[40:43], v[192:207]
    v_mfma_f32_32x32x16_bf16 v[208:223], v[236:239], v[44:47], v[208:223]
    ds_read_b64_tr_b16 v[232:233], v241 offset:6144
    ds_read_b64_tr_b16 v[234:235], v241 offset:6656
    ds_read_b64_tr_b16 v[236:237], v247 offset:6144
    ds_read_b64_tr_b16 v[238:239], v247 offset:6656
    s_waitcnt vmcnt(4) lgkmcnt(6)
    v_mfma_f32_32x32x16_bf16 v[160:175], v[224:227], v[48:51], v[160:175]
    s_waitcnt vmcnt(3)
    v_mfma_f32_32x32x16_bf16 v[176:191], v[224:227], v[52:55], v[176:191]
    s_waitcnt lgkmcnt(4)
    v_mfma_f32_32x32x16_bf16 v[192:207], v[228:231], v[48:51], v[192:207]
    v_mfma_f32_32x32x16_bf16 v[208:223], v[228:231], v[52:55], v[208:223]
    s_waitcnt vmcnt(2) lgkmcnt(2)
    v_mfma_f32_32x32x16_bf16 v[160:175], v[232:235], v[56:59], v[160:175]
    s_waitcnt vmcnt(1)
    v_mfma_f32_32x32x16_bf16 v[176:191], v[232:235], v[60:63], v[176:191]
    s_waitcnt lgkmcnt(0)
    v_mfma_f32_32x32x16_bf16 v[192:207], v[236:239], v[56:59], v[192:207]
    v_mfma_f32_32x32x16_bf16 v[208:223], v[236:239], v[60:63], v[208:223]
    v_mov_b32 v1, v240
    v_mov_b32 v7, v245
    v_and_b32 v4, 31, v1
    v_lshrrev_b32 v5, 5, v1
    v_and_b32 v6, 7, v1
    v_xor_b32 v6, v5, v6
    v_lshlrev_b32 v6, 4, v6
    v_lshl_add_u32 v6, v4, 8, v6
    v_add_u32 v72, s81, v6
    v_xor_b32 v73, 32, v72
    v_xor_b32 v74, 64, v72
    v_xor_b32 v75, 96, v72
    ds_write_b128 v72, v[160:163] offset:0
    ds_write_b128 v73, v[164:167] offset:0
    ds_write_b128 v74, v[168:171] offset:0
    ds_write_b128 v75, v[172:175] offset:0
    ds_write_b128 v72, v[176:179] offset:8192
    ds_write_b128 v73, v[180:183] offset:8192
    ds_write_b128 v74, v[184:187] offset:8192
    ds_write_b128 v75, v[188:191] offset:8192
    ds_write_b128 v72, v[192:195] offset:128
    ds_write_b128 v73, v[196:199] offset:128
    ds_write_b128 v74, v[200:203] offset:128
    ds_write_b128 v75, v[204:207] offset:128
    ds_write_b128 v72, v[208:211] offset:8320
    ds_write_b128 v73, v[212:215] offset:8320
    ds_write_b128 v74, v[216:219] offset:8320
    s_waitcnt lgkmcnt(8)
    ds_write_b128 v75, v[220:223] offset:8320
    s_waitcnt vmcnt(0)
    s_branch L_red
L_helper:
    s_cmp_eq_u32 s51, 0
    s_cbranch_scc1 L_helpX
    s_add_u32 m0, s97, 65536
    s_add_u32 s66, s96, 16384
    buffer_load_dwordx4 v10, s[8:11], s66 offen lds
    s_add_u32 m0, s97, 66560
    s_add_u32 s66, s96, 20480
    buffer_load_dwordx4 v11, s[8:11], s66 offen lds
    s_add_u32 m0, s97, 67584
    s_add_u32 s66, s96, 24576
    buffer_load_dwordx4 v12, s[8:11], s66 offen lds
    s_add_u32 m0, s97, 68608
    s_add_u32 s66, s96, 28672
    buffer_load_dwordx4 v13, s[8:11], s66 offen lds
    s_add_u32 m0, s97, 69632
    s_add_u32 s66, s96, 16640
    buffer_load_dwordx4 v10, s[8:11], s66 offen lds
    s_add_u32 m0, s97, 70656
    s_add_u32 s66, s96, 20736
    buffer_load_dwordx4 v11, s[8:11], s66 offen lds
    s_add_u32 m0, s97, 71680
    s_add_u32 s66, s96, 24832
    buffer_load_dwordx4 v12, s[8:11], s66 offen lds
    s_add_u32 m0, s97, 72704
    s_add_u32 s66, s96, 28928
    buffer_load_dwordx4 v13, s[8:11], s66 offen lds
    s_add_u32 m0, s97, 73728
    s_add_u32 s66, s96, 16896
    buffer_load_dwordx4 v10, s[8:11], s66 offen lds
    s_add_u32 m0, s97, 74752
    s_add_u32 s66, s96, 20992
    buffer_load_dwordx4 v11, s[8:11], s66 offen lds
    s_add_u32 m0, s97, 75776
    s_add_u32 s66, s96, 25088
    buffer_load_dwordx4 v12, s[8:11], s66 offen lds
    s_add_u32 m0, s97, 76800
    s_add_u32 s66, s96, 29184
    buffer_load_dwordx4 v13, s[8:11], s66 offen lds
    s_add_u32 m0, s97, 77824
    s_add_u32 s66, s96, 17152
    buffer_load_dwordx4 v10, s[8:11], s66 offen lds
    s_add_u32 m0, s97, 78848
    s_add_u32 s66, s96, 21248
    buffer_load_dwordx4 v11, s[8:11], s66 offen lds
    s_add_u32 m0, s97, 79872
    s_add_u32 s66, s96, 25344
    buffer_load_dwordx4 v12, s[8:11], s66 offen lds
    s_add_u32 m0, s97, 80896
    s_add_u32 s66, s96, 29440
    buffer_load_dwordx4 v13, s[8:11], s66 offen lds
    s_and_b32 s6, s49, 7
    s_lshl_b32 s6, s6, 6
    v_add_u32 v8, s6, v1
    v_mul_u32_u24 v9, 0xe00, v8
    s_cmp_eq_u32 s71, 1
    s_cselect_b32 s6, s4, s3
    s_cmp_eq_u32 s71, 2
    s_cselect_b32 s6, s5, s6
    s_lshl_b32 s6, s6, 1
    s_cmp_eq_u32 s71, 3
    s_cselect_b32 s6, 0x200000, s6
    s_cmp_ge_u32 s71, 1
    s_cselect_b32 s6, 0x200000, s6
    buffer_load_dword v253, v9, s[32:35], s6 offen
    buffer_load_dword v254, v9, s[36:39], s6 offen
    s_setprio 0
    v_lshrrev_b32 v4, 2, v1
    v_lshrrev_b32 v5, 4, v1
    v_and_b32 v5, 2, v5
    v_xor_b32 v5, v1, v5
    v_and_b32 v5, 3, v5
    v_lshlrev_b32 v5, 4, v5
    v_mul_u32_u24 v251, 0xe00, v4
    v_add_u32 v251, v251, v5
    v_lshrrev_b32 v4, 3, v1
    v_bfe_u32 v5, v1, 4, 1
    v_lshlrev_b32 v5, 2, v5
    v_xor_b32 v5, v1, v5
    v_and_b32 v5, 7, v5
    v_lshlrev_b32 v5, 4, v5
    v_mul_u32_u24 v2, 0xc00, v4
    v_add_u32 v2, v2, v5
    v_mul_u32_u24 v3, 0xe00, v4
    v_add_u32 v3, v3, v5
    v_lshl_add_u32 v252, v4, 10, v5
    v_xor_b32 v5, 32, v5
    v_mul_u32_u24 v249, 0xc00, v4
    v_add_u32 v249, v249, v5
    v_mul_u32_u24 v250, 0xe00, v4
    v_add_u32 v250, v250, v5
    s_lshl_b32 s59, s71, 12
    s_lshl_b32 s60, s71, 13
    s_mul_i32 s6, s71, 114688
    s_lshl_b32 s7, s5, 1
    s_add_u32 s58, s6, s7
    s_lshl_b32 s7, s3, 1
    s_add_u32 s54, s6, s7
    s_mul_i32 s6, s71, 229376
    s_lshl_b32 s7, s4, 1
    s_add_u32 s56, s6, s7
    s_lshl_b32 s57, s71, 11
    s_lshl_b32 s6, s71, 14
    s_lshl_b32 s7, s53, 7
    s_add_u32 s85, s6, s7
    s_lshl_b32 s67, s50, 2
    s_add_u32 s67, s67, s71
    s_lshl_b32 s78, s67, 12
    s_add_u32 s78, s78, 9437184
    s_cmp_lt_u32 s48, 6
    s_cselect_b32 s16, s12, s16
    s_cselect_b32 s17, s13, s17
    s_cselect_b32 s18, s14, s18
    v_lshrrev_b32 v4, 5, v1
    v_lshlrev_b32 v7, 8, v4
    v_and_b32 v6, 15, v1
    v_lshl_add_u32 v36, v6, 1, v7
    s_lshl_b32 s65, s67, 9
    v_lshlrev_b32 v238, 4, v1
    v_and_b32 v5, 31, v1
    v_min_u32 v5, 16, v5
    v_lshl_add_u32 v5, v4, 5, v5
    v_lshlrev_b32 v235, 2, v5
    s_add_u32 s79, s57, 65536
    v_lshrrev_b32 v11, 5, v1
    v_bfe_u32 v240, v1, 2, 2
    v_lshl_add_u32 v240, v11, 3, v240
    v_lshlrev_b32 v240, 7, v240
    v_bfe_u32 v11, v1, 3, 1
    v_lshl_add_u32 v240, v11, 6, v240
    v_bfe_u32 v11, v1, 4, 1
    v_lshl_add_u32 v240, v11, 5, v240
    v_and_b32 v11, 3, v1
    v_lshl_add_u32 v240, v11, 3, v240
    v_add_u32 v240, s79, v240
    v_xor_b32 v241, 64, v240
    s_waitcnt vmcnt(2)
    s_barrier
    s_add_u32 m0, s59, 131072
    s_add_u32 s64, s54, 0
    buffer_load_dwordx4 v3, s[32:35], s64 offen lds
    s_add_u32 m0, s59, 147456
    s_add_u32 s64, s54, 0
    buffer_load_dwordx4 v3, s[36:39], s64 offen lds
    s_add_u32 m0, s59, 132096
    s_add_u32 s64, s54, 28672
    buffer_load_dwordx4 v250, s[32:35], s64 offen lds
    s_add_u32 m0, s59, 148480
    s_add_u32 s64, s54, 28672
    buffer_load_dwordx4 v250, s[36:39], s64 offen lds
    s_add_u32 m0, s59, 133120
    s_add_u32 s64, s54, 57344
    buffer_load_dwordx4 v3, s[32:35], s64 offen lds
    s_add_u32 m0, s59, 149504
    s_add_u32 s64, s54, 57344
    buffer_load_dwordx4 v3, s[36:39], s64 offen lds
    s_add_u32 m0, s59, 134144
    s_add_u32 s64, s54, 86016
    buffer_load_dwordx4 v250, s[32:35], s64 offen lds
    s_add_u32 m0, s59, 150528
    s_add_u32 s64, s54, 86016
    buffer_load_dwordx4 v250, s[36:39], s64 offen lds
    s_add_u32 m0, s59, 0
    s_add_u32 s64, s54, 458752
    buffer_load_dwordx4 v3, s[32:35], s64 offen lds
    s_add_u32 m0, s59, 16384
    s_add_u32 s64, s54, 458752
    buffer_load_dwordx4 v3, s[36:39], s64 offen lds
    s_add_u32 m0, s59, 1024
    s_add_u32 s64, s54, 487424
    buffer_load_dwordx4 v250, s[32:35], s64 offen lds
    s_add_u32 m0, s59, 17408
    s_add_u32 s64, s54, 487424
    buffer_load_dwordx4 v250, s[36:39], s64 offen lds
    s_add_u32 m0, s59, 2048
    s_add_u32 s64, s54, 516096
    buffer_load_dwordx4 v3, s[32:35], s64 offen lds
    s_add_u32 m0, s59, 18432
    s_add_u32 s64, s54, 516096
    buffer_load_dwordx4 v3, s[36:39], s64 offen lds
    s_add_u32 m0, s59, 3072
    s_add_u32 s64, s54, 544768
    buffer_load_dwordx4 v250, s[32:35], s64 offen lds
    s_add_u32 m0, s59, 19456
    s_add_u32 s64, s54, 544768
    buffer_load_dwordx4 v250, s[36:39], s64 offen lds
    v_mov_b32 v17, 0
    buffer_load_dword v16, v17, s[40:43], 0 offen sc1
    s_barrier
    s_add_u32 m0, s59, 32768
    s_add_u32 s64, s54, 917504
    buffer_load_dwordx4 v3, s[32:35], s64 offen lds
    s_add_u32 m0, s59, 49152
    s_add_u32 s64, s54, 917504
    buffer_load_dwordx4 v3, s[36:39], s64 offen lds
    s_add_u32 m0, s59, 33792
    s_add_u32 s64, s54, 946176
    buffer_load_dwordx4 v250, s[32:35], s64 offen lds
    s_add_u32 m0, s59, 50176
    s_add_u32 s64, s54, 946176
    buffer_load_dwordx4 v250, s[36:39], s64 offen lds
    s_add_u32 m0, s59, 34816
    s_add_u32 s64, s54, 974848
    buffer_load_dwordx4 v3, s[32:35], s64 offen lds
    s_add_u32 m0, s59, 51200
    s_add_u32 s64, s54, 974848
    buffer_load_dwordx4 v3, s[36:39], s64 offen lds
    s_add_u32 m0, s59, 35840
    s_add_u32 s64, s54, 1003520
    buffer_load_dwordx4 v250, s[32:35], s64 offen lds
    s_add_u32 m0, s59, 52224
    s_add_u32 s64, s54, 1003520
    buffer_load_dwordx4 v250, s[36:39], s64 offen lds
    s_waitcnt vmcnt(17)
    s_barrier
    buffer_load_ushort v200, v36, s[44:47], s65 offen offset:0
    buffer_load_ushort v201, v36, s[44:47], s65 offen offset:32
    buffer_load_ushort v202, v36, s[44:47], s65 offen offset:64
    buffer_load_ushort v203, v36, s[44:47], s65 offen offset:96
    buffer_load_ushort v204, v36, s[44:47], s65 offen offset:128
    buffer_load_ushort v205, v36, s[44:47], s65 offen offset:160
    buffer_load_ushort v206, v36, s[44:47], s65 offen offset:192
    buffer_load_ushort v207, v36, s[44:47], s65 offen offset:224
    s_and_b32 s6, s49, 7
    s_lshl_b32 s6, s6, 6
    v_add_u32 v8, s6, v1
    v_mul_u32_u24 v9, 0xe00, v8
    s_cmp_eq_u32 s71, 1
    s_cselect_b32 s6, s4, s3
    s_cmp_eq_u32 s71, 2
    s_cselect_b32 s6, s5, s6
    s_lshl_b32 s6, s6, 1
    s_cmp_eq_u32 s71, 3
    s_cselect_b32 s6, 0x200000, s6
    s_cmp_lt_u32 s71, 1
    s_cselect_b32 s6, 0x200000, s6
    buffer_load_dword v243, v9, s[32:35], s6 offen
    buffer_load_dword v244, v9, s[36:39], s6 offen
    s_mul_i32 s6, s2, 7168
    s_lshl_b32 s7, s2, 11
    s_cmp_eq_u32 s48, 7
    s_cselect_b32 s6, s6, 0x200000
    s_cselect_b32 s7, s7, 0x200000
    v_lshlrev_b32 v8, 7, v1
    v_min_u32 v9, 1920, v8
    v_min_u32 v8, 7040, v8
    buffer_load_dword v246, v8, s[12:15], s6 offen
    buffer_load_dword v247, v9, s[16:19], s7 offen
    s_waitcnt lgkmcnt(0)
    s_waitcnt vmcnt(21)
    s_barrier
    s_add_u32 m0, s59, 131072
    s_add_u32 s64, s54, 1376256
    buffer_load_dwordx4 v3, s[32:35], s64 offen lds
    s_add_u32 m0, s59, 147456
    s_add_u32 s64, s54, 1376256
    buffer_load_dwordx4 v3, s[36:39], s64 offen lds
    s_add_u32 m0, s59, 132096
    s_add_u32 s64, s54, 1404928
    buffer_load_dwordx4 v250, s[32:35], s64 offen lds
    s_add_u32 m0, s59, 148480
    s_add_u32 s64, s54, 1404928
    buffer_load_dwordx4 v250, s[36:39], s64 offen lds
    s_add_u32 m0, s59, 133120
    s_add_u32 s64, s54, 1433600
    buffer_load_dwordx4 v3, s[32:35], s64 offen lds
    s_add_u32 m0, s59, 149504
    s_add_u32 s64, s54, 1433600
    buffer_load_dwordx4 v3, s[36:39], s64 offen lds
    s_add_u32 m0, s59, 134144
    s_add_u32 s64, s54, 1462272
    buffer_load_dwordx4 v250, s[32:35], s64 offen lds
    s_add_u32 m0, s59, 150528
    s_add_u32 s64, s54, 1462272
    buffer_load_dwordx4 v250, s[36:39], s64 offen lds
    s_add_u32 m0, s57, 65536
    s_add_u32 s64, s80, 0
    buffer_load_dwordx4 v252, s[16:19], s64 offen lds
    s_add_u32 m0, s57, 66560
    s_add_u32 s64, s80, 8192
    buffer_load_dwordx4 v252, s[16:19], s64 offen lds
    s_add_u32 m0, s57, 73728
    s_add_u32 s64, s80, 16384
    buffer_load_dwordx4 v252, s[16:19], s64 offen lds
    s_add_u32 m0, s57, 74752
    s_add_u32 s64, s80, 24576
    buffer_load_dwordx4 v252, s[16:19], s64 offen lds
    s_add_u32 m0, s57, 81920
    s_add_u32 s64, s80, 32768
    buffer_load_dwordx4 v252, s[16:19], s64 offen lds
    s_add_u32 m0, s57, 82944
    s_add_u32 s64, s80, 40960
    buffer_load_dwordx4 v252, s[16:19], s64 offen lds
    s_add_u32 m0, s57, 90112
    s_add_u32 s64, s80, 49152
    buffer_load_dwordx4 v252, s[16:19], s64 offen lds
    s_add_u32 m0, s57, 91136
    s_add_u32 s64, s80, 57344
    buffer_load_dwordx4 v252, s[16:19], s64 offen lds
    s_waitcnt lgkmcnt(0)
    s_waitcnt vmcnt(28)
    s_barrier
    s_add_u32 m0, s59, 0
    s_add_u32 s64, s56, 0
    buffer_load_dwordx4 v251, s[32:35], s64 offen lds
    s_add_u32 m0, s59, 16384
    s_add_u32 s64, s56, 0
    buffer_load_dwordx4 v251, s[36:39], s64 offen lds
    s_add_u32 m0, s59, 1024
    s_add_u32 s64, s56, 57344
    buffer_load_dwordx4 v251, s[32:35], s64 offen lds
    s_add_u32 m0, s59, 17408
    s_add_u32 s64, s56, 57344
    buffer_load_dwordx4 v251, s[36:39], s64 offen lds
    s_add_u32 m0, s59, 2048
    s_add_u32 s64, s56, 114688
    buffer_load_dwordx4 v251, s[32:35], s64 offen lds
    s_add_u32 m0, s59, 18432
    s_add_u32 s64, s56, 114688
    buffer_load_dwordx4 v251, s[36:39], s64 offen lds
    s_add_u32 m0, s59, 3072
    s_add_u32 s64, s56, 172032
    buffer_load_dwordx4 v251, s[32:35], s64 offen lds
    s_add_u32 m0, s59, 19456
    s_add_u32 s64, s56, 172032
    buffer_load_dwordx4 v251, s[36:39], s64 offen lds
    s_waitcnt lgkmcnt(0)
    s_waitcnt vmcnt(16)
    s_barrier
    s_waitcnt vmcnt(8)
    ds_read_b64_tr_b16 v[72:73], v240 offset:0
    ds_read_b64_tr_b16 v[74:75], v240 offset:512
    ds_read_b64_tr_b16 v[76:77], v241 offset:0
    ds_read_b64_tr_b16 v[78:79], v241 offset:512
    ds_read_b64_tr_b16 v[80:81], v240 offset:8192
    ds_read_b64_tr_b16 v[82:83], v240 offset:8704
    ds_read_b64_tr_b16 v[84:85], v241 offset:8192
    ds_read_b64_tr_b16 v[86:87], v241 offset:8704
    ds_read_b64_tr_b16 v[88:89], v240 offset:16384
    ds_read_b64_tr_b16 v[90:91], v240 offset:16896
    ds_read_b64_tr_b16 v[92:93], v241 offset:16384
    ds_read_b64_tr_b16 v[94:95], v241 offset:16896
    s_waitcnt lgkmcnt(4)
    ds_read_b64_tr_b16 v[96:97], v240 offset:24576
    ds_read_b64_tr_b16 v[98:99], v240 offset:25088
    ds_read_b64_tr_b16 v[100:101], v241 offset:24576
    ds_read_b64_tr_b16 v[102:103], v241 offset:25088
    s_waitcnt lgkmcnt(0)
    s_add_u32 m0, s59, 32768
    s_add_u32 s64, s56, 917504
    buffer_load_dwordx4 v251, s[32:35], s64 offen lds
    v_cmp_eq_u32 vcc, 0, v16
    s_nop 0
    s_cbranch_vccz L_nonY_x
    s_mov_b32 s75, 0
L_nonY:
    buffer_load_dword v16, v17, s[40:43], 0 offen sc1
    s_waitcnt vmcnt(0)
    s_add_u32 s75, s75, 1
    s_cmp_gt_u32 s75, 1048576
    s_cbranch_scc1 L_nonY_x
    v_cmp_eq_u32 vcc, 0, v16
    s_nop 0
    s_cbranch_vccnz L_nonY
L_nonY_x:
    s_add_u32 m0, s59, 49152
    s_add_u32 s64, s56, 917504
    buffer_load_dwordx4 v251, s[36:39], s64 offen lds
    v_readfirstlane_b32 s62, v16
    v_readfirstlane_b32 s63, v16
    v_bfe_u32 v6, v1, 4, 1
    v_mul_u32_u24 v6, 0x8000, v6
    v_lshl_or_b32 v6, v6, 16, v6
    v_lshl_or_b32 v8, v201, 16, v200
    s_add_u32 m0, s59, 33792
    s_add_u32 s64, s56, 974848
    buffer_load_dwordx4 v251, s[32:35], s64 offen lds
    v_xor_b32 v8, v6, v8
    v_lshl_or_b32 v9, v203, 16, v202
    v_xor_b32 v9, v6, v9
    v_lshl_or_b32 v10, v205, 16, v204
    v_xor_b32 v10, v6, v10
    v_lshl_or_b32 v11, v207, 16, v206
    s_add_u32 m0, s59, 50176
    s_add_u32 s64, s56, 974848
    buffer_load_dwordx4 v251, s[36:39], s64 offen lds
    v_xor_b32 v11, v6, v11
    s_lshl_b32 s6, s49, 3
    s_add_u32 s6, s6, s50
    s_lshl_b32 s72, s6, 14
    s_lshl_b32 s7, s71, 12
    s_add_u32 s72, s72, s7
    s_add_u32 m0, s59, 34816
    s_add_u32 s64, s56, 1032192
    buffer_load_dwordx4 v251, s[32:35], s64 offen lds
    s_add_u32 s72, s72, 9699328
    s_lshl_b32 s6, s6, 7
    s_add_u32 s6, s6, 11821056
    s_add_u32 s4, s20, s6
    s_addc_u32 s5, s21, 0
    s_lshl_b32 s6, s49, 5
    s_add_u32 m0, s59, 51200
    s_add_u32 s64, s56, 1032192
    buffer_load_dwordx4 v251, s[36:39], s64 offen lds
    s_add_u32 s6, s6, s67
    s_lshl_b32 s6, s6, 2
    s_add_u32 s6, s6, 11816960
    v_mov_b32 v18, s6
    s_add_u32 m0, s59, 35840
    s_add_u32 s64, s56, 1089536
    buffer_load_dwordx4 v251, s[32:35], s64 offen lds
    s_add_u32 m0, s59, 52224
    s_add_u32 s64, s56, 1089536
    buffer_load_dwordx4 v251, s[36:39], s64 offen lds
    s_waitcnt lgkmcnt(0)
    s_waitcnt vmcnt(8)
    s_barrier
    s_add_u32 m0, s59, 131072
    s_add_u32 s64, s58, 0
    buffer_load_dwordx4 v3, s[32:35], s64 offen lds
    s_add_u32 m0, s59, 147456
    s_add_u32 s64, s58, 0
    buffer_load_dwordx4 v3, s[36:39], s64 offen lds
    s_add_u32 m0, s59, 132096
    s_add_u32 s64, s58, 28672
    buffer_load_dwordx4 v250, s[32:35], s64 offen lds
    s_add_u32 m0, s59, 148480
    s_add_u32 s64, s58, 28672
    buffer_load_dwordx4 v250, s[36:39], s64 offen lds
    s_add_u32 m0, s59, 133120
    s_add_u32 s64, s58, 57344
    buffer_load_dwordx4 v3, s[32:35], s64 offen lds
    s_add_u32 m0, s59, 149504
    s_add_u32 s64, s58, 57344
    buffer_load_dwordx4 v3, s[36:39], s64 offen lds
    s_add_u32 m0, s59, 134144
    s_add_u32 s64, s58, 86016
    buffer_load_dwordx4 v250, s[32:35], s64 offen lds
    s_add_u32 m0, s59, 150528
    s_add_u32 s64, s58, 86016
    buffer_load_dwordx4 v250, s[36:39], s64 offen lds
    s_add_u32 m0, s57, 98304
    s_add_u32 s64, s80, 65536
    buffer_load_dwordx4 v252, s[16:19], s64 offen lds
    s_add_u32 m0, s57, 99328
    s_add_u32 s64, s80, 73728
    buffer_load_dwordx4 v252, s[16:19], s64 offen lds
    s_add_u32 m0, s57, 106496
    s_add_u32 s64, s80, 81920
    buffer_load_dwordx4 v252, s[16:19], s64 offen lds
    s_add_u32 m0, s57, 107520
    s_add_u32 s64, s80, 90112
    buffer_load_dwordx4 v252, s[16:19], s64 offen lds
    s_add_u32 m0, s57, 114688
    s_add_u32 s64, s80, 98304
    buffer_load_dwordx4 v252, s[16:19], s64 offen lds
    s_add_u32 m0, s57, 115712
    s_add_u32 s64, s80, 106496
    buffer_load_dwordx4 v252, s[16:19], s64 offen lds
    s_add_u32 m0, s57, 122880
    s_add_u32 s64, s80, 114688
    buffer_load_dwordx4 v252, s[16:19], s64 offen lds
    s_add_u32 m0, s57, 123904
    s_add_u32 s64, s80, 122880
    buffer_load_dwordx4 v252, s[16:19], s64 offen lds
    s_add_u32 m0, s57, 65536
    s_add_u32 s64, s85, 524288
    buffer_load_dwordx4 v252, s[12:15], s64 offen lds
    s_add_u32 m0, s57, 66560
    s_add_u32 s64, s85, 532480
    buffer_load_dwordx4 v252, s[12:15], s64 offen lds
    s_add_u32 m0, s57, 73728
    s_add_u32 s64, s85, 720896
    buffer_load_dwordx4 v252, s[12:15], s64 offen lds
    s_add_u32 m0, s57, 74752
    s_add_u32 s64, s85, 729088
    buffer_load_dwordx4 v252, s[12:15], s64 offen lds
    s_waitcnt lgkmcnt(0)
    s_waitcnt vmcnt(20)
    s_barrier
    s_add_u32 m0, s59, 0
    s_add_u32 s64, s58, 458752
    buffer_load_dwordx4 v3, s[32:35], s64 offen lds
    s_add_u32 m0, s59, 16384
    s_add_u32 s64, s58, 458752
    buffer_load_dwordx4 v3, s[36:39], s64 offen lds
    s_add_u32 m0, s59, 1024
    s_add_u32 s64, s58, 487424
    buffer_load_dwordx4 v250, s[32:35], s64 offen lds
    s_add_u32 m0, s59, 17408
    s_add_u32 s64, s58, 487424
    buffer_load_dwordx4 v250, s[36:39], s64 offen lds
    s_add_u32 m0, s59, 2048
    s_add_u32 s64, s58, 516096
    buffer_load_dwordx4 v3, s[32:35], s64 offen lds
    s_add_u32 m0, s59, 18432
    s_add_u32 s64, s58, 516096
    buffer_load_dwordx4 v3, s[36:39], s64 offen lds
    s_add_u32 m0, s59, 3072
    s_add_u32 s64, s58, 544768
    buffer_load_dwordx4 v250, s[32:35], s64 offen lds
    s_add_u32 m0, s59, 19456
    s_add_u32 s64, s58, 544768
    buffer_load_dwordx4 v250, s[36:39], s64 offen lds
    s_add_u32 m0, s57, 81920
    s_add_u32 s64, s85, 851968
    buffer_load_dwordx4 v252, s[12:15], s64 offen lds
    s_add_u32 m0, s57, 82944
    s_add_u32 s64, s85, 860160
    buffer_load_dwordx4 v252, s[12:15], s64 offen lds
    s_add_u32 m0, s57, 90112
    s_add_u32 s64, s85, 1048576
    buffer_load_dwordx4 v252, s[12:15], s64 offen lds
    s_add_u32 m0, s57, 91136
    s_add_u32 s64, s85, 1056768
    buffer_load_dwordx4 v252, s[12:15], s64 offen lds
    s_waitcnt lgkmcnt(0)
    s_waitcnt vmcnt(24)
    s_barrier
    s_waitcnt vmcnt(16)
    ds_read_b64_tr_b16 v[104:105], v240 offset:32768
    ds_read_b64_tr_b16 v[106:107], v240 offset:33280
    ds_read_b64_tr_b16 v[108:109], v241 offset:32768
    ds_read_b64_tr_b16 v[110:111], v241 offset:33280
    ds_read_b64_tr_b16 v[112:113], v240 offset:40960
    ds_read_b64_tr_b16 v[114:115], v240 offset:41472
    ds_read_b64_tr_b16 v[116:117], v241 offset:40960
    ds_read_b64_tr_b16 v[118:119], v241 offset:41472
    ds_read_b64_tr_b16 v[120:121], v240 offset:49152
    ds_read_b64_tr_b16 v[122:123], v240 offset:49664
    ds_read_b64_tr_b16 v[124:125], v241 offset:49152
    ds_read_b64_tr_b16 v[126:127], v241 offset:49664
    s_waitcnt lgkmcnt(4)
    ds_read_b64_tr_b16 v[128:129], v240 offset:57344
    ds_read_b64_tr_b16 v[130:131], v240 offset:57856
    ds_read_b64_tr_b16 v[132:133], v241 offset:57344
    ds_read_b64_tr_b16 v[134:135], v241 offset:57856
    s_waitcnt lgkmcnt(0)
    s_add_u32 m0, s59, 32768
    s_add_u32 s64, s58, 917504
    buffer_load_dwordx4 v3, s[32:35], s64 offen lds
    s_add_u32 m0, s59, 49152
    s_add_u32 s64, s58, 917504
    buffer_load_dwordx4 v3, s[36:39], s64 offen lds
    s_add_u32 m0, s59, 33792
    s_add_u32 s64, s58, 946176
    buffer_load_dwordx4 v250, s[32:35], s64 offen lds
    s_add_u32 m0, s59, 50176
    s_add_u32 s64, s58, 946176
    buffer_load_dwordx4 v250, s[36:39], s64 offen lds
    s_add_u32 m0, s59, 34816
    s_add_u32 s64, s58, 974848
    buffer_load_dwordx4 v3, s[32:35], s64 offen lds
    s_add_u32 m0, s59, 51200
    s_add_u32 s64, s58, 974848
    buffer_load_dwordx4 v3, s[36:39], s64 offen lds
    s_add_u32 m0, s59, 35840
    s_add_u32 s64, s58, 1003520
    buffer_load_dwordx4 v250, s[32:35], s64 offen lds
    s_add_u32 m0, s59, 52224
    s_add_u32 s64, s58, 1003520
    buffer_load_dwordx4 v250, s[36:39], s64 offen lds
    s_add_u32 m0, s57, 98304
    s_add_u32 s64, s85, 1179648
    buffer_load_dwordx4 v252, s[12:15], s64 offen lds
    s_add_u32 m0, s57, 99328
    s_add_u32 s64, s85, 1187840
    buffer_load_dwordx4 v252, s[12:15], s64 offen lds
    s_add_u32 m0, s57, 106496
    s_add_u32 s64, s85, 1376256
    buffer_load_dwordx4 v252, s[12:15], s64 offen lds
    s_add_u32 m0, s57, 107520
    s_add_u32 s64, s85, 1384448
    buffer_load_dwordx4 v252, s[12:15], s64 offen lds
    s_waitcnt lgkmcnt(0)
    s_waitcnt vmcnt(16)
    s_barrier
    s_add_u32 m0, s59, 131072
    s_add_u32 s64, s58, 1376256
    buffer_load_dwordx4 v3, s[32:35], s64 offen lds
    s_add_u32 m0, s59, 147456
    s_add_u32 s64, s58, 1376256
    buffer_load_dwordx4 v3, s[36:39], s64 offen lds
    s_add_u32 m0, s59, 132096
    s_add_u32 s64, s58, 1404928
    buffer_load_dwordx4 v250, s[32:35], s64 offen lds
    s_add_u32 m0, s59, 148480
    s_add_u32 s64, s58, 1404928
    buffer_load_dwordx4 v250, s[36:39], s64 offen lds
    s_add_u32 m0, s59, 133120
    s_add_u32 s64, s58, 1433600
    buffer_load_dwordx4 v3, s[32:35], s64 offen lds
    s_add_u32 m0, s59, 149504
    s_add_u32 s64, s58, 1433600
    buffer_load_dwordx4 v3, s[36:39], s64 offen lds
    s_add_u32 m0, s59, 134144
    s_add_u32 s64, s58, 1462272
    buffer_load_dwordx4 v250, s[32:35], s64 offen lds
    s_add_u32 m0, s59, 150528
    s_add_u32 s64, s58, 1462272
    buffer_load_dwordx4 v250, s[36:39], s64 offen lds
    s_add_u32 m0, s57, 114688
    s_add_u32 s64, s85, 1507328
    buffer_load_dwordx4 v252, s[12:15], s64 offen lds
    s_add_u32 m0, s57, 115712
    s_add_u32 s64, s85, 1515520
    buffer_load_dwordx4 v252, s[12:15], s64 offen lds
    s_add_u32 m0, s57, 122880
    s_add_u32 s64, s85, 1703936
    buffer_load_dwordx4 v252, s[12:15], s64 offen lds
    s_add_u32 m0, s57, 123904
    s_add_u32 s64, s85, 1712128
    buffer_load_dwordx4 v252, s[12:15], s64 offen lds
    s_waitcnt lgkmcnt(0)
    s_waitcnt vmcnt(16)
    s_barrier
    s_add_u32 m0, s57, 0
    s_add_u32 s64, s85, 786432
    buffer_load_dwordx4 v252, s[12:15], s64 offen lds
    s_add_u32 m0, s57, 1024
    s_add_u32 s64, s85, 794624
    buffer_load_dwordx4 v252, s[12:15], s64 offen lds
    s_add_u32 m0, s57, 8192
    s_add_u32 s64, s85, 1114112
    buffer_load_dwordx4 v252, s[12:15], s64 offen lds
    s_add_u32 m0, s57, 9216
    s_add_u32 s64, s85, 1122304
    buffer_load_dwordx4 v252, s[12:15], s64 offen lds
    s_add_u32 m0, s57, 16384
    s_add_u32 s64, s85, 1441792
    buffer_load_dwordx4 v252, s[12:15], s64 offen lds
    s_add_u32 m0, s57, 17408
    s_add_u32 s64, s85, 1449984
    buffer_load_dwordx4 v252, s[12:15], s64 offen lds
    s_add_u32 m0, s57, 24576
    s_add_u32 s64, s85, 1769472
    buffer_load_dwordx4 v252, s[12:15], s64 offen lds
    s_add_u32 m0, s57, 25600
    s_add_u32 s64, s85, 1777664
    buffer_load_dwordx4 v252, s[12:15], s64 offen lds
    s_load_dwordx4 s[44:47], s[4:5], 0 glc
    s_waitcnt vmcnt(8)
    s_barrier
    s_waitcnt lgkmcnt(0)
    s_xor_b64 s[6:7], s[44:45], s[62:63]
    s_xor_b64 s[76:77], s[46:47], s[62:63]
    s_or_b64 s[6:7], s[6:7], s[76:77]
    s_cmp_eq_u64 s[6:7], 0
    s_cbranch_scc1 L_pollq_x
    s_mov_b32 s75, 0
L_pollq:
    s_sleep 2
    s_load_dwordx4 s[44:47], s[4:5], 0 glc
    s_add_u32 s75, s75, 1
    s_cmp_gt_u32 s75, 1048576
    s_cbranch_scc1 L_pollq_y
    s_waitcnt lgkmcnt(0)
    s_xor_b64 s[6:7], s[44:45], s[62:63]
    s_xor_b64 s[76:77], s[46:47], s[62:63]
    s_or_b64 s[6:7], s[6:7], s[76:77]
    s_cmp_eq_u64 s[6:7], 0
    s_cbranch_scc0 L_pollq
L_pollq_y:
    s_waitcnt lgkmcnt(0)
L_pollq_x:
    s_setprio 3
    buffer_load_dwordx4 v[24:27], v238, s[20:23], s72 offen offset:0 sc1
    buffer_load_dwordx4 v[28:31], v238, s[20:23], s72 offen offset:1024 sc1
    buffer_load_dwordx4 v[32:35], v238, s[20:23], s72 offen offset:2048 sc1
    buffer_load_dwordx4 v[36:39], v238, s[20:23], s72 offen offset:3072 sc1
    s_lshl_b32 s6, s67, 7
    s_add_u32 s6, s6, 11796480
    s_add_u32 s4, s20, s6
    s_addc_u32 s5, s21, 0
    s_mov_b32 s73, 0
    s_waitcnt vmcnt(3)
    v_mfma_f32_32x32x16_bf16 v[136:151], v[8:11], v[24:27], 0
    s_waitcnt vmcnt(2)
    v_mfma_f32_32x32x16_bf16 v[152:167], v[8:11], v[28:31], 0
    s_waitcnt vmcnt(1)
    v_mfma_f32_32x32x16_bf16 v[168:183], v[8:11], v[32:35], 0
    s_waitcnt vmcnt(0)
    v_mfma_f32_32x32x16_bf16 v[184:199], v[8:11], v[36:39], 0
    s_setprio 0
    s_nop 4
    v_max3_f32 v4, v136, v137, v138
    v_max3_f32 v5, v144, v145, v146
    v_max3_f32 v6, v139, v140, v141
    v_max3_f32 v7, v147, v148, v149
    v_max3_f32 v4, v4, v142, v143
    v_max3_f32 v5, v5, v150, v151
    v_max_f32 v4, v4, v6
    v_max_f32 v5, v5, v7
    s_nop 1
    v_permlane32_swap_b32 v4, v5
    v_max_f32 v4, v4, v5
    v_mov_b32 v5, v4
    s_nop 1
    v_permlane32_swap_b32 v4, v5
    v_sub_f32 v136, v136, v4
    v_sub_f32 v137, v137, v4
    v_sub_f32 v138, v138, v4
    v_sub_f32 v139, v139, v4
    v_sub_f32 v140, v140, v4
    v_sub_f32 v141, v141, v4
    v_sub_f32 v142, v142, v4
    v_sub_f32 v143, v143, v4
    v_sub_f32 v144, v144, v5
    v_sub_f32 v145, v145, v5
    v_sub_f32 v146, v146, v5
    v_sub_f32 v147, v147, v5
    v_sub_f32 v148, v148, v5
    v_sub_f32 v149, v149, v5
    v_sub_f32 v150, v150, v5
    v_sub_f32 v151, v151, v5
    v_exp_f32 v136, v136
    v_exp_f32 v137, v137
    v_exp_f32 v138, v138
    v_exp_f32 v139, v139
    v_cvt_pk_bf16_f32 v56, v136, v137
    v_exp_f32 v140, v140
    v_exp_f32 v141, v141
    v_cvt_pk_bf16_f32 v57, v138, v139
    v_exp_f32 v142, v142
    v_exp_f32 v143, v143
    v_cvt_pk_bf16_f32 v58, v140, v141
    v_exp_f32 v144, v144
    v_exp_f32 v145, v145
    v_cvt_pk_bf16_f32 v59, v142, v143
    v_exp_f32 v146, v146
    v_exp_f32 v147, v147
    v_cvt_pk_bf16_f32 v60, v144, v145
    v_exp_f32 v148, v148
    v_exp_f32 v149, v149
    v_cvt_pk_bf16_f32 v61, v146, v147
    v_exp_f32 v150, v150
    v_exp_f32 v151, v151
    v_cvt_pk_bf16_f32 v62, v148, v149
    v_cvt_pk_bf16_f32 v63, v150, v151
    v_max3_f32 v4, v152, v153, v154
    v_max3_f32 v5, v160, v161, v162
    v_max3_f32 v6, v155, v156, v157
    v_max3_f32 v7, v163, v164, v165
    v_max3_f32 v4, v4, v158, v159
    v_max3_f32 v5, v5, v166, v167
    s_waitcnt lgkmcnt(0)
    s_barrier
    v_max_f32 v4, v4, v6
    v_max_f32 v5, v5, v7
    s_nop 1
    v_permlane32_swap_b32 v4, v5
    v_max_f32 v4, v4, v5
    v_mov_b32 v5, v4
    s_nop 1
    v_permlane32_swap_b32 v4, v5
    v_sub_f32 v152, v152, v4
    v_sub_f32 v153, v153, v4
    v_sub_f32 v154, v154, v4
    v_sub_f32 v155, v155, v4
    v_sub_f32 v156, v156, v4
    v_sub_f32 v157, v157, v4
    v_sub_f32 v158, v158, v4
    v_sub_f32 v159, v159, v4
    v_sub_f32 v160, v160, v5
    v_sub_f32 v161, v161, v5
    v_sub_f32 v162, v162, v5
    v_sub_f32 v163, v163, v5
    v_sub_f32 v164, v164, v5
    v_sub_f32 v165, v165, v5
    v_sub_f32 v166, v166, v5
    v_sub_f32 v167, v167, v5
    v_exp_f32 v152, v152
    v_exp_f32 v153, v153
    v_exp_f32 v154, v154
    v_exp_f32 v155, v155
    v_cvt_pk_bf16_f32 v64, v152, v153
    v_exp_f32 v156, v156
    v_exp_f32 v157, v157
    v_cvt_pk_bf16_f32 v65, v154, v155
    v_exp_f32 v158, v158
    v_exp_f32 v159, v159
    v_cvt_pk_bf16_f32 v66, v156, v157
    v_exp_f32 v160, v160
    v_exp_f32 v161, v161
    v_cvt_pk_bf16_f32 v67, v158, v159
    v_exp_f32 v162, v162
    v_exp_f32 v163, v163
    v_cvt_pk_bf16_f32 v68, v160, v161
    v_exp_f32 v164, v164
    v_exp_f32 v165, v165
    v_cvt_pk_bf16_f32 v69, v162, v163
    v_exp_f32 v166, v166
    v_exp_f32 v167, v167
    v_cvt_pk_bf16_f32 v70, v164, v165
    v_cvt_pk_bf16_f32 v71, v166, v167
    s_load_dwordx16 s[28:43], s[4:5], 0 glc
    v_max3_f32 v4, v168, v169, v170
    v_max3_f32 v5, v176, v177, v178
    v_max3_f32 v6, v171, v172, v173
    v_max3_f32 v7, v179, v180, v181
    v_max3_f32 v4, v4, v174, v175
    v_max3_f32 v5, v5, v182, v183
    v_max_f32 v4, v4, v6
    v_max_f32 v5, v5, v7
    s_nop 1
    v_permlane32_swap_b32 v4, v5
    v_max_f32 v4, v4, v5
    v_mov_b32 v5, v4
    s_nop 1
    v_permlane32_swap_b32 v4, v5
    v_sub_f32 v168, v168, v4
    v_sub_f32 v169, v169, v4
    v_sub_f32 v170, v170, v4
    v_sub_f32 v171, v171, v4
    v_sub_f32 v172, v172, v4
    v_sub_f32 v173, v173, v4
    v_sub_f32 v174, v174, v4
    v_sub_f32 v175, v175, v4
    v_sub_f32 v176, v176, v5
    v_sub_f32 v177, v177, v5
    v_sub_f32 v178, v178, v5
    v_sub_f32 v179, v179, v5
    v_sub_f32 v180, v180, v5
    v_sub_f32 v181, v181, v5
    v_sub_f32 v182, v182, v5
    v_sub_f32 v183, v183, v5
    v_exp_f32 v168, v168
    v_exp_f32 v169, v169
    v_exp_f32 v170, v170
    v_exp_f32 v171, v171
    v_cvt_pk_bf16_f32 v200, v168, v169
    v_exp_f32 v172, v172
    v_exp_f32 v173, v173
    v_cvt_pk_bf16_f32 v201, v170, v171
    v_exp_f32 v174, v174
    v_exp_f32 v175, v175
    v_cvt_pk_bf16_f32 v202, v172, v173
    v_exp_f32 v176, v176
    v_exp_f32 v177, v177
    v_cvt_pk_bf16_f32 v203, v174, v175
    v_exp_f32 v178, v178
    v_exp_f32 v179, v179
    v_cvt_pk_bf16_f32 v204, v176, v177
    v_exp_f32 v180, v180
    v_exp_f32 v181, v181
    v_cvt_pk_bf16_f32 v205, v178, v179
    v_exp_f32 v182, v182
    v_exp_f32 v183, v183
    v_cvt_pk_bf16_f32 v206, v180, v181
    v_cvt_pk_bf16_f32 v207, v182, v183
    s_waitcnt lgkmcnt(0)
    s_xor_b64 s[6:7], s[28:29], s[62:63]
    s_xor_b64 s[76:77], s[30:31], s[62:63]
    s_or_b64 s[6:7], s[6:7], s[76:77]
    s_xor_b64 s[76:77], s[32:33], s[62:63]
    s_or_b64 s[6:7], s[6:7], s[76:77]
    s_xor_b64 s[76:77], s[34:35], s[62:63]
    s_or_b64 s[6:7], s[6:7], s[76:77]
    s_xor_b64 s[76:77], s[36:37], s[62:63]
    s_or_b64 s[6:7], s[6:7], s[76:77]
    s_xor_b64 s[76:77], s[38:39], s[62:63]
    s_or_b64 s[6:7], s[6:7], s[76:77]
    s_xor_b64 s[76:77], s[40:41], s[62:63]
    s_or_b64 s[6:7], s[6:7], s[76:77]
    s_xor_b64 s[76:77], s[42:43], s[62:63]
    s_or_b64 s[6:7], s[6:7], s[76:77]
    s_cmp_eq_u64 s[6:7], 0
    s_cbranch_scc1 L_pollkv_x
    s_mov_b32 s75, 0
L_pollkv:
    s_sleep 2
    s_load_dwordx16 s[28:43], s[4:5], 0 glc
    s_add_u32 s75, s75, 1
    s_cmp_gt_u32 s75, 1048576
    s_cbranch_scc1 L_pollkv_y
    s_waitcnt lgkmcnt(0)
    s_xor_b64 s[6:7], s[28:29], s[62:63]
    s_xor_b64 s[76:77], s[30:31], s[62:63]
    s_or_b64 s[6:7], s[6:7], s[76:77]
    s_xor_b64 s[76:77], s[32:33], s[62:63]
    s_or_b64 s[6:7], s[6:7], s[76:77]
    s_xor_b64 s[76:77], s[34:35], s[62:63]
    s_or_b64 s[6:7], s[6:7], s[76:77]
    s_xor_b64 s[76:77], s[36:37], s[62:63]
    s_or_b64 s[6:7], s[6:7], s[76:77]
    s_xor_b64 s[76:77], s[38:39], s[62:63]
    s_or_b64 s[6:7], s[6:7], s[76:77]
    s_xor_b64 s[76:77], s[40:41], s[62:63]
    s_or_b64 s[6:7], s[6:7], s[76:77]
    s_xor_b64 s[76:77], s[42:43], s[62:63]
    s_or_b64 s[6:7], s[6:7], s[76:77]
    s_cmp_eq_u64 s[6:7], 0
    s_cbranch_scc0 L_pollkv
L_pollkv_y:
    s_waitcnt lgkmcnt(0)
L_pollkv_x:
    buffer_load_dword v40, v235, s[20:23], s78 offen offset:0 sc1
    buffer_load_dword v41, v235, s[20:23], s78 offen offset:256 sc1
    buffer_load_dword v42, v235, s[20:23], s78 offen offset:512 sc1
    buffer_load_dword v43, v235, s[20:23], s78 offen offset:768 sc1
    buffer_load_dword v44, v235, s[20:23], s78 offen offset:1024 sc1
    buffer_load_dword v45, v235, s[20:23], s78 offen offset:1280 sc1
    buffer_load_dword v46, v235, s[20:23], s78 offen offset:1536 sc1
    buffer_load_dword v47, v235, s[20:23], s78 offen offset:1792 sc1
    buffer_load_dword v48, v235, s[20:23], s78 offen offset:2048 sc1
    buffer_load_dword v49, v235, s[20:23], s78 offen offset:2304 sc1
    buffer_load_dword v50, v235, s[20:23], s78 offen offset:2560 sc1
    buffer_load_dword v51, v235, s[20:23], s78 offen offset:2816 sc1
    buffer_load_dword v52, v235, s[20:23], s78 offen offset:3072 sc1
    buffer_load_dword v53, v235, s[20:23], s78 offen offset:3328 sc1
    buffer_load_dword v54, v235, s[20:23], s78 offen offset:3584 sc1
    buffer_load_dword v55, v235, s[20:23], s78 offen offset:3840 sc1
    v_max3_f32 v4, v184, v185, v186
    v_max3_f32 v5, v192, v193, v194
    v_max3_f32 v6, v187, v188, v189
    v_max3_f32 v7, v195, v196, v197
    v_max3_f32 v4, v4, v190, v191
    v_max3_f32 v5, v5, v198, v199
    v_max_f32 v4, v4, v6
    v_max_f32 v5, v5, v7
    s_nop 1
    v_permlane32_swap_b32 v4, v5
    v_max_f32 v4, v4, v5
    v_mov_b32 v5, v4
    s_nop 1
    v_permlane32_swap_b32 v4, v5
    v_sub_f32 v184, v184, v4
    v_sub_f32 v185, v185, v4
    v_sub_f32 v186, v186, v4
    v_sub_f32 v187, v187, v4
    v_sub_f32 v188, v188, v4
    v_sub_f32 v189, v189, v4
    v_sub_f32 v190, v190, v4
    v_sub_f32 v191, v191, v4
    v_sub_f32 v192, v192, v5
    v_sub_f32 v193, v193, v5
    v_sub_f32 v194, v194, v5
    v_sub_f32 v195, v195, v5
    v_sub_f32 v196, v196, v5
    v_sub_f32 v197, v197, v5
    v_sub_f32 v198, v198, v5
    v_sub_f32 v199, v199, v5
    v_exp_f32 v184, v184
    v_exp_f32 v185, v185
    v_exp_f32 v186, v186
    v_exp_f32 v187, v187
    v_cvt_pk_bf16_f32 v208, v184, v185
    v_exp_f32 v188, v188
    v_exp_f32 v189, v189
    v_cvt_pk_bf16_f32 v209, v186, v187
    v_exp_f32 v190, v190
    v_exp_f32 v191, v191
    v_cvt_pk_bf16_f32 v210, v188, v189
    v_exp_f32 v192, v192
    v_exp_f32 v193, v193
    v_cvt_pk_bf16_f32 v211, v190, v191
    v_exp_f32 v194, v194
    v_exp_f32 v195, v195
    v_cvt_pk_bf16_f32 v212, v192, v193
    v_exp_f32 v196, v196
    v_exp_f32 v197, v197
    v_cvt_pk_bf16_f32 v213, v194, v195
    v_exp_f32 v198, v198
    v_exp_f32 v199, v199
    v_cvt_pk_bf16_f32 v214, v196, v197
    v_cvt_pk_bf16_f32 v215, v198, v199
    s_waitcnt vmcnt(0) lgkmcnt(0)
    v_and_b32 v4, 27, v1
    v_cmp_eq_u32 vcc, 17, v4
    v_mov_b32 v4, 0x3f803f80
    v_cvt_pk_bf16_f32 v40, v40, v41
    v_cvt_pk_bf16_f32 v41, v42, v43
    v_cvt_pk_bf16_f32 v42, v44, v45
    v_cvt_pk_bf16_f32 v43, v46, v47
    v_cvt_pk_bf16_f32 v44, v48, v49
    v_cvt_pk_bf16_f32 v45, v50, v51
    v_cvt_pk_bf16_f32 v46, v52, v53
    v_cvt_pk_bf16_f32 v47, v54, v55
    v_cndmask_b32 v40, v40, v4, vcc
    v_cndmask_b32 v41, v41, v4, vcc
    v_cndmask_b32 v42, v42, v4, vcc
    v_cndmask_b32 v43, v43, v4, vcc
    v_cndmask_b32 v44, v44, v4, vcc
    v_cndmask_b32 v45, v45, v4, vcc
    v_cndmask_b32 v46, v46, v4, vcc
    v_cndmask_b32 v47, v47, v4, vcc
    v_mov_b32 v3, v238
    v_mov_b32 v248, v16
    v_mov_b32 v249, v18
    s_setprio 3
    v_mfma_f32_32x32x16_bf16 v[136:151], v[40:43], v[56:59], 0
    v_mfma_f32_32x32x16_bf16 v[152:167], v[44:47], v[60:63], 0
    v_mfma_f32_32x32x16_bf16 v[168:183], v[40:43], v[64:67], 0
    v_mfma_f32_32x32x16_bf16 v[184:199], v[44:47], v[68:71], 0
    v_mfma_f32_32x32x16_bf16 v[24:39], v[40:43], v[200:203], 0
    v_mfma_f32_32x32x16_bf16 v[8:23], v[44:47], v[204:207], 0
    v_mfma_f32_32x32x16_bf16 v[216:231], v[40:43], v[208:211], 0
    v_mfma_f32_32x32x16_bf16 v[232:247], v[44:47], v[212:215], 0
    s_lshl_b32 s6, s49, 2
    s_mul_i32 s6, s6, 144
    s_add_u32 s6, s6, s67
    s_add_u32 s6, s6, 112
    s_lshl_b32 s79, s6, 10
    s_setprio 0
    v_mov_b32 v4, 0x358637bd
    v_rcp_f32 v145, v145
    v_rcp_f32 v161, v161
    v_fma_f32 v144, v144, v145, v4
    v_fma_f32 v144, v160, v161, v144
    v_rcp_f32 v144, v144
    s_nop 0
    v_mul_f32 v145, v145, v144
    v_mul_f32 v161, v161, v144
    v_mul_f32 v136, v136, v145
    v_mul_f32 v137, v137, v145
    v_mul_f32 v138, v138, v145
    v_mul_f32 v139, v139, v145
    v_mul_f32 v140, v140, v145
    v_mul_f32 v141, v141, v145
    v_mul_f32 v142, v142, v145
    v_mul_f32 v143, v143, v145
    v_fma_f32 v136, v152, v161, v136
    v_fma_f32 v137, v153, v161, v137
    v_fma_f32 v138, v154, v161, v138
    v_fma_f32 v139, v155, v161, v139
    v_fma_f32 v140, v156, v161, v140
    v_fma_f32 v141, v157, v161, v141
    v_fma_f32 v142, v158, v161, v142
    v_fma_f32 v143, v159, v161, v143
    v_cvt_pk_bf16_f32 v148, v136, v137
    v_cvt_pk_bf16_f32 v149, v138, v139
    v_cvt_pk_bf16_f32 v150, v140, v141
    v_cvt_pk_bf16_f32 v151, v142, v143
    s_setprio 3
    buffer_store_dwordx4 v[148:151], v3, s[20:23], s79 offen sc1
    s_add_u32 s79, s79, 147456
    s_setprio 0
    v_rcp_f32 v177, v177
    v_rcp_f32 v193, v193
    v_fma_f32 v176, v176, v177, v4
    v_fma_f32 v176, v192, v193, v176
    v_rcp_f32 v176, v176
    s_nop 0
    v_mul_f32 v177, v177, v176
    v_mul_f32 v193, v193, v176
    v_mul_f32 v168, v168, v177
    v_mul_f32 v169, v169, v177
    v_mul_f32 v170, v170, v177
    v_mul_f32 v171, v171, v177
    v_mul_f32 v172, v172, v177
    v_mul_f32 v173, v173, v177
    v_mul_f32 v174, v174, v177
    v_mul_f32 v175, v175, v177
    v_fma_f32 v168, v184, v193, v168
    v_fma_f32 v169, v185, v193, v169
    v_fma_f32 v170, v186, v193, v170
    v_fma_f32 v171, v187, v193, v171
    v_fma_f32 v172, v188, v193, v172
    v_fma_f32 v173, v189, v193, v173
    v_fma_f32 v174, v190, v193, v174
    v_fma_f32 v175, v191, v193, v175
    v_cvt_pk_bf16_f32 v180, v168, v169
    v_cvt_pk_bf16_f32 v181, v170, v171
    v_cvt_pk_bf16_f32 v182, v172, v173
    v_cvt_pk_bf16_f32 v183, v174, v175
    s_setprio 3
    buffer_store_dwordx4 v[180:183], v3, s[20:23], s79 offen sc1
    s_add_u32 s79, s79, 147456
    s_setprio 0
    v_rcp_f32 v33, v33
    v_rcp_f32 v17, v17
    v_fma_f32 v32, v32, v33, v4
    v_fma_f32 v32, v16, v17, v32
    v_rcp_f32 v32, v32
    s_nop 0
    v_mul_f32 v33, v33, v32
    v_mul_f32 v17, v17, v32
    v_mul_f32 v24, v24, v33
    v_mul_f32 v25, v25, v33
    v_mul_f32 v26, v26, v33
    v_mul_f32 v27, v27, v33
    v_mul_f32 v28, v28, v33
    v_mul_f32 v29, v29, v33
    v_mul_f32 v30, v30, v33
    v_mul_f32 v31, v31, v33
    v_fma_f32 v24, v8, v17, v24
    v_fma_f32 v25, v9, v17, v25
    v_fma_f32 v26, v10, v17, v26
    v_fma_f32 v27, v11, v17, v27
    v_fma_f32 v28, v12, v17, v28
    v_fma_f32 v29, v13, v17, v29
    v_fma_f32 v30, v14, v17, v30
    v_fma_f32 v31, v15, v17, v31
    v_cvt_pk_bf16_f32 v36, v24, v25
    v_cvt_pk_bf16_f32 v37, v26, v27
    v_cvt_pk_bf16_f32 v38, v28, v29
    v_cvt_pk_bf16_f32 v39, v30, v31
    s_setprio 3
    buffer_store_dwordx4 v[36:39], v3, s[20:23], s79 offen sc1
    s_add_u32 s79, s79, 147456
    s_setprio 0
    v_rcp_f32 v225, v225
    v_rcp_f32 v241, v241
    v_fma_f32 v224, v224, v225, v4
    v_fma_f32 v224, v240, v241, v224
    v_rcp_f32 v224, v224
    s_nop 0
    v_mul_f32 v225, v225, v224
    v_mul_f32 v241, v241, v224
    v_mul_f32 v216, v216, v225
    v_mul_f32 v217, v217, v225
    v_mul_f32 v218, v218, v225
    v_mul_f32 v219, v219, v225
    v_mul_f32 v220, v220, v225
    v_mul_f32 v221, v221, v225
    v_mul_f32 v222, v222, v225
    v_mul_f32 v223, v223, v225
    v_fma_f32 v216, v232, v241, v216
    v_fma_f32 v217, v233, v241, v217
    v_fma_f32 v218, v234, v241, v218
    v_fma_f32 v219, v235, v241, v219
    v_fma_f32 v220, v236, v241, v220
    v_fma_f32 v221, v237, v241, v221
    v_fma_f32 v222, v238, v241, v222
    v_fma_f32 v223, v239, v241, v223
    v_cvt_pk_bf16_f32 v228, v216, v217
    v_cvt_pk_bf16_f32 v229, v218, v219
    v_cvt_pk_bf16_f32 v230, v220, v221
    v_cvt_pk_bf16_f32 v231, v222, v223
    s_setprio 3
    buffer_store_dwordx4 v[228:231], v3, s[20:23], s79 offen sc1
    s_waitcnt vmcnt(0)
    s_mov_b64 exec, 1
    buffer_store_dword v248, v249, s[20:23], 0 offen sc1
    s_mov_b64 exec, -1
    s_branch L_BHY
L_BHY:
    s_setprio 0
    v_lshlrev_b32 v3, 4, v1
    v_lshrrev_b32 v7, 5, v1
    v_bfe_u32 v6, v1, 2, 2
    v_lshl_add_u32 v6, v7, 3, v6
    v_lshlrev_b32 v6, 7, v6
    v_bfe_u32 v7, v1, 3, 1
    v_lshl_add_u32 v6, v7, 6, v6
    v_bfe_u32 v7, v1, 4, 1
    v_lshl_add_u32 v6, v7, 5, v6
    v_and_b32 v7, 3, v1
    v_lshl_add_u32 v6, v7, 3, v6
    v_add_u32 v6, s81, v6
    v_xor_b32 v5, 64, v6
    s_lshr_b32 s6, s52, 1
    s_lshl_b32 s6, s6, 7
    s_and_b32 s78, s48, 1
    s_lshl_b32 s7, s78, 6
    s_add_u32 s6, s6, s7
    s_add_u32 s6, s6, 11816960
    s_lshl_b32 s7, s52, 8
    s_lshl_b32 s78, s78, 4
    s_add_u32 s7, s7, s78
    s_add_u32 s7, s7, 11800576
    s_cmp_ge_u32 s48, 6
    s_cselect_b32 s6, s6, s7
    s_add_u32 s4, s20, s6
    s_addc_u32 s5, s21, 0
    v_lshrrev_b32 v8, 3, v1
    v_and_b32 v7, 7, v1
    v_lshlrev_b32 v7, 4, v7
    v_lshl_add_u32 v7, v8, 10, v7
    buffer_load_dwordx4 v[248:251], v7, s[8:11], s84 offen
    s_waitcnt lgkmcnt(0)
    s_cmp_ge_u32 s48, 6
    s_cbranch_scc1 L_BHY_o0
    s_load_dwordx4 s[28:31], s[4:5], 0 glc
    s_load_dwordx4 s[32:35], s[4:5], 128 glc
    s_waitcnt lgkmcnt(0)
    s_xor_b64 s[6:7], s[28:29], s[62:63]
    s_xor_b64 s[76:77], s[32:33], s[62:63]
    s_or_b64 s[6:7], s[6:7], s[76:77]
    s_cmp_eq_u64 s[6:7], 0
    s_cbranch_scc1 L_BHY_ph0_x
    s_mov_b32 s75, 0
L_BHY_ph0:
    s_sleep 2
    s_load_dwordx4 s[28:31], s[4:5], 0 glc
    s_load_dwordx4 s[32:35], s[4:5], 128 glc
    s_add_u32 s75, s75, 1
    s_cmp_gt_u32 s75, 1048576
    s_cbranch_scc1 L_BHY_ph0_y
    s_waitcnt lgkmcnt(0)
    s_xor_b64 s[6:7], s[28:29], s[62:63]
    s_xor_b64 s[76:77], s[32:33], s[62:63]
    s_or_b64 s[6:7], s[6:7], s[76:77]
    s_cmp_eq_u64 s[6:7], 0
    s_cbranch_scc0 L_BHY_ph0
L_BHY_ph0_y:
    s_waitcnt lgkmcnt(0)
L_BHY_ph0_x:
    s_branch L_BHY_go0
L_BHY_o0:
    s_load_dwordx16 s[28:43], s[4:5], 0 glc
    s_waitcnt lgkmcnt(0)
    s_xor_b64 s[6:7], s[28:29], s[62:63]
    s_xor_b64 s[76:77], s[30:31], s[62:63]
    s_or_b64 s[6:7], s[6:7], s[76:77]
    s_xor_b64 s[76:77], s[32:33], s[62:63]
    s_or_b64 s[6:7], s[6:7], s[76:77]
    s_xor_b64 s[76:77], s[34:35], s[62:63]
    s_or_b64 s[6:7], s[6:7], s[76:77]
    s_cmp_eq_u64 s[6:7], 0
    s_cbranch_scc1 L_BHY_po0_x
    s_mov_b32 s75, 0
L_BHY_po0:
    s_sleep 2
    s_load_dwordx16 s[28:43], s[4:5], 0 glc
    s_add_u32 s75, s75, 1
    s_cmp_gt_u32 s75, 1048576
    s_cbranch_scc1 L_BHY_po0_y
    s_waitcnt lgkmcnt(0)
    s_xor_b64 s[6:7], s[28:29], s[62:63]
    s_xor_b64 s[76:77], s[30:31], s[62:63]
    s_or_b64 s[6:7], s[6:7], s[76:77]
    s_xor_b64 s[76:77], s[32:33], s[62:63]
    s_or_b64 s[6:7], s[6:7], s[76:77]
    s_xor_b64 s[76:77], s[34:35], s[62:63]
    s_or_b64 s[6:7], s[6:7], s[76:77]
    s_cmp_eq_u64 s[6:7], 0
    s_cbranch_scc0 L_BHY_po0
L_BHY_po0_y:
    s_waitcnt lgkmcnt(0)
L_BHY_po0_x:
L_BHY_go0:
    buffer_load_dwordx4 v[136:139], v3, s[20:23], s82 offen offset:0 sc1
    buffer_load_dwordx4 v[140:143], v3, s[20:23], s83 offen offset:0 sc1
    buffer_load_dwordx4 v[144:147], v3, s[20:23], s82 offen offset:1024 sc1
    buffer_load_dwordx4 v[148:151], v3, s[20:23], s83 offen offset:1024 sc1
    buffer_load_dwordx4 v[152:155], v3, s[20:23], s82 offen offset:2048 sc1
    buffer_load_dwordx4 v[156:159], v3, s[20:23], s83 offen offset:2048 sc1
    buffer_load_dwordx4 v[160:163], v3, s[20:23], s82 offen offset:3072 sc1
    buffer_load_dwordx4 v[164:167], v3, s[20:23], s83 offen offset:3072 sc1
    s_waitcnt vmcnt(7)
    v_mfma_f32_32x32x16_bf16 v[8:23], v[72:75], v[136:139], 0
    s_waitcnt vmcnt(6)
    v_mfma_f32_32x32x16_bf16 v[24:39], v[72:75], v[140:143], 0
    v_mfma_f32_32x32x16_bf16 v[40:55], v[76:79], v[136:139], 0
    v_mfma_f32_32x32x16_bf16 v[56:71], v[76:79], v[140:143], 0
    s_add_u32 s82, s82, 4096
    s_add_u32 s83, s83, 4096
    buffer_load_dwordx4 v[168:171], v3, s[20:23], s82 offen offset:0 sc1
    buffer_load_dwordx4 v[172:175], v3, s[20:23], s83 offen offset:0 sc1
    buffer_load_dwordx4 v[176:179], v3, s[20:23], s82 offen offset:1024 sc1
    buffer_load_dwordx4 v[180:183], v3, s[20:23], s83 offen offset:1024 sc1
    s_add_u32 m0, s81, 0
    s_add_u32 s64, s80, 131072
    buffer_load_dwordx4 v252, s[16:19], s64 offen lds
    s_add_u32 m0, s81, 1024
    s_add_u32 s64, s80, 139264
    buffer_load_dwordx4 v252, s[16:19], s64 offen lds
    s_add_u32 m0, s81, 2048
    s_add_u32 s64, s80, 147456
    buffer_load_dwordx4 v252, s[16:19], s64 offen lds
    s_add_u32 m0, s81, 3072
    s_add_u32 s64, s80, 155648
    buffer_load_dwordx4 v252, s[16:19], s64 offen lds
    s_waitcnt vmcnt(13)
    v_mfma_f32_32x32x16_bf16 v[8:23], v[80:83], v[144:147], v[8:23]
    s_waitcnt vmcnt(12)
    v_mfma_f32_32x32x16_bf16 v[24:39], v[80:83], v[148:151], v[24:39]
    v_mfma_f32_32x32x16_bf16 v[40:55], v[84:87], v[144:147], v[40:55]
    v_mfma_f32_32x32x16_bf16 v[56:71], v[84:87], v[148:151], v[56:71]
    buffer_load_dwordx4 v[184:187], v3, s[20:23], s82 offen offset:2048 sc1
    buffer_load_dwordx4 v[188:191], v3, s[20:23], s83 offen offset:2048 sc1
    buffer_load_dwordx4 v[192:195], v3, s[20:23], s82 offen offset:3072 sc1
    buffer_load_dwordx4 v[196:199], v3, s[20:23], s83 offen offset:3072 sc1
    s_add_u32 m0, s81, 4096
    s_add_u32 s64, s80, 163840
    buffer_load_dwordx4 v252, s[16:19], s64 offen lds
    s_add_u32 m0, s81, 5120
    s_add_u32 s64, s80, 172032
    buffer_load_dwordx4 v252, s[16:19], s64 offen lds
    s_add_u32 m0, s81, 6144
    s_add_u32 s64, s80, 180224
    buffer_load_dwordx4 v252, s[16:19], s64 offen lds
    s_add_u32 m0, s81, 7168
    s_add_u32 s64, s80, 188416
    buffer_load_dwordx4 v252, s[16:19], s64 offen lds
    s_waitcnt vmcnt(19)
    v_mfma_f32_32x32x16_bf16 v[8:23], v[88:91], v[152:155], v[8:23]
    s_waitcnt vmcnt(18)
    v_mfma_f32_32x32x16_bf16 v[24:39], v[88:91], v[156:159], v[24:39]
    v_mfma_f32_32x32x16_bf16 v[40:55], v[92:95], v[152:155], v[40:55]
    v_mfma_f32_32x32x16_bf16 v[56:71], v[92:95], v[156:159], v[56:71]
    s_add_u32 m0, s81, 8192
    s_add_u32 s64, s80, 196608
    buffer_load_dwordx4 v252, s[16:19], s64 offen lds
    s_add_u32 m0, s81, 9216
    s_add_u32 s64, s80, 204800
    buffer_load_dwordx4 v252, s[16:19], s64 offen lds
    s_add_u32 m0, s81, 10240
    s_add_u32 s64, s80, 212992
    buffer_load_dwordx4 v252, s[16:19], s64 offen lds
    s_add_u32 m0, s81, 11264
    s_add_u32 s64, s80, 221184
    buffer_load_dwordx4 v252, s[16:19], s64 offen lds
    s_waitcnt vmcnt(21)
    v_mfma_f32_32x32x16_bf16 v[8:23], v[96:99], v[160:163], v[8:23]
    s_waitcnt vmcnt(20)
    v_mfma_f32_32x32x16_bf16 v[24:39], v[96:99], v[164:167], v[24:39]
    v_mfma_f32_32x32x16_bf16 v[40:55], v[100:103], v[160:163], v[40:55]
    v_mfma_f32_32x32x16_bf16 v[56:71], v[100:103], v[164:167], v[56:71]
    s_cmp_ge_u32 s48, 6
    s_cbranch_scc1 L_BHY_o1
    s_waitcnt lgkmcnt(0)
    s_xor_b64 s[6:7], s[30:31], s[62:63]
    s_xor_b64 s[76:77], s[34:35], s[62:63]
    s_or_b64 s[6:7], s[6:7], s[76:77]
    s_cmp_eq_u64 s[6:7], 0
    s_cbranch_scc1 L_BHY_ph1_x
    s_mov_b32 s75, 0
L_BHY_ph1:
    s_sleep 2
    s_load_dwordx4 s[28:31], s[4:5], 0 glc
    s_load_dwordx4 s[32:35], s[4:5], 128 glc
    s_add_u32 s75, s75, 1
    s_cmp_gt_u32 s75, 1048576
    s_cbranch_scc1 L_BHY_ph1_y
    s_waitcnt lgkmcnt(0)
    s_xor_b64 s[6:7], s[30:31], s[62:63]
    s_xor_b64 s[76:77], s[34:35], s[62:63]
    s_or_b64 s[6:7], s[6:7], s[76:77]
    s_cmp_eq_u64 s[6:7], 0
    s_cbranch_scc0 L_BHY_ph1
L_BHY_ph1_y:
    s_waitcnt lgkmcnt(0)
L_BHY_ph1_x:
    s_branch L_BHY_go1
L_BHY_o1:
    s_waitcnt lgkmcnt(0)
    s_xor_b64 s[6:7], s[36:37], s[62:63]
    s_xor_b64 s[76:77], s[38:39], s[62:63]
    s_or_b64 s[6:7], s[6:7], s[76:77]
    s_xor_b64 s[76:77], s[40:41], s[62:63]
    s_or_b64 s[6:7], s[6:7], s[76:77]
    s_xor_b64 s[76:77], s[42:43], s[62:63]
    s_or_b64 s[6:7], s[6:7], s[76:77]
    s_cmp_eq_u64 s[6:7], 0
    s_cbranch_scc1 L_BHY_po1_x
    s_mov_b32 s75, 0
L_BHY_po1:
    s_sleep 2
    s_load_dwordx16 s[28:43], s[4:5], 0 glc
    s_add_u32 s75, s75, 1
    s_cmp_gt_u32 s75, 1048576
    s_cbranch_scc1 L_BHY_po1_y
    s_waitcnt lgkmcnt(0)
    s_xor_b64 s[6:7], s[36:37], s[62:63]
    s_xor_b64 s[76:77], s[38:39], s[62:63]
    s_or_b64 s[6:7], s[6:7], s[76:77]
    s_xor_b64 s[76:77], s[40:41], s[62:63]
    s_or_b64 s[6:7], s[6:7], s[76:77]
    s_xor_b64 s[76:77], s[42:43], s[62:63]
    s_or_b64 s[6:7], s[6:7], s[76:77]
    s_cmp_eq_u64 s[6:7], 0
    s_cbranch_scc0 L_BHY_po1
L_BHY_po1_y:
    s_waitcnt lgkmcnt(0)
L_BHY_po1_x:
L_BHY_go1:
    s_add_u32 s82, s82, 4096
    s_add_u32 s83, s83, 4096
    buffer_load_dwordx4 v[200:203], v3, s[20:23], s82 offen offset:0 sc1
    buffer_load_dwordx4 v[204:207], v3, s[20:23], s83 offen offset:0 sc1
    buffer_load_dwordx4 v[208:211], v3, s[20:23], s82 offen offset:1024 sc1
    buffer_load_dwordx4 v[212:215], v3, s[20:23], s83 offen offset:1024 sc1
    s_add_u32 m0, s81, 12288
    s_add_u32 s64, s80, 229376
    buffer_load_dwordx4 v252, s[16:19], s64 offen lds
    s_add_u32 m0, s81, 13312
    s_add_u32 s64, s80, 237568
    buffer_load_dwordx4 v252, s[16:19], s64 offen lds
    s_add_u32 m0, s81, 14336
    s_add_u32 s64, s80, 245760
    buffer_load_dwordx4 v252, s[16:19], s64 offen lds
    s_add_u32 m0, s81, 15360
    s_add_u32 s64, s80, 253952
    buffer_load_dwordx4 v252, s[16:19], s64 offen lds
    s_waitcnt vmcnt(27)
    v_mfma_f32_32x32x16_bf16 v[8:23], v[104:107], v[168:171], v[8:23]
    s_waitcnt vmcnt(26)
    v_mfma_f32_32x32x16_bf16 v[24:39], v[104:107], v[172:175], v[24:39]
    v_mfma_f32_32x32x16_bf16 v[40:55], v[108:111], v[168:171], v[40:55]
    v_mfma_f32_32x32x16_bf16 v[56:71], v[108:111], v[172:175], v[56:71]
    buffer_load_dwordx4 v[216:219], v3, s[20:23], s82 offen offset:2048 sc1
    buffer_load_dwordx4 v[220:223], v3, s[20:23], s83 offen offset:2048 sc1
    buffer_load_dwordx4 v[224:227], v3, s[20:23], s82 offen offset:3072 sc1
    buffer_load_dwordx4 v[228:231], v3, s[20:23], s83 offen offset:3072 sc1
    s_waitcnt vmcnt(29)
    v_mfma_f32_32x32x16_bf16 v[8:23], v[112:115], v[176:179], v[8:23]
    s_waitcnt vmcnt(28)
    v_mfma_f32_32x32x16_bf16 v[24:39], v[112:115], v[180:183], v[24:39]
    v_mfma_f32_32x32x16_bf16 v[40:55], v[116:119], v[176:179], v[40:55]
    v_mfma_f32_32x32x16_bf16 v[56:71], v[116:119], v[180:183], v[56:71]
    s_add_u32 s82, s82, 4096
    s_add_u32 s83, s83, 4096
    buffer_load_dwordx4 v[72:75], v3, s[20:23], s82 offen offset:0 sc1
    buffer_load_dwordx4 v[76:79], v3, s[20:23], s83 offen offset:0 sc1
    buffer_load_dwordx4 v[80:83], v3, s[20:23], s82 offen offset:1024 sc1
    buffer_load_dwordx4 v[84:87], v3, s[20:23], s83 offen offset:1024 sc1
    s_waitcnt vmcnt(27)
    v_mfma_f32_32x32x16_bf16 v[8:23], v[120:123], v[184:187], v[8:23]
    s_waitcnt vmcnt(26)
    v_mfma_f32_32x32x16_bf16 v[24:39], v[120:123], v[188:191], v[24:39]
    v_mfma_f32_32x32x16_bf16 v[40:55], v[124:127], v[184:187], v[40:55]
    v_mfma_f32_32x32x16_bf16 v[56:71], v[124:127], v[188:191], v[56:71]
    buffer_load_dwordx4 v[88:91], v3, s[20:23], s82 offen offset:2048 sc1
    buffer_load_dwordx4 v[92:95], v3, s[20:23], s83 offen offset:2048 sc1
    buffer_load_dwordx4 v[96:99], v3, s[20:23], s82 offen offset:3072 sc1
    buffer_load_dwordx4 v[100:103], v3, s[20:23], s83 offen offset:3072 sc1
    ds_read_b64_tr_b16 v[232:233], v6 offset:0
    ds_read_b64_tr_b16 v[234:235], v6 offset:512
    ds_read_b64_tr_b16 v[236:237], v5 offset:0
    ds_read_b64_tr_b16 v[238:239], v5 offset:512
    s_waitcnt vmcnt(29)
    v_mfma_f32_32x32x16_bf16 v[8:23], v[128:131], v[192:195], v[8:23]
    s_waitcnt vmcnt(28)
    v_mfma_f32_32x32x16_bf16 v[24:39], v[128:131], v[196:199], v[24:39]
    v_mfma_f32_32x32x16_bf16 v[40:55], v[132:135], v[192:195], v[40:55]
    v_mfma_f32_32x32x16_bf16 v[56:71], v[132:135], v[196:199], v[56:71]
    ds_read_b64_tr_b16 v[240:241], v6 offset:2048
    ds_read_b64_tr_b16 v[242:243], v6 offset:2560
    ds_read_b64_tr_b16 v[244:245], v5 offset:2048
    ds_read_b64_tr_b16 v[246:247], v5 offset:2560
    s_waitcnt vmcnt(19) lgkmcnt(6)
    v_mfma_f32_32x32x16_bf16 v[8:23], v[232:235], v[200:203], v[8:23]
    s_waitcnt vmcnt(18)
    v_mfma_f32_32x32x16_bf16 v[24:39], v[232:235], v[204:207], v[24:39]
    s_waitcnt lgkmcnt(4)
    v_mfma_f32_32x32x16_bf16 v[40:55], v[236:239], v[200:203], v[40:55]
    v_mfma_f32_32x32x16_bf16 v[56:71], v[236:239], v[204:207], v[56:71]
    ds_read_b64_tr_b16 v[232:233], v6 offset:4096
    ds_read_b64_tr_b16 v[234:235], v6 offset:4608
    ds_read_b64_tr_b16 v[236:237], v5 offset:4096
    ds_read_b64_tr_b16 v[238:239], v5 offset:4608
    s_waitcnt vmcnt(17) lgkmcnt(6)
    v_mfma_f32_32x32x16_bf16 v[8:23], v[240:243], v[208:211], v[8:23]
    s_waitcnt vmcnt(16)
    v_mfma_f32_32x32x16_bf16 v[24:39], v[240:243], v[212:215], v[24:39]
    s_waitcnt lgkmcnt(4)
    v_mfma_f32_32x32x16_bf16 v[40:55], v[244:247], v[208:211], v[40:55]
    v_mfma_f32_32x32x16_bf16 v[56:71], v[244:247], v[212:215], v[56:71]
    ds_read_b64_tr_b16 v[240:241], v6 offset:6144
    ds_read_b64_tr_b16 v[242:243], v6 offset:6656
    ds_read_b64_tr_b16 v[244:245], v5 offset:6144
    ds_read_b64_tr_b16 v[246:247], v5 offset:6656
    s_waitcnt vmcnt(11) lgkmcnt(6)
    v_mfma_f32_32x32x16_bf16 v[8:23], v[232:235], v[216:219], v[8:23]
    s_waitcnt vmcnt(10)
    v_mfma_f32_32x32x16_bf16 v[24:39], v[232:235], v[220:223], v[24:39]
    s_waitcnt lgkmcnt(4)
    v_mfma_f32_32x32x16_bf16 v[40:55], v[236:239], v[216:219], v[40:55]
    v_mfma_f32_32x32x16_bf16 v[56:71], v[236:239], v[220:223], v[56:71]
    ds_read_b64_tr_b16 v[232:233], v6 offset:8192
    ds_read_b64_tr_b16 v[234:235], v6 offset:8704
    ds_read_b64_tr_b16 v[236:237], v5 offset:8192
    ds_read_b64_tr_b16 v[238:239], v5 offset:8704
    s_waitcnt vmcnt(9) lgkmcnt(6)
    v_mfma_f32_32x32x16_bf16 v[8:23], v[240:243], v[224:227], v[8:23]
    s_waitcnt vmcnt(8)
    v_mfma_f32_32x32x16_bf16 v[24:39], v[240:243], v[228:231], v[24:39]
    s_waitcnt lgkmcnt(4)
    v_mfma_f32_32x32x16_bf16 v[40:55], v[244:247], v[224:227], v[40:55]
    v_mfma_f32_32x32x16_bf16 v[56:71], v[244:247], v[228:231], v[56:71]
    ds_read_b64_tr_b16 v[240:241], v6 offset:10240
    ds_read_b64_tr_b16 v[242:243], v6 offset:10752
    ds_read_b64_tr_b16 v[244:245], v5 offset:10240
    ds_read_b64_tr_b16 v[246:247], v5 offset:10752
    s_waitcnt vmcnt(7) lgkmcnt(6)
    v_mfma_f32_32x32x16_bf16 v[8:23], v[232:235], v[72:75], v[8:23]
    s_waitcnt vmcnt(6)
    v_mfma_f32_32x32x16_bf16 v[24:39], v[232:235], v[76:79], v[24:39]
    s_waitcnt lgkmcnt(4)
    v_mfma_f32_32x32x16_bf16 v[40:55], v[236:239], v[72:75], v[40:55]
    v_mfma_f32_32x32x16_bf16 v[56:71], v[236:239], v[76:79], v[56:71]
    ds_read_b64_tr_b16 v[232:233], v6 offset:12288
    ds_read_b64_tr_b16 v[234:235], v6 offset:12800
    ds_read_b64_tr_b16 v[236:237], v5 offset:12288
    ds_read_b64_tr_b16 v[238:239], v5 offset:12800
    s_waitcnt vmcnt(5) lgkmcnt(6)
    v_mfma_f32_32x32x16_bf16 v[8:23], v[240:243], v[80:83], v[8:23]
    s_waitcnt vmcnt(4)
    v_mfma_f32_32x32x16_bf16 v[24:39], v[240:243], v[84:87], v[24:39]
    s_waitcnt lgkmcnt(4)
    v_mfma_f32_32x32x16_bf16 v[40:55], v[244:247], v[80:83], v[40:55]
    v_mfma_f32_32x32x16_bf16 v[56:71], v[244:247], v[84:87], v[56:71]
    ds_read_b64_tr_b16 v[240:241], v6 offset:14336
    ds_read_b64_tr_b16 v[242:243], v6 offset:14848
    ds_read_b64_tr_b16 v[244:245], v5 offset:14336
    ds_read_b64_tr_b16 v[246:247], v5 offset:14848
    s_waitcnt vmcnt(3) lgkmcnt(6)
    v_mfma_f32_32x32x16_bf16 v[8:23], v[232:235], v[88:91], v[8:23]
    s_waitcnt vmcnt(2)
    v_mfma_f32_32x32x16_bf16 v[24:39], v[232:235], v[92:95], v[24:39]
    s_waitcnt lgkmcnt(4)
    v_mfma_f32_32x32x16_bf16 v[40:55], v[236:239], v[88:91], v[40:55]
    v_mfma_f32_32x32x16_bf16 v[56:71], v[236:239], v[92:95], v[56:71]
    s_waitcnt vmcnt(1) lgkmcnt(2)
    v_mfma_f32_32x32x16_bf16 v[8:23], v[240:243], v[96:99], v[8:23]
    s_waitcnt vmcnt(0)
    v_mfma_f32_32x32x16_bf16 v[24:39], v[240:243], v[100:103], v[24:39]
    s_waitcnt lgkmcnt(0)
    v_mfma_f32_32x32x16_bf16 v[40:55], v[244:247], v[96:99], v[40:55]
    v_mfma_f32_32x32x16_bf16 v[56:71], v[244:247], v[100:103], v[56:71]
    v_and_b32 v4, 31, v1
    v_lshrrev_b32 v5, 5, v1
    v_and_b32 v6, 7, v1
    v_xor_b32 v6, v5, v6
    v_lshlrev_b32 v6, 4, v6
    v_lshl_add_u32 v6, v4, 8, v6
    v_add_u32 v72, s81, v6
    v_xor_b32 v73, 32, v72
    v_xor_b32 v74, 64, v72
    v_xor_b32 v75, 96, v72
    ds_write_b128 v72, v[8:11] offset:0
    ds_write_b128 v73, v[12:15] offset:0
    ds_write_b128 v74, v[16:19] offset:0
    ds_write_b128 v75, v[20:23] offset:0
    ds_write_b128 v72, v[24:27] offset:8192
    ds_write_b128 v73, v[28:31] offset:8192
    ds_write_b128 v74, v[32:35] offset:8192
    ds_write_b128 v75, v[36:39] offset:8192
    ds_write_b128 v72, v[40:43] offset:128
    ds_write_b128 v73, v[44:47] offset:128
    ds_write_b128 v74, v[48:51] offset:128
    ds_write_b128 v75, v[52:55] offset:128
    ds_write_b128 v72, v[56:59] offset:8320
    ds_write_b128 v73, v[60:63] offset:8320
    ds_write_b128 v74, v[64:67] offset:8320
    s_waitcnt lgkmcnt(8)
    ds_write_b128 v75, v[68:71] offset:8320
    s_waitcnt vmcnt(0)
    s_branch L_red
L_helpX:
    s_add_u32 m0, s97, 65536
    s_add_u32 s66, s96, 16384
    buffer_load_dwordx4 v10, s[8:11], s66 offen lds
    s_add_u32 m0, s97, 66560
    s_add_u32 s66, s96, 20480
    buffer_load_dwordx4 v11, s[8:11], s66 offen lds
    s_add_u32 m0, s97, 67584
    s_add_u32 s66, s96, 24576
    buffer_load_dwordx4 v12, s[8:11], s66 offen lds
    s_add_u32 m0, s97, 68608
    s_add_u32 s66, s96, 28672
    buffer_load_dwordx4 v13, s[8:11], s66 offen lds
    s_add_u32 m0, s97, 69632
    s_add_u32 s66, s96, 16640
    buffer_load_dwordx4 v10, s[8:11], s66 offen lds
    s_add_u32 m0, s97, 70656
    s_add_u32 s66, s96, 20736
    buffer_load_dwordx4 v11, s[8:11], s66 offen lds
    s_add_u32 m0, s97, 71680
    s_add_u32 s66, s96, 24832
    buffer_load_dwordx4 v12, s[8:11], s66 offen lds
    s_add_u32 m0, s97, 72704
    s_add_u32 s66, s96, 28928
    buffer_load_dwordx4 v13, s[8:11], s66 offen lds
    s_add_u32 m0, s97, 73728
    s_add_u32 s66, s96, 16896
    buffer_load_dwordx4 v10, s[8:11], s66 offen lds
    s_add_u32 m0, s97, 74752
    s_add_u32 s66, s96, 20992
    buffer_load_dwordx4 v11, s[8:11], s66 offen lds
    s_add_u32 m0, s97, 75776
    s_add_u32 s66, s96, 25088
    buffer_load_dwordx4 v12, s[8:11], s66 offen lds
    s_add_u32 m0, s97, 76800
    s_add_u32 s66, s96, 29184
    buffer_load_dwordx4 v13, s[8:11], s66 offen lds
    s_add_u32 m0, s97, 77824
    s_add_u32 s66, s96, 17152
    buffer_load_dwordx4 v10, s[8:11], s66 offen lds
    s_add_u32 m0, s97, 78848
    s_add_u32 s66, s96, 21248
    buffer_load_dwordx4 v11, s[8:11], s66 offen lds
    s_add_u32 m0, s97, 79872
    s_add_u32 s66, s96, 25344
    buffer_load_dwordx4 v12, s[8:11], s66 offen lds
    s_add_u32 m0, s97, 80896
    s_add_u32 s66, s96, 29440
    buffer_load_dwordx4 v13, s[8:11], s66 offen lds
    s_and_b32 s6, s49, 7
    s_lshl_b32 s6, s6, 6
    v_add_u32 v8, s6, v1
    v_mul_u32_u24 v9, 0xe00, v8
    v_mul_u32_u24 v8, 0xc00, v8
    s_lshl_b32 s6, s50, 7
    s_add_u32 s7, s71, 1
    s_cmp_eq_u32 s71, 2
    s_cselect_b32 s7, 0, s7
    s_lshl_b32 s7, s7, 10
    s_add_u32 s6, s6, s7
    s_lshl_b32 s7, s5, 1
    s_cmp_eq_u32 s71, 3
    s_cselect_b32 s6, 0x200000, s6
    s_cselect_b32 s7, s7, 0x200000
    s_cmp_ge_u32 s71, 2
    s_cselect_b32 s6, 0x200000, s6
    s_mov_b32 s7, 0x200000
    buffer_load_dword v253, v8, s[28:31], s6 offen
    s_cmp_lg_u32 s2, 0
    s_cbranch_scc1 L_np
    s_cmp_lg_u32 s48, 4
    s_cbranch_scc1 L_np
    s_memrealtime s[76:77]
    s_waitcnt lgkmcnt(0)
    s_or_b32 s76, s76, 1
    v_mov_b32 v4, s76
    v_mov_b32 v6, 0
    s_mov_b64 exec, 1
    buffer_store_dword v4, v6, s[40:43], 0 offen sc1
    s_mov_b64 exec, -1
L_np:
    s_setprio 0
    v_lshrrev_b32 v4, 3, v1
    v_bfe_u32 v5, v1, 4, 1
    v_lshlrev_b32 v5, 2, v5
    v_xor_b32 v5, v1, v5
    v_and_b32 v5, 7, v5
    v_lshlrev_b32 v5, 4, v5
    v_mul_u32_u24 v2, 0xc00, v4
    v_add_u32 v2, v2, v5
    v_mul_u32_u24 v3, 0xe00, v4
    v_add_u32 v3, v3, v5
    v_lshl_add_u32 v252, v4, 10, v5
    v_xor_b32 v5, 32, v5
    v_mul_u32_u24 v249, 0xc00, v4
    v_add_u32 v249, v249, v5
    v_mul_u32_u24 v250, 0xe00, v4
    v_add_u32 v250, v250, v5
    s_lshl_b32 s59, s71, 12
    s_lshl_b32 s60, s71, 13
    s_mul_i32 s6, s71, 114688
    s_lshl_b32 s7, s5, 1
    s_add_u32 s58, s6, s7
    s_mul_i32 s6, s71, 196608
    s_lshl_b32 s7, s50, 7
    s_add_u32 s56, s6, s7
    s_lshl_b32 s57, s71, 11
    s_lshl_b32 s6, s71, 14
    s_lshl_b32 s7, s53, 7
    s_add_u32 s85, s6, s7
    s_lshl_b32 s67, s50, 2
    s_add_u32 s67, s67, s71
    s_lshl_b32 s78, s67, 12
    s_add_u32 s78, s78, 9437184
    s_cmp_lt_u32 s48, 6
    s_cselect_b32 s16, s12, s16
    s_cselect_b32 s17, s13, s17
    s_cselect_b32 s18, s14, s18
    v_lshrrev_b32 v4, 5, v1
    v_lshlrev_b32 v7, 8, v4
    v_bfe_u32 v6, v1, 3, 2
    v_and_b32 v36, 3, v1
    v_lshl_add_u32 v6, v6, 2, v36
    v_lshl_add_u32 v36, v6, 1, v7
    s_lshl_b32 s65, s67, 9
    v_lshlrev_b32 v238, 4, v1
    s_lshl_b32 s6, s71, 12
    s_add_u32 s6, s6, 65536
    v_lshlrev_b32 v5, 3, v1
    v_add_u32 v234, s6, v5
    v_bfe_u32 v5, v1, 2, 2
    v_lshl_add_u32 v5, v4, 2, v5
    v_and_b32 v7, 3, v1
    v_xor_b32 v7, v7, v4
    v_lshlrev_b32 v7, 3, v7
    v_lshl_add_u32 v7, v5, 5, v7
    v_add_u32 v7, s6, v7
    v_lshlrev_b32 v6, 3, v5
    v_add_u32 v6, 129024, v6
    v_bfe_u32 v5, v1, 4, 1
    v_cmp_eq_u32 vcc, 1, v5
    s_nop 1
    v_cndmask_b32 v232, v7, v6, vcc
    v_xor_b32 v7, 16, v7
    v_add_u32 v7, 256, v7
    v_add_u32 v6, 64, v6
    v_cndmask_b32 v233, v7, v6, vcc
    v_mov_b32 v6, 512
    v_mov_b32 v7, 128
    v_cndmask_b32 v239, v6, v7, vcc
    v_and_b32 v5, 31, v1
    v_min_u32 v5, 16, v5
    v_lshl_add_u32 v5, v4, 5, v5
    v_lshlrev_b32 v235, 2, v5
    v_and_b32 v5, 1, v1
    v_lshlrev_b32 v5, 4, v5
    v_mov_b32 v6, 0x3f80
    v_lshlrev_b32 v6, v5, v6
    v_bfe_u32 v5, v1, 4, 1
    v_cmp_eq_u32 vcc, v5, v4
    s_nop 1
    v_cndmask_b32 v6, 0, v6, vcc
    v_bfe_u32 v5, v1, 1, 3
    v_cmp_eq_u32 vcc, 0, v5
    s_nop 1
    v_cndmask_b32 v224, 0, v6, vcc
    v_cmp_eq_u32 vcc, 1, v5
    s_nop 1
    v_cndmask_b32 v225, 0, v6, vcc
    v_cmp_eq_u32 vcc, 2, v5
    s_nop 1
    v_cndmask_b32 v226, 0, v6, vcc
    v_cmp_eq_u32 vcc, 3, v5
    s_nop 1
    v_cndmask_b32 v227, 0, v6, vcc
    v_cmp_eq_u32 vcc, 4, v5
    s_nop 1
    v_cndmask_b32 v228, 0, v6, vcc
    v_cmp_eq_u32 vcc, 5, v5
    s_nop 1
    v_cndmask_b32 v229, 0, v6, vcc
    v_cmp_eq_u32 vcc, 6, v5
    s_nop 1
    v_cndmask_b32 v230, 0, v6, vcc
    v_cmp_eq_u32 vcc, 7, v5
    s_nop 1
    v_cndmask_b32 v231, 0, v6, vcc
    s_lshl_b32 s54, s71, 12
    s_lshl_b32 s6, s71, 1
    s_and_b32 s7, s71, 2
    s_lshl_b32 s7, s7, 2
    s_add_u32 s6, s6, s7
    s_lshl_b32 s6, s6, 14
    s_lshl_b32 s7, s53, 7
    s_add_u32 s55, s6, s7
    s_waitcnt vmcnt(1)
    s_barrier
    s_add_u32 m0, s60, 131072
    s_add_u32 s64, s56, 1024
    buffer_load_dwordx4 v2, s[28:31], s64 offen lds
    s_add_u32 m0, s60, 132096
    s_add_u32 s64, s56, 25600
    buffer_load_dwordx4 v249, s[28:31], s64 offen lds
    s_add_u32 m0, s60, 133120
    s_add_u32 s64, s56, 50176
    buffer_load_dwordx4 v2, s[28:31], s64 offen lds
    s_add_u32 m0, s60, 134144
    s_add_u32 s64, s56, 74752
    buffer_load_dwordx4 v249, s[28:31], s64 offen lds
    s_add_u32 m0, s60, 135168
    s_add_u32 s64, s56, 99328
    buffer_load_dwordx4 v2, s[28:31], s64 offen lds
    s_add_u32 m0, s60, 136192
    s_add_u32 s64, s56, 123904
    buffer_load_dwordx4 v249, s[28:31], s64 offen lds
    s_add_u32 m0, s60, 137216
    s_add_u32 s64, s56, 148480
    buffer_load_dwordx4 v2, s[28:31], s64 offen lds
    s_add_u32 m0, s60, 138240
    s_add_u32 s64, s56, 173056
    buffer_load_dwordx4 v249, s[28:31], s64 offen lds
    s_add_u32 m0, s60, 0
    s_add_u32 s64, s56, 787456
    buffer_load_dwordx4 v2, s[28:31], s64 offen lds
    s_add_u32 m0, s60, 1024
    s_add_u32 s64, s56, 812032
    buffer_load_dwordx4 v249, s[28:31], s64 offen lds
    s_add_u32 m0, s60, 2048
    s_add_u32 s64, s56, 836608
    buffer_load_dwordx4 v2, s[28:31], s64 offen lds
    s_add_u32 m0, s60, 3072
    s_add_u32 s64, s56, 861184
    buffer_load_dwordx4 v249, s[28:31], s64 offen lds
    s_add_u32 m0, s60, 4096
    s_add_u32 s64, s56, 885760
    buffer_load_dwordx4 v2, s[28:31], s64 offen lds
    s_add_u32 m0, s60, 5120
    s_add_u32 s64, s56, 910336
    buffer_load_dwordx4 v249, s[28:31], s64 offen lds
    s_add_u32 m0, s60, 6144
    s_add_u32 s64, s56, 934912
    buffer_load_dwordx4 v2, s[28:31], s64 offen lds
    s_add_u32 m0, s60, 7168
    s_add_u32 s64, s56, 959488
    buffer_load_dwordx4 v249, s[28:31], s64 offen lds
    v_mov_b32 v17, 0
    buffer_load_dword v16, v17, s[40:43], 0 offen sc1
    s_barrier
    s_add_u32 m0, s60, 32768
    s_add_u32 s64, s56, 2048
    buffer_load_dwordx4 v2, s[28:31], s64 offen lds
    s_add_u32 m0, s60, 33792
    s_add_u32 s64, s56, 26624
    buffer_load_dwordx4 v249, s[28:31], s64 offen lds
    s_add_u32 m0, s60, 34816
    s_add_u32 s64, s56, 51200
    buffer_load_dwordx4 v2, s[28:31], s64 offen lds
    s_add_u32 m0, s60, 35840
    s_add_u32 s64, s56, 75776
    buffer_load_dwordx4 v249, s[28:31], s64 offen lds
    s_add_u32 m0, s60, 36864
    s_add_u32 s64, s56, 100352
    buffer_load_dwordx4 v2, s[28:31], s64 offen lds
    s_add_u32 m0, s60, 37888
    s_add_u32 s64, s56, 124928
    buffer_load_dwordx4 v249, s[28:31], s64 offen lds
    s_add_u32 m0, s60, 38912
    s_add_u32 s64, s56, 149504
    buffer_load_dwordx4 v2, s[28:31], s64 offen lds
    s_add_u32 m0, s60, 39936
    s_add_u32 s64, s56, 174080
    buffer_load_dwordx4 v249, s[28:31], s64 offen lds
    s_waitcnt vmcnt(17)
    s_barrier
    buffer_load_ushort v200, v36, s[44:47], s65 offen offset:0
    buffer_load_ushort v201, v36, s[44:47], s65 offen offset:32
    buffer_load_ushort v202, v36, s[44:47], s65 offen offset:64
    buffer_load_ushort v203, v36, s[44:47], s65 offen offset:96
    buffer_load_ushort v204, v36, s[44:47], s65 offen offset:128
    buffer_load_ushort v205, v36, s[44:47], s65 offen offset:160
    buffer_load_ushort v206, v36, s[44:47], s65 offen offset:192
    buffer_load_ushort v207, v36, s[44:47], s65 offen offset:224
    s_and_b32 s6, s49, 7
    s_lshl_b32 s6, s6, 6
    v_add_u32 v8, s6, v1
    v_mul_u32_u24 v9, 0xe00, v8
    v_mul_u32_u24 v8, 0xc00, v8
    s_lshl_b32 s6, s50, 7
    s_add_u32 s7, s71, 1
    s_cmp_eq_u32 s71, 2
    s_cselect_b32 s7, 0, s7
    s_lshl_b32 s7, s7, 10
    s_add_u32 s6, s6, s7
    s_lshl_b32 s7, s5, 1
    s_cmp_eq_u32 s71, 3
    s_cselect_b32 s6, 0x200000, s6
    s_cselect_b32 s7, s7, 0x200000
    s_cmp_lt_u32 s71, 2
    s_cselect_b32 s6, 0x200000, s6
    buffer_load_dword v243, v8, s[28:31], s6 offen
    buffer_load_dword v244, v9, s[32:35], s7 offen
    buffer_load_dword v245, v9, s[36:39], s7 offen
    s_mul_i32 s6, s2, 7168
    s_lshl_b32 s7, s2, 11
    s_cmp_eq_u32 s48, 7
    s_cselect_b32 s6, s6, 0x200000
    s_cselect_b32 s7, s7, 0x200000
    v_lshlrev_b32 v8, 7, v1
    v_min_u32 v9, 1920, v8
    v_min_u32 v8, 7040, v8
    buffer_load_dword v246, v8, s[12:15], s6 offen
    buffer_load_dword v247, v9, s[16:19], s7 offen
    s_waitcnt lgkmcnt(0)
    s_waitcnt vmcnt(22)
    s_barrier
    s_add_u32 m0, s60, 131072
    s_add_u32 s64, s56, 788480
    buffer_load_dwordx4 v2, s[28:31], s64 offen lds
    v_and_b32 v5, 31, v1
    v_lshlrev_b32 v5, 2, v5
    v_add_u32 v5, 130048, v5
    ds_read_b32 v20, v5 offset:0
    ds_read_b32 v21, v5 offset:128
    ds_read_b32 v22, v5 offset:256
    s_add_u32 m0, s60, 132096
    s_add_u32 s64, s56, 813056
    buffer_load_dwordx4 v249, s[28:31], s64 offen lds
    ds_read_b32 v23, v5 offset:384
    s_waitcnt vmcnt(23)
    v_cmp_eq_u32 vcc, 0, v16
    s_nop 0
    s_cbranch_vccz L_nonX_x
    s_mov_b32 s75, 0
L_nonX:
    buffer_load_dword v16, v17, s[40:43], 0 offen sc1
    s_waitcnt vmcnt(0)
    s_add_u32 s75, s75, 1
    s_cmp_gt_u32 s75, 1048576
    s_cbranch_scc1 L_nonX_x
    v_cmp_eq_u32 vcc, 0, v16
    s_nop 0
    s_cbranch_vccnz L_nonX
L_nonX_x:
    s_add_u32 m0, s60, 133120
    s_add_u32 s64, s56, 837632
    buffer_load_dwordx4 v2, s[28:31], s64 offen lds
    v_readfirstlane_b32 s62, v16
    v_readfirstlane_b32 s63, v16
    v_bfe_u32 v6, v1, 2, 1
    v_mul_u32_u24 v6, 0x8000, v6
    v_lshl_or_b32 v6, v6, 16, v6
    s_waitcnt vmcnt(14)
    v_lshl_or_b32 v8, v201, 16, v200
    s_add_u32 m0, s60, 134144
    s_add_u32 s64, s56, 862208
    buffer_load_dwordx4 v249, s[28:31], s64 offen lds
    v_xor_b32 v8, v6, v8
    s_waitcnt vmcnt(13)
    v_lshl_or_b32 v9, v203, 16, v202
    v_xor_b32 v9, v6, v9
    s_waitcnt vmcnt(11)
    v_lshl_or_b32 v10, v205, 16, v204
    v_xor_b32 v10, v6, v10
    s_waitcnt vmcnt(9)
    v_lshl_or_b32 v11, v207, 16, v206
    s_add_u32 m0, s60, 135168
    s_add_u32 s64, s56, 886784
    buffer_load_dwordx4 v2, s[28:31], s64 offen lds
    v_xor_b32 v11, v6, v11
    s_lshl_b32 s6, s67, 7
    s_add_u32 s6, s6, 11796544
    v_mov_b32 v17, s6
    s_add_u32 s4, s20, s6
    s_addc_u32 s5, s21, 0
    s_add_u32 m0, s60, 136192
    s_add_u32 s64, s56, 911360
    buffer_load_dwordx4 v249, s[28:31], s64 offen lds
    s_lshl_b32 s7, s49, 2
    s_sub_u32 s6, s6, 64
    s_add_u32 s6, s6, s7
    v_mov_b32 v18, s6
    s_cmp_lg_u32 s49, 0
    s_cbranch_scc1 L_zero_x
    v_mov_b32 v136, 0
    v_mov_b32 v137, 0
    v_mov_b32 v138, 0
    v_mov_b32 v139, 0
    buffer_store_dwordx4 v[136:139], v238, s[20:23], s78 offen offset:0 sc1
    buffer_store_dwordx4 v[136:139], v238, s[20:23], s78 offen offset:1024 sc1
    buffer_store_dwordx4 v[136:139], v238, s[20:23], s78 offen offset:2048 sc1
    buffer_store_dwordx4 v[136:139], v238, s[20:23], s78 offen offset:3072 sc1
    s_waitcnt vmcnt(0)
    s_mov_b64 exec, 1
    buffer_store_dword v16, v17, s[20:23], 0 offen sc1
    s_mov_b64 exec, -1
L_zero_x:
    s_add_u32 m0, s60, 137216
    s_add_u32 s64, s56, 935936
    buffer_load_dwordx4 v2, s[28:31], s64 offen lds
    s_add_u32 m0, s60, 138240
    s_add_u32 s64, s56, 960512
    buffer_load_dwordx4 v249, s[28:31], s64 offen lds
    s_add_u32 m0, s54, 81920
    s_add_u32 s64, s55, 851968
    buffer_load_dwordx4 v252, s[12:15], s64 offen lds
    s_add_u32 m0, s54, 82944
    s_add_u32 s64, s55, 860160
    buffer_load_dwordx4 v252, s[12:15], s64 offen lds
    s_add_u32 m0, s54, 83968
    s_add_u32 s64, s55, 868352
    buffer_load_dwordx4 v252, s[12:15], s64 offen lds
    s_add_u32 m0, s54, 84992
    s_add_u32 s64, s55, 876544
    buffer_load_dwordx4 v252, s[12:15], s64 offen lds
    s_waitcnt lgkmcnt(0)
    s_barrier
    s_waitcnt lgkmcnt(0)
    s_barrier
    s_add_u32 m0, s60, 0
    s_add_u32 s64, s56, 0
    buffer_load_dwordx4 v2, s[28:31], s64 offen lds
    ds_read_b64 v[24:25], v234 offset:0
    ds_read_b64 v[26:27], v234 offset:512
    ds_read_b64 v[28:29], v234 offset:1024
    ds_read_b64 v[30:31], v234 offset:1536
    ds_read_b64 v[32:33], v234 offset:2048
    ds_read_b64 v[34:35], v234 offset:2560
    s_add_u32 m0, s60, 1024
    s_add_u32 s64, s56, 24576
    buffer_load_dwordx4 v249, s[28:31], s64 offen lds
    ds_read_b64 v[36:37], v234 offset:3072
    ds_read_b64 v[38:39], v234 offset:3584
    s_setprio 3
    s_waitcnt lgkmcnt(6)
    v_mfma_f32_32x32x16_bf16 v[136:151], v[8:11], v[24:27], 0
    s_waitcnt lgkmcnt(4)
    v_mfma_f32_32x32x16_bf16 v[152:167], v[8:11], v[28:31], 0
    s_waitcnt lgkmcnt(2)
    v_mfma_f32_32x32x16_bf16 v[168:183], v[8:11], v[32:35], 0
    s_add_u32 m0, s60, 2048
    s_add_u32 s64, s56, 49152
    s_setprio 0
    buffer_load_dwordx4 v2, s[28:31], s64 offen lds
    s_add_u32 m0, s60, 3072
    s_add_u32 s64, s56, 73728
    buffer_load_dwordx4 v249, s[28:31], s64 offen lds
    s_add_u32 m0, s60, 4096
    s_add_u32 s64, s56, 98304
    buffer_load_dwordx4 v2, s[28:31], s64 offen lds
    s_add_u32 m0, s60, 5120
    s_add_u32 s64, s56, 122880
    buffer_load_dwordx4 v249, s[28:31], s64 offen lds
    s_add_u32 m0, s60, 6144
    s_add_u32 s64, s56, 147456
    buffer_load_dwordx4 v2, s[28:31], s64 offen lds
    s_add_u32 m0, s60, 7168
    s_add_u32 s64, s56, 172032
    buffer_load_dwordx4 v249, s[28:31], s64 offen lds
    s_waitcnt lgkmcnt(0)
    s_waitcnt vmcnt(12)
    s_barrier
    s_add_u32 m0, s60, 32768
    s_add_u32 s64, s56, 786432
    buffer_load_dwordx4 v2, s[28:31], s64 offen lds
    s_setprio 3
    v_mfma_f32_32x32x16_bf16 v[184:199], v[8:11], v[36:39], 0
    s_setprio 0
    v_max3_f32 v4, v136, v137, v138
    v_max3_f32 v5, v139, v140, v141
    v_max3_f32 v6, v142, v143, v144
    v_max3_f32 v7, v145, v146, v147
    v_max3_f32 v4, v4, v148, v149
    s_add_u32 m0, s60, 33792
    s_add_u32 s64, s56, 811008
    buffer_load_dwordx4 v249, s[28:31], s64 offen lds
    v_max3_f32 v5, v5, v150, v151
    v_max3_f32 v4, v4, v6, v7
    v_max_f32 v4, v4, v5
    v_sub_f32 v136, v136, v4
    v_sub_f32 v137, v137, v4
    v_sub_f32 v138, v138, v4
    s_add_u32 m0, s60, 34816
    s_add_u32 s64, s56, 835584
    buffer_load_dwordx4 v2, s[28:31], s64 offen lds
    v_sub_f32 v139, v139, v4
    v_sub_f32 v140, v140, v4
    v_sub_f32 v141, v141, v4
    v_sub_f32 v142, v142, v4
    v_sub_f32 v143, v143, v4
    v_sub_f32 v144, v144, v4
    s_add_u32 m0, s60, 35840
    s_add_u32 s64, s56, 860160
    buffer_load_dwordx4 v249, s[28:31], s64 offen lds
    v_sub_f32 v145, v145, v4
    v_sub_f32 v146, v146, v4
    v_sub_f32 v147, v147, v4
    v_sub_f32 v148, v148, v4
    v_sub_f32 v149, v149, v4
    v_sub_f32 v150, v150, v4
    s_add_u32 m0, s60, 36864
    s_add_u32 s64, s56, 884736
    buffer_load_dwordx4 v2, s[28:31], s64 offen lds
    v_sub_f32 v151, v151, v4
    v_exp_f32 v136, v136
    v_exp_f32 v137, v137
    v_exp_f32 v138, v138
    v_exp_f32 v139, v139
    v_exp_f32 v140, v140
    s_add_u32 m0, s60, 37888
    s_add_u32 s64, s56, 909312
    buffer_load_dwordx4 v249, s[28:31], s64 offen lds
    v_exp_f32 v141, v141
    v_exp_f32 v142, v142
    v_exp_f32 v143, v143
    v_exp_f32 v144, v144
    v_exp_f32 v145, v145
    v_exp_f32 v146, v146
    s_add_u32 m0, s60, 38912
    s_add_u32 s64, s56, 933888
    buffer_load_dwordx4 v2, s[28:31], s64 offen lds
    v_exp_f32 v147, v147
    v_exp_f32 v148, v148
    v_exp_f32 v149, v149
    v_exp_f32 v150, v150
    v_exp_f32 v151, v151
    v_add_f32 v6, v136, v137
    s_add_u32 m0, s60, 39936
    s_add_u32 s64, s56, 958464
    buffer_load_dwordx4 v249, s[28:31], s64 offen lds
    v_add_f32 v7, v138, v139
    v_add_f32 v4, v140, v141
    v_add_f32 v5, v142, v143
    v_add_f32 v4, v4, v144
    v_add_f32 v5, v5, v145
    v_add_f32 v6, v6, v146
    s_add_u32 m0, s54, 98304
    s_add_u32 s64, s55, 1179648
    buffer_load_dwordx4 v252, s[12:15], s64 offen lds
    v_add_f32 v7, v7, v147
    v_add_f32 v4, v4, v148
    v_add_f32 v5, v5, v149
    v_add_f32 v6, v6, v150
    v_add_f32 v7, v7, v151
    v_add_f32 v4, v4, v5
    s_add_u32 m0, s54, 99328
    s_add_u32 s64, s55, 1187840
    buffer_load_dwordx4 v252, s[12:15], s64 offen lds
    v_add_f32 v6, v6, v7
    v_add_f32 v6, v6, v4
    v_rcp_f32 v6, v6
    s_nop 0
    v_mul_f32 v6, v6, v20
    v_mul_f32 v136, v136, v6
    v_mul_f32 v137, v137, v6
    s_add_u32 m0, s54, 100352
    s_add_u32 s64, s55, 1196032
    buffer_load_dwordx4 v252, s[12:15], s64 offen lds
    v_mul_f32 v138, v138, v6
    v_mul_f32 v139, v139, v6
    v_cvt_pk_bf16_f32 v56, v136, v137
    v_mul_f32 v140, v140, v6
    v_mul_f32 v141, v141, v6
    v_cvt_pk_bf16_f32 v57, v138, v139
    s_add_u32 m0, s54, 101376
    s_add_u32 s64, s55, 1204224
    buffer_load_dwordx4 v252, s[12:15], s64 offen lds
    v_mul_f32 v142, v142, v6
    v_mul_f32 v143, v143, v6
    v_cvt_pk_bf16_f32 v58, v140, v141
    v_mul_f32 v144, v144, v6
    v_mul_f32 v145, v145, v6
    v_cvt_pk_bf16_f32 v59, v142, v143
    v_mul_f32 v146, v146, v6
    v_mul_f32 v147, v147, v6
    v_cvt_pk_bf16_f32 v60, v144, v145
    v_mul_f32 v148, v148, v6
    v_mul_f32 v149, v149, v6
    v_cvt_pk_bf16_f32 v61, v146, v147
    v_mul_f32 v150, v150, v6
    v_mul_f32 v151, v151, v6
    v_cvt_pk_bf16_f32 v62, v148, v149
    v_cvt_pk_bf16_f32 v63, v150, v151
    v_max3_f32 v4, v152, v153, v154
    v_max3_f32 v5, v155, v156, v157
    v_max3_f32 v6, v158, v159, v160
    v_max3_f32 v7, v161, v162, v163
    v_max3_f32 v4, v4, v164, v165
    v_max3_f32 v5, v5, v166, v167
    v_max3_f32 v4, v4, v6, v7
    v_max_f32 v4, v4, v5
    s_setprio 3
    v_mfma_f32_32x32x16_bf16 v[200:215], v[56:59], v[224:227], 0
    s_setprio 0
    v_sub_f32 v152, v152, v4
    v_sub_f32 v153, v153, v4
    v_sub_f32 v154, v154, v4
    v_sub_f32 v155, v155, v4
    v_sub_f32 v156, v156, v4
    v_sub_f32 v157, v157, v4
    v_sub_f32 v158, v158, v4
    v_sub_f32 v159, v159, v4
    s_setprio 3
    v_mfma_f32_32x32x16_bf16 v[200:215], v[60:63], v[228:231], v[200:215]
    s_waitcnt lgkmcnt(0)
    s_waitcnt vmcnt(12)
    s_barrier
    s_setprio 0
    v_sub_f32 v160, v160, v4
    v_sub_f32 v161, v161, v4
    v_sub_f32 v162, v162, v4
    v_sub_f32 v163, v163, v4
    v_sub_f32 v164, v164, v4
    v_sub_f32 v165, v165, v4
    v_sub_f32 v166, v166, v4
    v_sub_f32 v167, v167, v4
    v_exp_f32 v152, v152
    v_exp_f32 v153, v153
    v_exp_f32 v154, v154
    v_exp_f32 v155, v155
    v_exp_f32 v156, v156
    v_exp_f32 v157, v157
    v_exp_f32 v158, v158
    v_exp_f32 v159, v159
    v_cvt_pk_bf16_f32 v216, v200, v201
    v_cvt_pk_bf16_f32 v217, v202, v203
    v_cvt_pk_bf16_f32 v218, v204, v205
    v_cvt_pk_bf16_f32 v219, v206, v207
    v_cvt_pk_bf16_f32 v220, v208, v209
    v_cvt_pk_bf16_f32 v221, v210, v211
    v_cvt_pk_bf16_f32 v222, v212, v213
    v_cvt_pk_bf16_f32 v223, v214, v215
    v_exp_f32 v160, v160
    v_exp_f32 v161, v161
    v_exp_f32 v162, v162
    v_exp_f32 v163, v163
    v_exp_f32 v164, v164
    v_exp_f32 v165, v165
    v_exp_f32 v166, v166
    v_exp_f32 v167, v167
    v_add_f32 v6, v152, v153
    v_add_f32 v7, v154, v155
    v_add_f32 v4, v156, v157
    v_add_f32 v5, v158, v159
    v_add_f32 v4, v4, v160
    v_add_f32 v5, v5, v161
    v_add_f32 v6, v6, v162
    v_add_f32 v7, v7, v163
    v_add_f32 v4, v4, v164
    v_add_f32 v5, v5, v165
    v_add_f32 v6, v6, v166
    v_add_f32 v7, v7, v167
    v_add_f32 v4, v4, v5
    v_add_f32 v6, v6, v7
    v_add_f32 v6, v6, v4
    v_rcp_f32 v6, v6
    s_nop 0
    v_mul_f32 v6, v6, v21
    v_mul_f32 v152, v152, v6
    v_mul_f32 v153, v153, v6
    v_mul_f32 v154, v154, v6
    v_mul_f32 v155, v155, v6
    v_cvt_pk_bf16_f32 v64, v152, v153
    v_mul_f32 v156, v156, v6
    v_mul_f32 v157, v157, v6
    v_cvt_pk_bf16_f32 v65, v154, v155
    v_mul_f32 v158, v158, v6
    v_mul_f32 v159, v159, v6
    v_cvt_pk_bf16_f32 v66, v156, v157
    v_mul_f32 v160, v160, v6
    v_mul_f32 v161, v161, v6
    v_cvt_pk_bf16_f32 v67, v158, v159
    v_mul_f32 v162, v162, v6
    v_mul_f32 v163, v163, v6
    v_cvt_pk_bf16_f32 v68, v160, v161
    v_mul_f32 v164, v164, v6
    v_mul_f32 v165, v165, v6
    v_cvt_pk_bf16_f32 v69, v162, v163
    v_mul_f32 v166, v166, v6
    v_mul_f32 v167, v167, v6
    v_cvt_pk_bf16_f32 v70, v164, v165
    v_cvt_pk_bf16_f32 v71, v166, v167
    v_max3_f32 v4, v168, v169, v170
    v_max3_f32 v5, v171, v172, v173
    v_max3_f32 v6, v174, v175, v176
    v_max3_f32 v7, v177, v178, v179
    v_max3_f32 v4, v4, v180, v181
    v_max3_f32 v5, v5, v182, v183
    s_waitcnt lgkmcnt(0)
    s_barrier
    s_add_u32 m0, s59, 131072
    s_add_u32 s64, s58, 0
    buffer_load_dwordx4 v3, s[32:35], s64 offen lds
    v_max3_f32 v4, v4, v6, v7
    v_max_f32 v4, v4, v5
    s_setprio 3
    v_mfma_f32_32x32x16_bf16 v[200:215], v[64:67], v[224:227], 0
    s_setprio 0
    v_sub_f32 v168, v168, v4
    v_sub_f32 v169, v169, v4
    v_sub_f32 v170, v170, v4
    s_add_u32 m0, s59, 147456
    s_add_u32 s64, s58, 0
    buffer_load_dwordx4 v3, s[36:39], s64 offen lds
    v_sub_f32 v171, v171, v4
    v_sub_f32 v172, v172, v4
    v_sub_f32 v173, v173, v4
    v_sub_f32 v174, v174, v4
    v_sub_f32 v175, v175, v4
    s_setprio 3
    v_mfma_f32_32x32x16_bf16 v[200:215], v[68:71], v[228:231], v[200:215]
    s_add_u32 m0, s59, 132096
    s_add_u32 s64, s58, 28672
    s_setprio 0
    buffer_load_dwordx4 v250, s[32:35], s64 offen lds
    v_sub_f32 v176, v176, v4
    v_sub_f32 v177, v177, v4
    v_sub_f32 v178, v178, v4
    v_sub_f32 v179, v179, v4
    v_sub_f32 v180, v180, v4
    v_sub_f32 v181, v181, v4
    s_add_u32 m0, s59, 148480
    s_add_u32 s64, s58, 28672
    buffer_load_dwordx4 v250, s[36:39], s64 offen lds
    v_sub_f32 v182, v182, v4
    v_sub_f32 v183, v183, v4
    v_exp_f32 v168, v168
    v_exp_f32 v169, v169
    v_exp_f32 v170, v170
    v_exp_f32 v171, v171
    s_add_u32 m0, s59, 133120
    s_add_u32 s64, s58, 57344
    buffer_load_dwordx4 v3, s[32:35], s64 offen lds
    v_exp_f32 v172, v172
    v_exp_f32 v173, v173
    v_exp_f32 v174, v174
    v_exp_f32 v175, v175
    v_cvt_pk_bf16_f32 v56, v200, v201
    v_cvt_pk_bf16_f32 v57, v202, v203
    s_add_u32 m0, s59, 149504
    s_add_u32 s64, s58, 57344
    buffer_load_dwordx4 v3, s[36:39], s64 offen lds
    v_cvt_pk_bf16_f32 v58, v204, v205
    v_cvt_pk_bf16_f32 v59, v206, v207
    v_cvt_pk_bf16_f32 v60, v208, v209
    s_add_u32 m0, s59, 134144
    s_add_u32 s64, s58, 86016
    buffer_load_dwordx4 v250, s[32:35], s64 offen lds
    s_add_u32 m0, s59, 150528
    s_add_u32 s64, s58, 86016
    buffer_load_dwordx4 v250, s[36:39], s64 offen lds
    s_waitcnt lgkmcnt(0)
    s_waitcnt vmcnt(12)
    s_barrier
    s_add_u32 m0, s59, 0
    s_add_u32 s64, s58, 458752
    buffer_load_dwordx4 v3, s[32:35], s64 offen lds
    v_cvt_pk_bf16_f32 v61, v210, v211
    v_cvt_pk_bf16_f32 v62, v212, v213
    v_cvt_pk_bf16_f32 v63, v214, v215
    v_exp_f32 v176, v176
    v_exp_f32 v177, v177
    v_exp_f32 v178, v178
    s_add_u32 m0, s59, 16384
    s_add_u32 s64, s58, 458752
    buffer_load_dwordx4 v3, s[36:39], s64 offen lds
    v_exp_f32 v179, v179
    v_exp_f32 v180, v180
    v_exp_f32 v181, v181
    v_exp_f32 v182, v182
    v_exp_f32 v183, v183
    v_add_f32 v6, v168, v169
    s_add_u32 m0, s59, 1024
    s_add_u32 s64, s58, 487424
    buffer_load_dwordx4 v250, s[32:35], s64 offen lds
    v_add_f32 v7, v170, v171
    v_add_f32 v4, v172, v173
    v_add_f32 v5, v174, v175
    v_add_f32 v4, v4, v176
    v_add_f32 v5, v5, v177
    v_add_f32 v6, v6, v178
    s_add_u32 m0, s59, 17408
    s_add_u32 s64, s58, 487424
    buffer_load_dwordx4 v250, s[36:39], s64 offen lds
    v_add_f32 v7, v7, v179
    v_add_f32 v4, v4, v180
    v_add_f32 v5, v5, v181
    v_add_f32 v6, v6, v182
    v_add_f32 v7, v7, v183
    v_add_f32 v4, v4, v5
    s_add_u32 m0, s59, 2048
    s_add_u32 s64, s58, 516096
    buffer_load_dwordx4 v3, s[32:35], s64 offen lds
    v_add_f32 v6, v6, v7
    v_add_f32 v6, v6, v4
    v_rcp_f32 v6, v6
    s_nop 0
    v_mul_f32 v6, v6, v22
    v_mul_f32 v168, v168, v6
    v_mul_f32 v169, v169, v6
    s_add_u32 m0, s59, 18432
    s_add_u32 s64, s58, 516096
    buffer_load_dwordx4 v3, s[36:39], s64 offen lds
    v_mul_f32 v170, v170, v6
    v_mul_f32 v171, v171, v6
    v_cvt_pk_bf16_f32 v24, v168, v169
    v_mul_f32 v172, v172, v6
    v_mul_f32 v173, v173, v6
    v_cvt_pk_bf16_f32 v25, v170, v171
    s_add_u32 m0, s59, 3072
    s_add_u32 s64, s58, 544768
    buffer_load_dwordx4 v250, s[32:35], s64 offen lds
    v_mul_f32 v174, v174, v6
    v_mul_f32 v175, v175, v6
    v_cvt_pk_bf16_f32 v26, v172, v173
    v_mul_f32 v176, v176, v6
    v_mul_f32 v177, v177, v6
    v_cvt_pk_bf16_f32 v27, v174, v175
    s_add_u32 m0, s59, 19456
    s_add_u32 s64, s58, 544768
    buffer_load_dwordx4 v250, s[36:39], s64 offen lds
    v_mul_f32 v178, v178, v6
    v_mul_f32 v179, v179, v6
    v_cvt_pk_bf16_f32 v28, v176, v177
    v_mul_f32 v180, v180, v6
    v_mul_f32 v181, v181, v6
    v_cvt_pk_bf16_f32 v29, v178, v179
    s_add_u32 m0, s54, 114688
    s_add_u32 s64, s55, 1507328
    buffer_load_dwordx4 v252, s[12:15], s64 offen lds
    v_mul_f32 v182, v182, v6
    v_mul_f32 v183, v183, v6
    v_cvt_pk_bf16_f32 v30, v180, v181
    v_cvt_pk_bf16_f32 v31, v182, v183
    v_max3_f32 v4, v184, v185, v186
    v_max3_f32 v5, v187, v188, v189
    s_add_u32 m0, s54, 115712
    s_add_u32 s64, s55, 1515520
    buffer_load_dwordx4 v252, s[12:15], s64 offen lds
    v_max3_f32 v6, v190, v191, v192
    v_max3_f32 v7, v193, v194, v195
    v_max3_f32 v4, v4, v196, v197
    v_max3_f32 v5, v5, v198, v199
    v_max3_f32 v4, v4, v6, v7
    v_max_f32 v4, v4, v5
    s_setprio 3
    v_mfma_f32_32x32x16_bf16 v[200:215], v[24:27], v[224:227], 0
    s_setprio 0
    v_sub_f32 v184, v184, v4
    v_sub_f32 v185, v185, v4
    v_sub_f32 v186, v186, v4
    v_sub_f32 v187, v187, v4
    v_sub_f32 v188, v188, v4
    v_sub_f32 v189, v189, v4
    v_sub_f32 v190, v190, v4
    v_sub_f32 v191, v191, v4
    s_setprio 3
    v_mfma_f32_32x32x16_bf16 v[200:215], v[28:31], v[228:231], v[200:215]
    s_setprio 0
    v_sub_f32 v192, v192, v4
    v_sub_f32 v193, v193, v4
    v_sub_f32 v194, v194, v4
    v_sub_f32 v195, v195, v4
    v_sub_f32 v196, v196, v4
    v_sub_f32 v197, v197, v4
    v_sub_f32 v198, v198, v4
    v_sub_f32 v199, v199, v4
    v_exp_f32 v184, v184
    v_exp_f32 v185, v185
    v_exp_f32 v186, v186
    v_exp_f32 v187, v187
    v_exp_f32 v188, v188
    v_exp_f32 v189, v189
    v_exp_f32 v190, v190
    v_exp_f32 v191, v191
    v_cvt_pk_bf16_f32 v64, v200, v201
    v_cvt_pk_bf16_f32 v65, v202, v203
    v_cvt_pk_bf16_f32 v66, v204, v205
    v_cvt_pk_bf16_f32 v67, v206, v207
    v_cvt_pk_bf16_f32 v68, v208, v209
    v_cvt_pk_bf16_f32 v69, v210, v211
    v_cvt_pk_bf16_f32 v70, v212, v213
    v_cvt_pk_bf16_f32 v71, v214, v215
    v_exp_f32 v192, v192
    v_exp_f32 v193, v193
    v_exp_f32 v194, v194
    v_exp_f32 v195, v195
    v_exp_f32 v196, v196
    v_exp_f32 v197, v197
    v_exp_f32 v198, v198
    v_exp_f32 v199, v199
    v_add_f32 v6, v184, v185
    v_add_f32 v7, v186, v187
    v_add_f32 v4, v188, v189
    s_waitcnt lgkmcnt(0)
    s_waitcnt vmcnt(10)
    s_barrier
    s_add_u32 m0, s59, 32768
    s_add_u32 s64, s58, 917504
    buffer_load_dwordx4 v3, s[32:35], s64 offen lds
    v_add_f32 v5, v190, v191
    v_add_f32 v4, v4, v192
    v_add_f32 v5, v5, v193
    v_add_f32 v6, v6, v194
    v_add_f32 v7, v7, v195
    v_add_f32 v4, v4, v196
    s_add_u32 m0, s59, 49152
    s_add_u32 s64, s58, 917504
    buffer_load_dwordx4 v3, s[36:39], s64 offen lds
    v_add_f32 v5, v5, v197
    v_add_f32 v6, v6, v198
    v_add_f32 v7, v7, v199
    v_add_f32 v4, v4, v5
    v_add_f32 v6, v6, v7
    v_add_f32 v6, v6, v4
    s_add_u32 m0, s59, 33792
    s_add_u32 s64, s58, 946176
    buffer_load_dwordx4 v250, s[32:35], s64 offen lds
    v_rcp_f32 v6, v6
    s_nop 0
    v_mul_f32 v6, v6, v23
    v_mul_f32 v184, v184, v6
    v_mul_f32 v185, v185, v6
    v_mul_f32 v186, v186, v6
    v_mul_f32 v187, v187, v6
    s_add_u32 m0, s59, 50176
    s_add_u32 s64, s58, 946176
    buffer_load_dwordx4 v250, s[36:39], s64 offen lds
    v_cvt_pk_bf16_f32 v32, v184, v185
    v_mul_f32 v188, v188, v6
    v_mul_f32 v189, v189, v6
    v_cvt_pk_bf16_f32 v33, v186, v187
    v_mul_f32 v190, v190, v6
    v_mul_f32 v191, v191, v6
    s_add_u32 m0, s59, 34816
    s_add_u32 s64, s58, 974848
    buffer_load_dwordx4 v3, s[32:35], s64 offen lds
    v_cvt_pk_bf16_f32 v34, v188, v189
    v_mul_f32 v192, v192, v6
    v_mul_f32 v193, v193, v6
    v_cvt_pk_bf16_f32 v35, v190, v191
    v_mul_f32 v194, v194, v6
    v_mul_f32 v195, v195, v6
    s_add_u32 m0, s59, 51200
    s_add_u32 s64, s58, 974848
    buffer_load_dwordx4 v3, s[36:39], s64 offen lds
    v_cvt_pk_bf16_f32 v36, v192, v193
    v_mul_f32 v196, v196, v6
    v_mul_f32 v197, v197, v6
    v_cvt_pk_bf16_f32 v37, v194, v195
    v_mul_f32 v198, v198, v6
    v_mul_f32 v199, v199, v6
    s_add_u32 m0, s59, 35840
    s_add_u32 s64, s58, 1003520
    buffer_load_dwordx4 v250, s[32:35], s64 offen lds
    v_cvt_pk_bf16_f32 v38, v196, v197
    v_cvt_pk_bf16_f32 v39, v198, v199
    s_setprio 3
    v_mfma_f32_32x32x16_bf16 v[200:215], v[32:35], v[224:227], 0
    v_mfma_f32_32x32x16_bf16 v[200:215], v[36:39], v[228:231], v[200:215]
    s_load_dword s44, s[4:5], 0 glc
    s_waitcnt lgkmcnt(0)
    s_cmp_eq_u32 s44, s62
    s_cbranch_scc1 L_pollz_x
    s_mov_b32 s75, 0
L_pollz:
    s_sleep 2
    s_load_dword s44, s[4:5], 0 glc
    s_add_u32 s75, s75, 1
    s_cmp_gt_u32 s75, 1048576
    s_cbranch_scc1 L_pollz_y
    s_waitcnt lgkmcnt(0)
    s_cmp_eq_u32 s44, s62
    s_cbranch_scc0 L_pollz
L_pollz_y:
    s_waitcnt lgkmcnt(0)
L_pollz_x:
    s_add_u32 m0, s59, 52224
    s_add_u32 s64, s58, 1003520
    s_setprio 0
    buffer_load_dwordx4 v250, s[36:39], s64 offen lds
    v_cvt_pk_bf16_f32 v24, v200, v201
    v_cvt_pk_bf16_f32 v25, v202, v203
    v_cvt_pk_bf16_f32 v26, v204, v205
    v_cvt_pk_bf16_f32 v27, v206, v207
    v_cvt_pk_bf16_f32 v28, v208, v209
    v_cvt_pk_bf16_f32 v29, v210, v211
    v_cvt_pk_bf16_f32 v30, v212, v213
    v_cvt_pk_bf16_f32 v31, v214, v215
    ds_read_b64_tr_b16 v[136:137], v232
    ds_read_b64_tr_b16 v[138:139], v233
    v_add_u32 v232, v232, v239
    v_add_u32 v233, v233, v239
    ds_read_b64_tr_b16 v[140:141], v232
    ds_read_b64_tr_b16 v[142:143], v233
    v_add_u32 v232, v232, v239
    v_add_u32 v233, v233, v239
    ds_read_b64_tr_b16 v[144:145], v232
    ds_read_b64_tr_b16 v[146:147], v233
    v_add_u32 v232, v232, v239
    v_add_u32 v233, v233, v239
    ds_read_b64_tr_b16 v[148:149], v232
    ds_read_b64_tr_b16 v[150:151], v233
    v_add_u32 v232, v232, v239
    v_add_u32 v233, v233, v239
    ds_read_b64_tr_b16 v[152:153], v232
    ds_read_b64_tr_b16 v[154:155], v233
    v_add_u32 v232, v232, v239
    v_add_u32 v233, v233, v239
    ds_read_b64_tr_b16 v[156:157], v232
    ds_read_b64_tr_b16 v[158:159], v233
    v_add_u32 v232, v232, v239
    v_add_u32 v233, v233, v239
    s_waitcnt lgkmcnt(8)
    ds_read_b64_tr_b16 v[160:161], v232
    ds_read_b64_tr_b16 v[162:163], v233
    v_add_u32 v232, v232, v239
    v_add_u32 v233, v233, v239
    ds_read_b64_tr_b16 v[164:165], v232
    ds_read_b64_tr_b16 v[166:167], v233
    s_setprio 3
    v_mfma_f32_32x32x16_bf16 v[40:55], v[216:219], v[136:139], 0
    v_mfma_f32_32x32x16_bf16 v[40:55], v[220:223], v[140:143], v[40:55]
    s_waitcnt lgkmcnt(10)
    v_mfma_f32_32x32x16_bf16 v[40:55], v[56:59], v[144:147], v[40:55]
    s_waitcnt lgkmcnt(8)
    v_mfma_f32_32x32x16_bf16 v[40:55], v[60:63], v[148:151], v[40:55]
    s_waitcnt lgkmcnt(6)
    v_mfma_f32_32x32x16_bf16 v[40:55], v[64:67], v[152:155], v[40:55]
    s_waitcnt lgkmcnt(4)
    v_mfma_f32_32x32x16_bf16 v[40:55], v[68:71], v[156:159], v[40:55]
    s_waitcnt lgkmcnt(2)
    v_mfma_f32_32x32x16_bf16 v[40:55], v[24:27], v[160:163], v[40:55]
    s_waitcnt lgkmcnt(0)
    v_mfma_f32_32x32x16_bf16 v[40:55], v[28:31], v[164:167], v[40:55]
    s_waitcnt lgkmcnt(0)
    s_waitcnt vmcnt(10)
    s_barrier
    s_add_u32 m0, s59, 131072
    s_add_u32 s64, s58, 1376256
    s_setprio 0
    buffer_load_dwordx4 v3, s[32:35], s64 offen lds
    s_add_u32 m0, s59, 147456
    s_add_u32 s64, s58, 1376256
    buffer_load_dwordx4 v3, s[36:39], s64 offen lds
    s_add_u32 m0, s59, 132096
    s_add_u32 s64, s58, 1404928
    buffer_load_dwordx4 v250, s[32:35], s64 offen lds
    s_add_u32 m0, s59, 148480
    s_add_u32 s64, s58, 1404928
    buffer_load_dwordx4 v250, s[36:39], s64 offen lds
    s_add_u32 m0, s59, 133120
    s_add_u32 s64, s58, 1433600
    buffer_load_dwordx4 v3, s[32:35], s64 offen lds
    s_add_u32 m0, s59, 149504
    s_add_u32 s64, s58, 1433600
    buffer_load_dwordx4 v3, s[36:39], s64 offen lds
    s_add_u32 m0, s59, 134144
    s_add_u32 s64, s58, 1462272
    buffer_load_dwordx4 v250, s[32:35], s64 offen lds
    s_add_u32 m0, s59, 150528
    s_add_u32 s64, s58, 1462272
    buffer_load_dwordx4 v250, s[36:39], s64 offen lds
    s_add_u32 m0, s54, 116736
    s_add_u32 s64, s55, 1523712
    buffer_load_dwordx4 v252, s[12:15], s64 offen lds
    s_add_u32 m0, s54, 65536
    s_add_u32 s64, s55, 524288
    buffer_load_dwordx4 v252, s[12:15], s64 offen lds
    s_add_u32 m0, s54, 66560
    s_add_u32 s64, s55, 532480
    buffer_load_dwordx4 v252, s[12:15], s64 offen lds
    s_add_u32 m0, s54, 117760
    s_add_u32 s64, s55, 1531904
    buffer_load_dwordx4 v252, s[12:15], s64 offen lds
    s_add_u32 m0, s54, 67584
    s_add_u32 s64, s55, 540672
    buffer_load_dwordx4 v252, s[12:15], s64 offen lds
    s_add_u32 m0, s54, 68608
    s_add_u32 s64, s55, 548864
    buffer_load_dwordx4 v252, s[12:15], s64 offen lds
    s_waitcnt lgkmcnt(0)
    s_waitcnt vmcnt(14)
    s_barrier
    s_mov_b32 s76, 0x1ffff
    s_mov_b32 s77, 0x1ffff
    s_mov_b64 exec, s[76:77]
    s_setprio 3
    buffer_atomic_add_f32 v40, v235, s[20:23], s78 offen offset:0
    buffer_atomic_add_f32 v41, v235, s[20:23], s78 offen offset:256
    buffer_atomic_add_f32 v42, v235, s[20:23], s78 offen offset:512
    buffer_atomic_add_f32 v43, v235, s[20:23], s78 offen offset:768
    buffer_atomic_add_f32 v44, v235, s[20:23], s78 offen offset:1024
    buffer_atomic_add_f32 v45, v235, s[20:23], s78 offen offset:1280
    buffer_atomic_add_f32 v46, v235, s[20:23], s78 offen offset:1536
    buffer_atomic_add_f32 v47, v235, s[20:23], s78 offen offset:1792
    buffer_atomic_add_f32 v48, v235, s[20:23], s78 offen offset:2048
    buffer_atomic_add_f32 v49, v235, s[20:23], s78 offen offset:2304
    buffer_atomic_add_f32 v50, v235, s[20:23], s78 offen offset:2560
    buffer_atomic_add_f32 v51, v235, s[20:23], s78 offen offset:2816
    buffer_atomic_add_f32 v52, v235, s[20:23], s78 offen offset:3072
    buffer_atomic_add_f32 v53, v235, s[20:23], s78 offen offset:3328
    buffer_atomic_add_f32 v54, v235, s[20:23], s78 offen offset:3584
    buffer_atomic_add_f32 v55, v235, s[20:23], s78 offen offset:3840
    s_mov_b64 exec, -1
    s_waitcnt vmcnt(0)
    s_mov_b64 exec, 1
    buffer_store_dword v16, v18, s[20:23], 0 offen sc1
    s_mov_b64 exec, -1
    s_waitcnt lgkmcnt(0)
    s_barrier
    s_add_u32 m0, s57, 0
    s_add_u32 s64, s85, 786432
    s_setprio 0
    buffer_load_dwordx4 v252, s[12:15], s64 offen lds
    s_add_u32 m0, s57, 1024
    s_add_u32 s64, s85, 794624
    buffer_load_dwordx4 v252, s[12:15], s64 offen lds
    s_add_u32 m0, s57, 8192
    s_add_u32 s64, s85, 1114112
    buffer_load_dwordx4 v252, s[12:15], s64 offen lds
    s_add_u32 m0, s57, 9216
    s_add_u32 s64, s85, 1122304
    buffer_load_dwordx4 v252, s[12:15], s64 offen lds
    s_add_u32 m0, s57, 16384
    s_add_u32 s64, s85, 1441792
    buffer_load_dwordx4 v252, s[12:15], s64 offen lds
    s_add_u32 m0, s57, 17408
    s_add_u32 s64, s85, 1449984
    buffer_load_dwordx4 v252, s[12:15], s64 offen lds
    s_add_u32 m0, s57, 24576
    s_add_u32 s64, s85, 1769472
    buffer_load_dwordx4 v252, s[12:15], s64 offen lds
    s_add_u32 m0, s57, 25600
    s_add_u32 s64, s85, 1777664
    buffer_load_dwordx4 v252, s[12:15], s64 offen lds
    s_waitcnt lgkmcnt(0)
    s_waitcnt vmcnt(0)
    s_barrier
L_BHX:
    s_setprio 0
    v_lshlrev_b32 v3, 4, v1
    v_lshrrev_b32 v7, 5, v1
    v_bfe_u32 v6, v1, 2, 2
    v_lshl_add_u32 v6, v7, 3, v6
    v_lshlrev_b32 v6, 7, v6
    v_bfe_u32 v7, v1, 3, 1
    v_lshl_add_u32 v6, v7, 6, v6
    v_bfe_u32 v7, v1, 4, 1
    v_lshl_add_u32 v6, v7, 5, v6
    v_and_b32 v7, 3, v1
    v_lshl_add_u32 v6, v7, 3, v6
    v_add_u32 v6, s81, v6
    v_xor_b32 v5, 64, v6
    s_lshr_b32 s6, s52, 1
    s_lshl_b32 s6, s6, 7
    s_and_b32 s78, s48, 1
    s_lshl_b32 s7, s78, 6
    s_add_u32 s6, s6, s7
    s_add_u32 s6, s6, 11816960
    s_lshl_b32 s7, s52, 8
    s_lshl_b32 s78, s78, 4
    s_add_u32 s7, s7, s78
    s_add_u32 s7, s7, 11800576
    s_cmp_ge_u32 s48, 6
    s_cselect_b32 s6, s6, s7
    s_add_u32 s4, s20, s6
    s_addc_u32 s5, s21, 0
    s_add_u32 m0, s81, 0
    s_add_u32 s64, s80, 0
    buffer_load_dwordx4 v252, s[16:19], s64 offen lds
    s_add_u32 m0, s81, 1024
    s_add_u32 s64, s80, 8192
    buffer_load_dwordx4 v252, s[16:19], s64 offen lds
    s_add_u32 m0, s81, 2048
    s_add_u32 s64, s80, 16384
    buffer_load_dwordx4 v252, s[16:19], s64 offen lds
    s_add_u32 m0, s81, 3072
    s_add_u32 s64, s80, 24576
    buffer_load_dwordx4 v252, s[16:19], s64 offen lds
    s_add_u32 m0, s81, 4096
    s_add_u32 s64, s80, 32768
    buffer_load_dwordx4 v252, s[16:19], s64 offen lds
    s_add_u32 m0, s81, 5120
    s_add_u32 s64, s80, 40960
    buffer_load_dwordx4 v252, s[16:19], s64 offen lds
    s_add_u32 m0, s81, 6144
    s_add_u32 s64, s80, 49152
    buffer_load_dwordx4 v252, s[16:19], s64 offen lds
    s_add_u32 m0, s81, 7168
    s_add_u32 s64, s80, 57344
    buffer_load_dwordx4 v252, s[16:19], s64 offen lds
    s_add_u32 m0, s81, 8192
    s_add_u32 s64, s80, 65536
    buffer_load_dwordx4 v252, s[16:19], s64 offen lds
    s_add_u32 m0, s81, 9216
    s_add_u32 s64, s80, 73728
    buffer_load_dwordx4 v252, s[16:19], s64 offen lds
    s_add_u32 m0, s81, 10240
    s_add_u32 s64, s80, 81920
    buffer_load_dwordx4 v252, s[16:19], s64 offen lds
    s_add_u32 m0, s81, 11264
    s_add_u32 s64, s80, 90112
    buffer_load_dwordx4 v252, s[16:19], s64 offen lds
    s_add_u32 m0, s81, 12288
    s_add_u32 s64, s80, 98304
    buffer_load_dwordx4 v252, s[16:19], s64 offen lds
    s_add_u32 m0, s81, 13312
    s_add_u32 s64, s80, 106496
    buffer_load_dwordx4 v252, s[16:19], s64 offen lds
    s_add_u32 m0, s81, 14336
    s_add_u32 s64, s80, 114688
    buffer_load_dwordx4 v252, s[16:19], s64 offen lds
    s_add_u32 m0, s81, 15360
    s_add_u32 s64, s80, 122880
    buffer_load_dwordx4 v252, s[16:19], s64 offen lds
    s_waitcnt vmcnt(14)
    ds_read_b64_tr_b16 v[72:73], v6 offset:0
    ds_read_b64_tr_b16 v[74:75], v6 offset:512
    ds_read_b64_tr_b16 v[76:77], v5 offset:0
    ds_read_b64_tr_b16 v[78:79], v5 offset:512
    s_waitcnt vmcnt(12)
    ds_read_b64_tr_b16 v[80:81], v6 offset:2048
    ds_read_b64_tr_b16 v[82:83], v6 offset:2560
    ds_read_b64_tr_b16 v[84:85], v5 offset:2048
    ds_read_b64_tr_b16 v[86:87], v5 offset:2560
    s_waitcnt vmcnt(10)
    ds_read_b64_tr_b16 v[88:89], v6 offset:4096
    ds_read_b64_tr_b16 v[90:91], v6 offset:4608
    ds_read_b64_tr_b16 v[92:93], v5 offset:4096
    ds_read_b64_tr_b16 v[94:95], v5 offset:4608
    s_waitcnt vmcnt(8)
    ds_read_b64_tr_b16 v[96:97], v6 offset:6144
    ds_read_b64_tr_b16 v[98:99], v6 offset:6656
    ds_read_b64_tr_b16 v[100:101], v5 offset:6144
    ds_read_b64_tr_b16 v[102:103], v5 offset:6656
    s_waitcnt lgkmcnt(8)
    s_waitcnt vmcnt(6)
    ds_read_b64_tr_b16 v[104:105], v6 offset:8192
    ds_read_b64_tr_b16 v[106:107], v6 offset:8704
    ds_read_b64_tr_b16 v[108:109], v5 offset:8192
    ds_read_b64_tr_b16 v[110:111], v5 offset:8704
    s_waitcnt vmcnt(4)
    ds_read_b64_tr_b16 v[112:113], v6 offset:10240
    ds_read_b64_tr_b16 v[114:115], v6 offset:10752
    ds_read_b64_tr_b16 v[116:117], v5 offset:10240
    ds_read_b64_tr_b16 v[118:119], v5 offset:10752
    s_waitcnt lgkmcnt(8)
    s_waitcnt vmcnt(2)
    ds_read_b64_tr_b16 v[120:121], v6 offset:12288
    ds_read_b64_tr_b16 v[122:123], v6 offset:12800
    ds_read_b64_tr_b16 v[124:125], v5 offset:12288
    ds_read_b64_tr_b16 v[126:127], v5 offset:12800
    s_waitcnt vmcnt(0)
    ds_read_b64_tr_b16 v[128:129], v6 offset:14336
    ds_read_b64_tr_b16 v[130:131], v6 offset:14848
    ds_read_b64_tr_b16 v[132:133], v5 offset:14336
    ds_read_b64_tr_b16 v[134:135], v5 offset:14848
    s_waitcnt lgkmcnt(8)
    s_add_u32 m0, s81, 0
    s_add_u32 s64, s80, 131072
    buffer_load_dwordx4 v252, s[16:19], s64 offen lds
    s_add_u32 m0, s81, 1024
    s_add_u32 s64, s80, 139264
    buffer_load_dwordx4 v252, s[16:19], s64 offen lds
    s_add_u32 m0, s81, 2048
    s_add_u32 s64, s80, 147456
    buffer_load_dwordx4 v252, s[16:19], s64 offen lds
    s_add_u32 m0, s81, 3072
    s_add_u32 s64, s80, 155648
    buffer_load_dwordx4 v252, s[16:19], s64 offen lds
    s_add_u32 m0, s81, 4096
    s_add_u32 s64, s80, 163840
    buffer_load_dwordx4 v252, s[16:19], s64 offen lds
    s_add_u32 m0, s81, 5120
    s_add_u32 s64, s80, 172032
    buffer_load_dwordx4 v252, s[16:19], s64 offen lds
    s_add_u32 m0, s81, 6144
    s_add_u32 s64, s80, 180224
    buffer_load_dwordx4 v252, s[16:19], s64 offen lds
    s_add_u32 m0, s81, 7168
    s_add_u32 s64, s80, 188416
    buffer_load_dwordx4 v252, s[16:19], s64 offen lds
    s_add_u32 m0, s81, 8192
    s_add_u32 s64, s80, 196608
    buffer_load_dwordx4 v252, s[16:19], s64 offen lds
    s_add_u32 m0, s81, 9216
    s_add_u32 s64, s80, 204800
    buffer_load_dwordx4 v252, s[16:19], s64 offen lds
    s_add_u32 m0, s81, 10240
    s_add_u32 s64, s80, 212992
    buffer_load_dwordx4 v252, s[16:19], s64 offen lds
    s_add_u32 m0, s81, 11264
    s_add_u32 s64, s80, 221184
    buffer_load_dwordx4 v252, s[16:19], s64 offen lds
    s_add_u32 m0, s81, 12288
    s_add_u32 s64, s80, 229376
    s_waitcnt lgkmcnt(4)
    buffer_load_dwordx4 v252, s[16:19], s64 offen lds
    s_add_u32 m0, s81, 13312
    s_add_u32 s64, s80, 237568
    buffer_load_dwordx4 v252, s[16:19], s64 offen lds
    s_add_u32 m0, s81, 14336
    s_add_u32 s64, s80, 245760
    s_waitcnt lgkmcnt(0)
    buffer_load_dwordx4 v252, s[16:19], s64 offen lds
    s_add_u32 m0, s81, 15360
    s_add_u32 s64, s80, 253952
    buffer_load_dwordx4 v252, s[16:19], s64 offen lds
    v_lshrrev_b32 v8, 3, v1
    v_and_b32 v7, 7, v1
    v_lshlrev_b32 v7, 4, v7
    v_lshl_add_u32 v7, v8, 10, v7
    buffer_load_dwordx4 v[248:251], v7, s[8:11], s84 offen
    s_waitcnt lgkmcnt(0)
    s_cmp_ge_u32 s48, 6
    s_cbranch_scc1 L_BHX_o0
    s_load_dwordx4 s[28:31], s[4:5], 0 glc
    s_load_dwordx4 s[32:35], s[4:5], 128 glc
    s_waitcnt lgkmcnt(0)
    s_xor_b64 s[6:7], s[28:29], s[62:63]
    s_xor_b64 s[76:77], s[32:33], s[62:63]
    s_or_b64 s[6:7], s[6:7], s[76:77]
    s_cmp_eq_u64 s[6:7], 0
    s_cbranch_scc1 L_BHX_ph0_x
    s_mov_b32 s75, 0
L_BHX_ph0:
    s_sleep 2
    s_load_dwordx4 s[28:31], s[4:5], 0 glc
    s_load_dwordx4 s[32:35], s[4:5], 128 glc
    s_add_u32 s75, s75, 1
    s_cmp_gt_u32 s75, 1048576
    s_cbranch_scc1 L_BHX_ph0_y
    s_waitcnt lgkmcnt(0)
    s_xor_b64 s[6:7], s[28:29], s[62:63]
    s_xor_b64 s[76:77], s[32:33], s[62:63]
    s_or_b64 s[6:7], s[6:7], s[76:77]
    s_cmp_eq_u64 s[6:7], 0
    s_cbranch_scc0 L_BHX_ph0
L_BHX_ph0_y:
    s_waitcnt lgkmcnt(0)
L_BHX_ph0_x:
    s_branch L_BHX_go0
L_BHX_o0:
    s_load_dwordx16 s[28:43], s[4:5], 0 glc
    s_waitcnt lgkmcnt(0)
    s_xor_b64 s[6:7], s[28:29], s[62:63]
    s_xor_b64 s[76:77], s[30:31], s[62:63]
    s_or_b64 s[6:7], s[6:7], s[76:77]
    s_xor_b64 s[76:77], s[32:33], s[62:63]
    s_or_b64 s[6:7], s[6:7], s[76:77]
    s_xor_b64 s[76:77], s[34:35], s[62:63]
    s_or_b64 s[6:7], s[6:7], s[76:77]
    s_cmp_eq_u64 s[6:7], 0
    s_cbranch_scc1 L_BHX_po0_x
    s_mov_b32 s75, 0
L_BHX_po0:
    s_sleep 2
    s_load_dwordx16 s[28:43], s[4:5], 0 glc
    s_add_u32 s75, s75, 1
    s_cmp_gt_u32 s75, 1048576
    s_cbranch_scc1 L_BHX_po0_y
    s_waitcnt lgkmcnt(0)
    s_xor_b64 s[6:7], s[28:29], s[62:63]
    s_xor_b64 s[76:77], s[30:31], s[62:63]
    s_or_b64 s[6:7], s[6:7], s[76:77]
    s_xor_b64 s[76:77], s[32:33], s[62:63]
    s_or_b64 s[6:7], s[6:7], s[76:77]
    s_xor_b64 s[76:77], s[34:35], s[62:63]
    s_or_b64 s[6:7], s[6:7], s[76:77]
    s_cmp_eq_u64 s[6:7], 0
    s_cbranch_scc0 L_BHX_po0
L_BHX_po0_y:
    s_waitcnt lgkmcnt(0)
L_BHX_po0_x:
L_BHX_go0:
    buffer_load_dwordx4 v[136:139], v3, s[20:23], s82 offen offset:0 sc1
    buffer_load_dwordx4 v[140:143], v3, s[20:23], s83 offen offset:0 sc1
    buffer_load_dwordx4 v[144:147], v3, s[20:23], s82 offen offset:1024 sc1
    buffer_load_dwordx4 v[148:151], v3, s[20:23], s83 offen offset:1024 sc1
    buffer_load_dwordx4 v[152:155], v3, s[20:23], s82 offen offset:2048 sc1
    buffer_load_dwordx4 v[156:159], v3, s[20:23], s83 offen offset:2048 sc1
    buffer_load_dwordx4 v[160:163], v3, s[20:23], s82 offen offset:3072 sc1
    buffer_load_dwordx4 v[164:167], v3, s[20:23], s83 offen offset:3072 sc1
    s_waitcnt vmcnt(7)
    v_mfma_f32_32x32x16_bf16 v[8:23], v[72:75], v[136:139], 0
    s_waitcnt vmcnt(6)
    v_mfma_f32_32x32x16_bf16 v[24:39], v[72:75], v[140:143], 0
    v_mfma_f32_32x32x16_bf16 v[40:55], v[76:79], v[136:139], 0
    v_mfma_f32_32x32x16_bf16 v[56:71], v[76:79], v[140:143], 0
    s_add_u32 s82, s82, 4096
    s_add_u32 s83, s83, 4096
    buffer_load_dwordx4 v[168:171], v3, s[20:23], s82 offen offset:0 sc1
    buffer_load_dwordx4 v[172:175], v3, s[20:23], s83 offen offset:0 sc1
    buffer_load_dwordx4 v[176:179], v3, s[20:23], s82 offen offset:1024 sc1
    buffer_load_dwordx4 v[180:183], v3, s[20:23], s83 offen offset:1024 sc1
    s_waitcnt vmcnt(9)
    v_mfma_f32_32x32x16_bf16 v[8:23], v[80:83], v[144:147], v[8:23]
    s_waitcnt vmcnt(8)
    v_mfma_f32_32x32x16_bf16 v[24:39], v[80:83], v[148:151], v[24:39]
    v_mfma_f32_32x32x16_bf16 v[40:55], v[84:87], v[144:147], v[40:55]
    v_mfma_f32_32x32x16_bf16 v[56:71], v[84:87], v[148:151], v[56:71]
    buffer_load_dwordx4 v[184:187], v3, s[20:23], s82 offen offset:2048 sc1
    buffer_load_dwordx4 v[188:191], v3, s[20:23], s83 offen offset:2048 sc1
    buffer_load_dwordx4 v[192:195], v3, s[20:23], s82 offen offset:3072 sc1
    buffer_load_dwordx4 v[196:199], v3, s[20:23], s83 offen offset:3072 sc1
    s_waitcnt vmcnt(11)
    v_mfma_f32_32x32x16_bf16 v[8:23], v[88:91], v[152:155], v[8:23]
    s_waitcnt vmcnt(10)
    v_mfma_f32_32x32x16_bf16 v[24:39], v[88:91], v[156:159], v[24:39]
    v_mfma_f32_32x32x16_bf16 v[40:55], v[92:95], v[152:155], v[40:55]
    v_mfma_f32_32x32x16_bf16 v[56:71], v[92:95], v[156:159], v[56:71]
    s_waitcnt vmcnt(9)
    v_mfma_f32_32x32x16_bf16 v[8:23], v[96:99], v[160:163], v[8:23]
    s_waitcnt vmcnt(8)
    v_mfma_f32_32x32x16_bf16 v[24:39], v[96:99], v[164:167], v[24:39]
    v_mfma_f32_32x32x16_bf16 v[40:55], v[100:103], v[160:163], v[40:55]
    v_mfma_f32_32x32x16_bf16 v[56:71], v[100:103], v[164:167], v[56:71]
    s_cmp_ge_u32 s48, 6
    s_cbranch_scc1 L_BHX_o1
    s_waitcnt lgkmcnt(0)
    s_xor_b64 s[6:7], s[30:31], s[62:63]
    s_xor_b64 s[76:77], s[34:35], s[62:63]
    s_or_b64 s[6:7], s[6:7], s[76:77]
    s_cmp_eq_u64 s[6:7], 0
    s_cbranch_scc1 L_BHX_ph1_x
    s_mov_b32 s75, 0
L_BHX_ph1:
    s_sleep 2
    s_load_dwordx4 s[28:31], s[4:5], 0 glc
    s_load_dwordx4 s[32:35], s[4:5], 128 glc
    s_add_u32 s75, s75, 1
    s_cmp_gt_u32 s75, 1048576
    s_cbranch_scc1 L_BHX_ph1_y
    s_waitcnt lgkmcnt(0)
    s_xor_b64 s[6:7], s[30:31], s[62:63]
    s_xor_b64 s[76:77], s[34:35], s[62:63]
    s_or_b64 s[6:7], s[6:7], s[76:77]
    s_cmp_eq_u64 s[6:7], 0
    s_cbranch_scc0 L_BHX_ph1
L_BHX_ph1_y:
    s_waitcnt lgkmcnt(0)
L_BHX_ph1_x:
    s_branch L_BHX_go1
L_BHX_o1:
    s_waitcnt lgkmcnt(0)
    s_xor_b64 s[6:7], s[36:37], s[62:63]
    s_xor_b64 s[76:77], s[38:39], s[62:63]
    s_or_b64 s[6:7], s[6:7], s[76:77]
    s_xor_b64 s[76:77], s[40:41], s[62:63]
    s_or_b64 s[6:7], s[6:7], s[76:77]
    s_xor_b64 s[76:77], s[42:43], s[62:63]
    s_or_b64 s[6:7], s[6:7], s[76:77]
    s_cmp_eq_u64 s[6:7], 0
    s_cbranch_scc1 L_BHX_po1_x
    s_mov_b32 s75, 0
L_BHX_po1:
    s_sleep 2
    s_load_dwordx16 s[28:43], s[4:5], 0 glc
    s_add_u32 s75, s75, 1
    s_cmp_gt_u32 s75, 1048576
    s_cbranch_scc1 L_BHX_po1_y
    s_waitcnt lgkmcnt(0)
    s_xor_b64 s[6:7], s[36:37], s[62:63]
    s_xor_b64 s[76:77], s[38:39], s[62:63]
    s_or_b64 s[6:7], s[6:7], s[76:77]
    s_xor_b64 s[76:77], s[40:41], s[62:63]
    s_or_b64 s[6:7], s[6:7], s[76:77]
    s_xor_b64 s[76:77], s[42:43], s[62:63]
    s_or_b64 s[6:7], s[6:7], s[76:77]
    s_cmp_eq_u64 s[6:7], 0
    s_cbranch_scc0 L_BHX_po1
L_BHX_po1_y:
    s_waitcnt lgkmcnt(0)
L_BHX_po1_x:
L_BHX_go1:
    s_add_u32 s82, s82, 4096
    s_add_u32 s83, s83, 4096
    buffer_load_dwordx4 v[200:203], v3, s[20:23], s82 offen offset:0 sc1
    buffer_load_dwordx4 v[204:207], v3, s[20:23], s83 offen offset:0 sc1
    buffer_load_dwordx4 v[208:211], v3, s[20:23], s82 offen offset:1024 sc1
    buffer_load_dwordx4 v[212:215], v3, s[20:23], s83 offen offset:1024 sc1
    s_waitcnt vmcnt(11)
    v_mfma_f32_32x32x16_bf16 v[8:23], v[104:107], v[168:171], v[8:23]
    s_waitcnt vmcnt(10)
    v_mfma_f32_32x32x16_bf16 v[24:39], v[104:107], v[172:175], v[24:39]
    v_mfma_f32_32x32x16_bf16 v[40:55], v[108:111], v[168:171], v[40:55]
    v_mfma_f32_32x32x16_bf16 v[56:71], v[108:111], v[172:175], v[56:71]
    buffer_load_dwordx4 v[216:219], v3, s[20:23], s82 offen offset:2048 sc1
    buffer_load_dwordx4 v[220:223], v3, s[20:23], s83 offen offset:2048 sc1
    buffer_load_dwordx4 v[224:227], v3, s[20:23], s82 offen offset:3072 sc1
    buffer_load_dwordx4 v[228:231], v3, s[20:23], s83 offen offset:3072 sc1
    s_waitcnt vmcnt(13)
    v_mfma_f32_32x32x16_bf16 v[8:23], v[112:115], v[176:179], v[8:23]
    s_waitcnt vmcnt(12)
    v_mfma_f32_32x32x16_bf16 v[24:39], v[112:115], v[180:183], v[24:39]
    v_mfma_f32_32x32x16_bf16 v[40:55], v[116:119], v[176:179], v[40:55]
    v_mfma_f32_32x32x16_bf16 v[56:71], v[116:119], v[180:183], v[56:71]
    s_add_u32 s82, s82, 4096
    s_add_u32 s83, s83, 4096
    buffer_load_dwordx4 v[72:75], v3, s[20:23], s82 offen offset:0 sc1
    buffer_load_dwordx4 v[76:79], v3, s[20:23], s83 offen offset:0 sc1
    buffer_load_dwordx4 v[80:83], v3, s[20:23], s82 offen offset:1024 sc1
    buffer_load_dwordx4 v[84:87], v3, s[20:23], s83 offen offset:1024 sc1
    s_waitcnt vmcnt(15)
    v_mfma_f32_32x32x16_bf16 v[8:23], v[120:123], v[184:187], v[8:23]
    s_waitcnt vmcnt(14)
    v_mfma_f32_32x32x16_bf16 v[24:39], v[120:123], v[188:191], v[24:39]
    v_mfma_f32_32x32x16_bf16 v[40:55], v[124:127], v[184:187], v[40:55]
    v_mfma_f32_32x32x16_bf16 v[56:71], v[124:127], v[188:191], v[56:71]
    buffer_load_dwordx4 v[88:91], v3, s[20:23], s82 offen offset:2048 sc1
    buffer_load_dwordx4 v[92:95], v3, s[20:23], s83 offen offset:2048 sc1
    buffer_load_dwordx4 v[96:99], v3, s[20:23], s82 offen offset:3072 sc1
    buffer_load_dwordx4 v[100:103], v3, s[20:23], s83 offen offset:3072 sc1
    ds_read_b64_tr_b16 v[232:233], v6 offset:0
    ds_read_b64_tr_b16 v[234:235], v6 offset:512
    ds_read_b64_tr_b16 v[236:237], v5 offset:0
    ds_read_b64_tr_b16 v[238:239], v5 offset:512
    s_waitcnt vmcnt(17)
    v_mfma_f32_32x32x16_bf16 v[8:23], v[128:131], v[192:195], v[8:23]
    s_waitcnt vmcnt(16)
    v_mfma_f32_32x32x16_bf16 v[24:39], v[128:131], v[196:199], v[24:39]
    v_mfma_f32_32x32x16_bf16 v[40:55], v[132:135], v[192:195], v[40:55]
    v_mfma_f32_32x32x16_bf16 v[56:71], v[132:135], v[196:199], v[56:71]
    ds_read_b64_tr_b16 v[240:241], v6 offset:2048
    ds_read_b64_tr_b16 v[242:243], v6 offset:2560
    ds_read_b64_tr_b16 v[244:245], v5 offset:2048
    ds_read_b64_tr_b16 v[246:247], v5 offset:2560
    s_waitcnt vmcnt(15) lgkmcnt(6)
    v_mfma_f32_32x32x16_bf16 v[8:23], v[232:235], v[200:203], v[8:23]
    s_waitcnt vmcnt(14)
    v_mfma_f32_32x32x16_bf16 v[24:39], v[232:235], v[204:207], v[24:39]
    s_waitcnt lgkmcnt(4)
    v_mfma_f32_32x32x16_bf16 v[40:55], v[236:239], v[200:203], v[40:55]
    v_mfma_f32_32x32x16_bf16 v[56:71], v[236:239], v[204:207], v[56:71]
    ds_read_b64_tr_b16 v[232:233], v6 offset:4096
    ds_read_b64_tr_b16 v[234:235], v6 offset:4608
    ds_read_b64_tr_b16 v[236:237], v5 offset:4096
    ds_read_b64_tr_b16 v[238:239], v5 offset:4608
    s_waitcnt vmcnt(13) lgkmcnt(6)
    v_mfma_f32_32x32x16_bf16 v[8:23], v[240:243], v[208:211], v[8:23]
    s_waitcnt vmcnt(12)
    v_mfma_f32_32x32x16_bf16 v[24:39], v[240:243], v[212:215], v[24:39]
    s_waitcnt lgkmcnt(4)
    v_mfma_f32_32x32x16_bf16 v[40:55], v[244:247], v[208:211], v[40:55]
    v_mfma_f32_32x32x16_bf16 v[56:71], v[244:247], v[212:215], v[56:71]
    ds_read_b64_tr_b16 v[240:241], v6 offset:6144
    ds_read_b64_tr_b16 v[242:243], v6 offset:6656
    ds_read_b64_tr_b16 v[244:245], v5 offset:6144
    ds_read_b64_tr_b16 v[246:247], v5 offset:6656
    s_waitcnt vmcnt(11) lgkmcnt(6)
    v_mfma_f32_32x32x16_bf16 v[8:23], v[232:235], v[216:219], v[8:23]
    s_waitcnt vmcnt(10)
    v_mfma_f32_32x32x16_bf16 v[24:39], v[232:235], v[220:223], v[24:39]
    s_waitcnt lgkmcnt(4)
    v_mfma_f32_32x32x16_bf16 v[40:55], v[236:239], v[216:219], v[40:55]
    v_mfma_f32_32x32x16_bf16 v[56:71], v[236:239], v[220:223], v[56:71]
    ds_read_b64_tr_b16 v[232:233], v6 offset:8192
    ds_read_b64_tr_b16 v[234:235], v6 offset:8704
    ds_read_b64_tr_b16 v[236:237], v5 offset:8192
    ds_read_b64_tr_b16 v[238:239], v5 offset:8704
    s_waitcnt vmcnt(9) lgkmcnt(6)
    v_mfma_f32_32x32x16_bf16 v[8:23], v[240:243], v[224:227], v[8:23]
    s_waitcnt vmcnt(8)
    v_mfma_f32_32x32x16_bf16 v[24:39], v[240:243], v[228:231], v[24:39]
    s_waitcnt lgkmcnt(4)
    v_mfma_f32_32x32x16_bf16 v[40:55], v[244:247], v[224:227], v[40:55]
    v_mfma_f32_32x32x16_bf16 v[56:71], v[244:247], v[228:231], v[56:71]
    ds_read_b64_tr_b16 v[240:241], v6 offset:10240
    ds_read_b64_tr_b16 v[242:243], v6 offset:10752
    ds_read_b64_tr_b16 v[244:245], v5 offset:10240
    ds_read_b64_tr_b16 v[246:247], v5 offset:10752
    s_waitcnt vmcnt(7) lgkmcnt(6)
    v_mfma_f32_32x32x16_bf16 v[8:23], v[232:235], v[72:75], v[8:23]
    s_waitcnt vmcnt(6)
    v_mfma_f32_32x32x16_bf16 v[24:39], v[232:235], v[76:79], v[24:39]
    s_waitcnt lgkmcnt(4)
    v_mfma_f32_32x32x16_bf16 v[40:55], v[236:239], v[72:75], v[40:55]
    v_mfma_f32_32x32x16_bf16 v[56:71], v[236:239], v[76:79], v[56:71]
    ds_read_b64_tr_b16 v[232:233], v6 offset:12288
    ds_read_b64_tr_b16 v[234:235], v6 offset:12800
    ds_read_b64_tr_b16 v[236:237], v5 offset:12288
    ds_read_b64_tr_b16 v[238:239], v5 offset:12800
    s_waitcnt vmcnt(5) lgkmcnt(6)
    v_mfma_f32_32x32x16_bf16 v[8:23], v[240:243], v[80:83], v[8:23]
    s_waitcnt vmcnt(4)
    v_mfma_f32_32x32x16_bf16 v[24:39], v[240:243], v[84:87], v[24:39]
    s_waitcnt lgkmcnt(4)
    v_mfma_f32_32x32x16_bf16 v[40:55], v[244:247], v[80:83], v[40:55]
    v_mfma_f32_32x32x16_bf16 v[56:71], v[244:247], v[84:87], v[56:71]
    ds_read_b64_tr_b16 v[240:241], v6 offset:14336
    ds_read_b64_tr_b16 v[242:243], v6 offset:14848
    ds_read_b64_tr_b16 v[244:245], v5 offset:14336
    ds_read_b64_tr_b16 v[246:247], v5 offset:14848
    s_waitcnt vmcnt(3) lgkmcnt(6)
    v_mfma_f32_32x32x16_bf16 v[8:23], v[232:235], v[88:91], v[8:23]
    s_waitcnt vmcnt(2)
    v_mfma_f32_32x32x16_bf16 v[24:39], v[232:235], v[92:95], v[24:39]
    s_waitcnt lgkmcnt(4)
    v_mfma_f32_32x32x16_bf16 v[40:55], v[236:239], v[88:91], v[40:55]
    v_mfma_f32_32x32x16_bf16 v[56:71], v[236:239], v[92:95], v[56:71]
    s_waitcnt vmcnt(1) lgkmcnt(2)
    v_mfma_f32_32x32x16_bf16 v[8:23], v[240:243], v[96:99], v[8:23]
    s_waitcnt vmcnt(0)
    v_mfma_f32_32x32x16_bf16 v[24:39], v[240:243], v[100:103], v[24:39]
    s_waitcnt lgkmcnt(0)
    v_mfma_f32_32x32x16_bf16 v[40:55], v[244:247], v[96:99], v[40:55]
    v_mfma_f32_32x32x16_bf16 v[56:71], v[244:247], v[100:103], v[56:71]
    v_and_b32 v4, 31, v1
    v_lshrrev_b32 v5, 5, v1
    v_and_b32 v6, 7, v1
    v_xor_b32 v6, v5, v6
    v_lshlrev_b32 v6, 4, v6
    v_lshl_add_u32 v6, v4, 8, v6
    v_add_u32 v72, s81, v6
    v_xor_b32 v73, 32, v72
    v_xor_b32 v74, 64, v72
    v_xor_b32 v75, 96, v72
    ds_write_b128 v72, v[8:11] offset:0
    ds_write_b128 v73, v[12:15] offset:0
    ds_write_b128 v74, v[16:19] offset:0
    ds_write_b128 v75, v[20:23] offset:0
    ds_write_b128 v72, v[24:27] offset:8192
    ds_write_b128 v73, v[28:31] offset:8192
    ds_write_b128 v74, v[32:35] offset:8192
    ds_write_b128 v75, v[36:39] offset:8192
    ds_write_b128 v72, v[40:43] offset:128
    ds_write_b128 v73, v[44:47] offset:128
    ds_write_b128 v74, v[48:51] offset:128
    ds_write_b128 v75, v[52:55] offset:128
    ds_write_b128 v72, v[56:59] offset:8320
    ds_write_b128 v73, v[60:63] offset:8320
    ds_write_b128 v74, v[64:67] offset:8320
    s_waitcnt lgkmcnt(8)
    ds_write_b128 v75, v[68:71] offset:8320
    s_waitcnt vmcnt(0)
L_red:
    v_lshrrev_b32 v4, 3, v1
    v_and_b32 v5, 7, v1
    v_lshlrev_b32 v5, 1, v5
    v_xor_b32 v5, v4, v5
    v_lshlrev_b32 v5, 4, v5
    v_lshl_add_u32 v5, v4, 8, v5
    s_lshl_b32 s7, s48, 11
    v_add_u32 v76, s7, v5
    v_xor_b32 v77, 16, v76
    v_add_u32 v78, 0x10000, v76
    v_add_u32 v79, 0x10000, v77
    v_add_u32 v80, 0x20000, v76
    v_add_u32 v81, 0x20000, v77
    v_lshlrev_b32 v148, 16, v248
    v_and_b32 v149, 0xffff0000, v248
    v_lshlrev_b32 v150, 16, v249
    v_and_b32 v151, 0xffff0000, v249
    v_lshlrev_b32 v152, 16, v250
    v_and_b32 v153, 0xffff0000, v250
    v_lshlrev_b32 v154, 16, v251
    v_and_b32 v155, 0xffff0000, v251
    s_waitcnt lgkmcnt(0)
    s_barrier
    ds_read_b128 v[84:87], v78 offset:0
    ds_read_b128 v[88:91], v79 offset:0
    ds_read_b128 v[92:95], v78 offset:16384
    ds_read_b128 v[96:99], v79 offset:16384
    ds_read_b128 v[100:103], v78 offset:32768
    ds_read_b128 v[104:107], v79 offset:32768
    ds_read_b128 v[108:111], v78 offset:49152
    ds_read_b128 v[112:115], v79 offset:49152
    ds_read_b128 v[116:119], v76 offset:32768
    ds_read_b128 v[120:123], v77 offset:32768
    ds_read_b128 v[124:127], v76 offset:49152
    ds_read_b128 v[128:131], v77 offset:49152
    ds_read_b128 v[132:135], v80 offset:0
    ds_read_b128 v[136:139], v81 offset:0
    s_waitcnt lgkmcnt(8)
    ds_read_b128 v[140:143], v80 offset:16384
    ds_read_b128 v[144:147], v81 offset:16384
    v_add_f32 v84, v84, v92
    v_add_f32 v85, v85, v93
    v_add_f32 v86, v86, v94
    v_add_f32 v87, v87, v95
    v_add_f32 v88, v88, v96
    v_add_f32 v89, v89, v97
    v_add_f32 v90, v90, v98
    v_add_f32 v91, v91, v99
    v_add_f32 v84, v84, v100
    v_add_f32 v85, v85, v101
    v_add_f32 v86, v86, v102
    v_add_f32 v87, v87, v103
    v_add_f32 v88, v88, v104
    v_add_f32 v89, v89, v105
    v_add_f32 v90, v90, v106
    v_add_f32 v91, v91, v107
    s_waitcnt lgkmcnt(9)
    v_add_f32 v84, v84, v108
    v_add_f32 v85, v85, v109
    v_add_f32 v86, v86, v110
    v_add_f32 v87, v87, v111
    s_waitcnt lgkmcnt(8)
    v_add_f32 v88, v88, v112
    v_add_f32 v89, v89, v113
    v_add_f32 v90, v90, v114
    v_add_f32 v91, v91, v115
    s_waitcnt lgkmcnt(7)
    v_add_f32 v84, v84, v116
    v_add_f32 v85, v85, v117
    v_add_f32 v86, v86, v118
    v_add_f32 v87, v87, v119
    s_waitcnt lgkmcnt(6)
    v_add_f32 v88, v88, v120
    v_add_f32 v89, v89, v121
    v_add_f32 v90, v90, v122
    v_add_f32 v91, v91, v123
    s_waitcnt lgkmcnt(5)
    v_add_f32 v84, v84, v124
    v_add_f32 v85, v85, v125
    v_add_f32 v86, v86, v126
    v_add_f32 v87, v87, v127
    s_waitcnt lgkmcnt(4)
    v_add_f32 v88, v88, v128
    v_add_f32 v89, v89, v129
    v_add_f32 v90, v90, v130
    v_add_f32 v91, v91, v131
    v_mul_f32 v92, 0xbfb8aa3b, v84
    v_mul_f32 v93, 0xbfb8aa3b, v85
    v_mul_f32 v94, 0xbfb8aa3b, v86
    v_mul_f32 v95, 0xbfb8aa3b, v87
    v_mul_f32 v96, 0xbfb8aa3b, v88
    v_mul_f32 v97, 0xbfb8aa3b, v89
    v_mul_f32 v98, 0xbfb8aa3b, v90
    v_mul_f32 v99, 0xbfb8aa3b, v91
    v_exp_f32 v92, v92
    v_exp_f32 v93, v93
    v_exp_f32 v94, v94
    v_exp_f32 v95, v95
    v_exp_f32 v96, v96
    v_exp_f32 v97, v97
    v_exp_f32 v98, v98
    v_exp_f32 v99, v99
    s_waitcnt lgkmcnt(1)
    v_add_f32 v132, v132, v140
    v_add_f32 v133, v133, v141
    v_add_f32 v134, v134, v142
    v_add_f32 v135, v135, v143
    s_waitcnt lgkmcnt(0)
    v_add_f32 v136, v136, v144
    v_add_f32 v137, v137, v145
    v_add_f32 v138, v138, v146
    v_add_f32 v139, v139, v147
    v_add_f32 v92, 1.0, v92
    v_add_f32 v93, 1.0, v93
    v_add_f32 v94, 1.0, v94
    v_add_f32 v95, 1.0, v95
    v_add_f32 v96, 1.0, v96
    v_add_f32 v97, 1.0, v97
    v_add_f32 v98, 1.0, v98
    v_add_f32 v99, 1.0, v99
    v_rcp_f32 v92, v92
    v_rcp_f32 v93, v93
    v_rcp_f32 v94, v94
    v_rcp_f32 v95, v95
    v_rcp_f32 v96, v96
    v_rcp_f32 v97, v97
    v_rcp_f32 v98, v98
    v_rcp_f32 v99, v99
    v_mul_f32 v84, v84, v132
    v_mul_f32 v85, v85, v133
    v_mul_f32 v86, v86, v134
    v_mul_f32 v87, v87, v135
    v_mul_f32 v88, v88, v136
    v_mul_f32 v89, v89, v137
    v_mul_f32 v90, v90, v138
    v_mul_f32 v91, v91, v139
    v_fma_f32 v84, v84, v92, v148
    v_fma_f32 v85, v85, v93, v149
    v_fma_f32 v86, v86, v94, v150
    v_fma_f32 v87, v87, v95, v151
    v_fma_f32 v88, v88, v96, v152
    v_fma_f32 v89, v89, v97, v153
    v_fma_f32 v90, v90, v98, v154
    v_fma_f32 v91, v91, v99, v155
    v_cvt_pk_bf16_f32 v108, v84, v85
    v_cvt_pk_bf16_f32 v109, v86, v87
    v_cvt_pk_bf16_f32 v110, v88, v89
    v_cvt_pk_bf16_f32 v111, v90, v91
    buffer_store_dwordx4 v[108:111], v7, s[24:27], s84 offen sc1 nt
L_fin:
L_end:
    s_endpgm
.section .rodata,"a"
.p2align 6
.amdhsa_kernel recurrent_scan__linear_kernel_hedgehog__glu_gated_reglu__prompt_kernel
  .amdhsa_next_free_vgpr 256
  .amdhsa_next_free_sgpr 102
  .amdhsa_accum_offset 256
  .amdhsa_group_segment_fixed_size 0
  .amdhsa_kernarg_size 88
  .amdhsa_user_sgpr_count 2
  .amdhsa_user_sgpr_kernarg_segment_ptr 1
  .amdhsa_system_sgpr_workgroup_id_x 1
.end_amdhsa_kernel
```
